```python
import torch

def _softmax(x, axis=-1):
    return torch.softmax(x, dim=axis)
def _gelu(x):
    return torch.nn.functional.gelu(x, approximate="tanh")
def _silu(x):
    return torch.nn.functional.silu(x)
def _sigmoid(x):
    return torch.sigmoid(x)
def _layernorm(x, axis=-1, eps=1e-5):
    m = x.mean(dim=axis, keepdim=True)
    v = x.var(dim=axis, keepdim=True, unbiased=False)
    return (x - m) / torch.sqrt(v + eps)
def _scatter_add(tgt, idx, src, axis=0):
    return tgt.clone().index_add_(axis, idx, src)
def _segment_sum(src, seg, n):
    out = torch.zeros((n,) + src.shape[1:], dtype=src.dtype)
    return out.index_add_(0, seg, src)
def _pad(x, pw):
    flat = tuple(v for pair in reversed(pw) for v in pair)
    return torch.nn.functional.pad(x, flat)

kernel_name = 'concat_heads__mha_block_cached__gqa_block_cached__near_ridge'

def setup_inputs():

    _w = (lambda a: (lambda t: t.to(torch.bfloat16) if t.is_floating_point() else t)(torch.as_tensor(a)))
    def _A_setup():
        B, Sq, D = 8, 240, 512
        H, Sk, Dh = 32, 1024, 128
        return {
            "x": _w((lambda *s: torch.randn(*s, dtype=torch.bfloat16) * 0.8)(B, Sq, D)),
            "k_cache": _w((lambda *s: torch.randn(*s, dtype=torch.bfloat16) * 0.8)(B, H, Sk, Dh)),
            "v_cache": _w((lambda *s: torch.randn(*s, dtype=torch.bfloat16) * 0.05)(B, H, Sk, Dh)),
            "wq": _w((lambda *s: torch.randn(*s, dtype=torch.bfloat16) * 0.8)(D, H * Dh) * (D ** -0.5)),
            "wo": _w((lambda *s: torch.randn(*s, dtype=torch.bfloat16) * 0.05)(H * Dh, D) * ((H * Dh) ** -0.5)),
        }
    _A_in = _A_setup()

    def _B_setup():
        B, Sq, D = 8, 240, 512
        Hq, Hkv, Sk, Dh = 32, 32, 1024, 128
        assert Hq % Hkv == 0, (Hq, Hkv)
        return {
            "x": _w((lambda *s: torch.randn(*s, dtype=torch.bfloat16) * 0.8)(B, Sq, D)),
            "k_cache": _w((lambda *s: torch.randn(*s, dtype=torch.bfloat16) * 0.8)(B, Hkv, Sk, Dh)),
            "v_cache": _w((lambda *s: torch.randn(*s, dtype=torch.bfloat16) * 0.05)(B, Hkv, Sk, Dh)),
            "wq": _w((lambda *s: torch.randn(*s, dtype=torch.bfloat16) * 0.8)(D, Hq * Dh) * (D ** -0.5)),
            "wo": _w((lambda *s: torch.randn(*s, dtype=torch.bfloat16) * 0.05)(Hq * Dh, D) * ((Hq * Dh) ** -0.5)),
        }
    _B_in = _B_setup()

    return {
        "A_x": _A_in["x"],
        "A_k_cache": _A_in["k_cache"],
        "A_v_cache": _A_in["v_cache"],
        "A_wq": _A_in["wq"],
        "A_wo": _A_in["wo"],
        "B_x": _B_in["x"],
        "B_k_cache": _B_in["k_cache"],
        "B_v_cache": _B_in["v_cache"],
        "B_wq": _B_in["wq"],
        "B_wo": _B_in["wo"],
    }

def reference(A_x, A_k_cache, A_v_cache, A_wq, A_wo, B_x, B_k_cache, B_v_cache, B_wq, B_wo):
    def _A_ref(x, k_cache, v_cache, wq, wo):
        B, Sq, D = x.shape
        H, Dh = 32, 128
        q = (lambda x, *d: x.permute(*d))((x @ wq).reshape(B, Sq, H, Dh), 0, 2, 1, 3)
        scores = torch.einsum("bhqd,bhkd->bhqk", q, k_cache) * (Dh ** -0.5)
        p = _softmax(scores, axis=-1)
        o = torch.einsum("bhqk,bhkd->bhqd", p, v_cache)
        return (lambda x, *d: x.permute(*d))(o, 0, 2, 1, 3).reshape(B, Sq, H * Dh) @ wo

    def _B_ref(x, k_cache, v_cache, wq, wo):
        B, Sq, D = x.shape
        Hq, Dh = 32, 128
        Hkv = k_cache.shape[1]
        rep = Hq // Hkv
        q = (lambda x, *d: x.permute(*d))((x @ wq).reshape(B, Sq, Hq, Dh), 0, 2, 1, 3)
        k = (lambda x, n, axis: torch.repeat_interleave(x, n, dim=axis))(k_cache, rep, axis=1)
        v = (lambda x, n, axis: torch.repeat_interleave(x, n, dim=axis))(v_cache, rep, axis=1)
        scores = torch.einsum("bhqd,bhkd->bhqk", q, k) * (Dh ** -0.5)
        p = _softmax(scores, axis=-1)
        o = torch.einsum("bhqk,bhkd->bhqd", p, v)
        return (lambda x, *d: x.permute(*d))(o, 0, 2, 1, 3).reshape(B, Sq, Hq * Dh) @ wo

    a = _A_ref(A_x, A_k_cache, A_v_cache, A_wq, A_wo)
    b = _B_ref(B_x, B_k_cache, B_v_cache, B_wq, B_wo)
    return torch.concatenate([a, b], axis=-1)
```

```asm
; @launch grid=(256,1,1) block=(256,1,1) lds=163840
.amdgcn_target "amdgcn-amd-amdhsa--gfx950"
.text
.globl concat_heads__mha_block_cached__gqa_block_cached__near_ridge_kernel
.p2align 8
.type concat_heads__mha_block_cached__gqa_block_cached__near_ridge_kernel,@function
concat_heads__mha_block_cached__gqa_block_cached__near_ridge_kernel:
    s_cmp_ge_u32 s2, 256
    s_cbranch_scc1 K1_END
    s_bfe_u32 s44, s2, 0x10002
    s_mul_i32 s3, s44, 40
    s_load_dwordx8 s[28:35], s[0:1], s3
    s_add_u32 s3, s3, 32
    s_load_dwordx2 s[36:37], s[0:1], s3
    s_load_dwordx2 s[38:39], s[0:1], 96
    s_getpc_b64 s[24:25]
K1_PC:
    v_lshrrev_b32 v224, 6, v0
    v_and_b32 v225, 63, v0
    v_readfirstlane_b32 s3, v224
    v_lshlrev_b32 v223, 4, v225
    s_lshl_b32 s40, s3, 12
    s_lshl_b32 s100, s3, 10
    s_lshl_b32 s49, s3, 13
    s_mul_i32 s60, s3, 2056
    s_cmp_eq_u32 s3, 3
    s_cselect_b32 s61, 0xf149f2ca, 0
    s_mov_b32 s41, 0
    s_mov_b32 s62, 0x3e0293ee
    s_mov_b32 s63, 0x3e0293ee
    s_lshr_b32 s42, s2, 5
    s_and_b32 s59, s2, 3
    s_lshl_b32 s43, s59, 2
    s_bfe_u32 s59, s2, 0x20003
    s_add_u32 s43, s43, s59
    s_lshl_b32 s43, s43, 1
    s_mov_b32 s101, 0
    s_mov_b32 s55, 0
    s_mov_b32 s56, 131072
    s_mov_b32 s57, 262144
    s_mov_b32 s58, 393216
    s_mov_b32 s26, 46400
    s_mov_b32 s27, 0x20000
    s_lshr_b32 s3, s2, 3
    s_lshl_b32 s3, s3, 10
    v_lshl_add_u32 v226, v224, 15, v223
    buffer_load_dwordx4 v[236:239], v226, s[24:27], s3 offen
    v_lshrrev_b32 v226, 3, v225
    v_lshl_add_u32 v226, v224, 6, v226
    v_lshlrev_b32 v226, 10, v226
    v_lshrrev_b32 v227, 4, v225
    v_and_b32 v229, 7, v225
    v_xor_b32 v228, v227, v229
    v_lshl_add_u32 v210, v228, 4, v226
    v_xor_b32 v211, 64, v210
    v_add_u32 v211, 7168, v211
    v_add_u32 v212, 14336, v210
    v_add_u32 v213, 14336, v211
    v_and_b32 v226, 15, v225
    v_lshlrev_b32 v228, 2, v227
    v_xor_b32 v228, v228, v226
    v_lshlrev_b32 v228, 4, v228
    v_lshl_add_u32 v229, v224, 3, v227
    v_lshl_add_u32 v214, v229, 13, v228
    v_add_u32 v215, 31744, v214
    s_mov_b32 s46, 0
    s_mov_b32 s47, 0
    s_mov_b32 s48, 256
    s_waitcnt lgkmcnt(0)
    s_mul_i32 s3, s42, 245760
    s_add_u32 s12, s28, s3
    s_addc_u32 s13, s29, 0
    s_mov_b32 s14, 245760
    s_mov_b32 s15, 0x20000
    s_lshl_b32 s3, s43, 8
    s_add_u32 s16, s34, s3
    s_addc_u32 s17, s35, 0
    s_sub_u32 s18, 4194304, s3
    s_mov_b32 s19, 0x20000
    s_add_u32 m0, s60, 123104
    s_nop 0
    buffer_load_dwordx4 v214, s[16:19], s48 offen offset:0 nt lds
    buffer_load_dwordx4 v215, s[16:19], s48 offen offset:1024 nt lds
    s_add_u32 s48, s48, 262144
    s_add_u32 m0, s60, 114880
    s_nop 0
    buffer_load_dwordx4 v214, s[16:19], s47 offen offset:0 nt lds
    buffer_load_dwordx4 v215, s[16:19], s47 offen offset:1024 nt lds
    s_add_u32 s47, s47, 262144
    s_add_u32 m0, s49, 0
    s_nop 0
    buffer_load_dwordx4 v210, s[12:15], s46 offen offset:0 nt lds
    buffer_load_dwordx4 v211, s[12:15], s46 offen offset:1024 nt lds
    buffer_load_dwordx4 v212, s[12:15], s46 offen offset:2048 nt lds
    buffer_load_dwordx4 v213, s[12:15], s46 offen offset:3072 nt lds
    s_add_u32 s46, s46, 32768
    s_add_u32 m0, s49, 4096
    s_nop 0
    buffer_load_dwordx4 v210, s[12:15], s46 offen offset:0 nt lds
    buffer_load_dwordx4 v211, s[12:15], s46 offen offset:1024 nt lds
    buffer_load_dwordx4 v212, s[12:15], s46 offen offset:2048 nt lds
    buffer_load_dwordx4 v213, s[12:15], s46 offen offset:3072 nt lds
    s_sub_u32 s46, s46, 32640
    s_lshl_b32 s3, s42, 5
    s_add_u32 s3, s3, s43
    s_lshl_b32 s3, s3, 18
    s_add_u32 s4, s30, s3
    s_addc_u32 s5, s31, 0
    s_mov_b32 s6, 524288
    s_mov_b32 s7, 0x20000
    s_add_u32 s8, s32, s3
    s_addc_u32 s9, s33, 0
    s_mov_b32 s10, 524288
    s_mov_b32 s11, 0x20000
    s_mul_i32 s3, s44, 120
    s_mul_i32 s59, s42, 15
    s_add_u32 s3, s3, s59
    s_lshl_b32 s3, s3, 17
    s_lshl_b32 s59, s43, 12
    s_add_u32 s3, s3, s59
    s_add_u32 s20, s38, s3
    s_addc_u32 s21, s39, 0
    s_sub_u32 s22, 1966080, s59
    s_mov_b32 s23, 0x20000
    s_and_b32 s3, s2, 3
    s_lshl_b32 s3, s3, 5
    s_lshr_b32 s59, s2, 3
    s_add_u32 s3, s3, s59
    s_lshl_b32 s3, s3, 15
    s_add_u32 s24, s36, s3
    s_addc_u32 s25, s37, 0
    s_mov_b32 s26, 32768
    s_mov_b32 s27, 0x20000
    v_lshlrev_b32 v230, 17, v224
    buffer_load_dword v240, v230, s[4:7], 0 offen nt
    buffer_load_dword v241, v230, s[8:11], 0 offen nt
    v_lshlrev_b32 v230, 20, v224
    v_add_u32 v230, 0xfe000, v230
    buffer_load_dword v243, v230, s[16:19], 0 offen
    v_lshl_add_u32 v230, v224, 2, v227
    v_lshlrev_b32 v229, 8, v230
    v_xor_b32 v231, v230, v226
    v_lshl_add_u32 v204, v231, 4, v229
    v_and_b32 v230, 7, v230
    v_lshlrev_b32 v230, 1, v230
    v_xor_b32 v231, v230, v226
    v_lshl_add_u32 v208, v231, 4, v229
    v_lshlrev_b32 v229, 8, v226
    v_add_u32 v229, 147456, v229
    v_add_u32 v230, 0, v227
    v_xor_b32 v230, v230, v226
    v_lshl_add_u32 v192, v230, 4, v229
    v_add_u32 v230, 4, v227
    v_xor_b32 v230, v230, v226
    v_lshl_add_u32 v193, v230, 4, v229
    v_add_u32 v230, 8, v227
    v_xor_b32 v230, v230, v226
    v_lshl_add_u32 v194, v230, 4, v229
    v_add_u32 v230, 12, v227
    v_xor_b32 v230, v230, v226
    v_lshl_add_u32 v195, v230, 4, v229
    v_lshrrev_b32 v228, 1, v226
    v_xor_b32 v229, v228, v227
    v_lshlrev_b32 v229, 4, v229
    v_lshl_add_u32 v229, v226, 7, v229
    v_lshl_add_u32 v209, v224, 13, v229
    v_xor_b32 v216, 64, v209
    v_lshrrev_b32 v228, 2, v226
    v_and_b32 v229, 3, v225
    v_lshl_add_u32 v230, v227, 2, v228
    v_and_b32 v231, 7, v230
    v_lshlrev_b32 v230, 8, v230
    v_lshl_add_u32 v230, v229, 3, v230
    v_xor_b32 v232, 0, v231
    v_lshl_add_u32 v196, v232, 5, v230
    v_xor_b32 v232, 1, v231
    v_lshl_add_u32 v197, v232, 5, v230
    v_xor_b32 v232, 2, v231
    v_lshl_add_u32 v198, v232, 5, v230
    v_xor_b32 v232, 3, v231
    v_lshl_add_u32 v199, v232, 5, v230
    v_xor_b32 v232, 4, v231
    v_lshl_add_u32 v200, v232, 5, v230
    v_xor_b32 v232, 5, v231
    v_lshl_add_u32 v201, v232, 5, v230
    v_xor_b32 v232, 6, v231
    v_lshl_add_u32 v202, v232, 5, v230
    v_xor_b32 v232, 7, v231
    v_lshl_add_u32 v203, v232, 5, v230
    v_mul_u32_u24 v230, 2056, v227
    v_lshl_add_u32 v230, v228, 8, v230
    v_lshl_add_u32 v230, v229, 4, v230
    v_add_u32 v230, 65536, v230
    v_xor_b32 v232, 0, v228
    v_lshl_add_u32 v217, v232, 6, v230
    v_xor_b32 v232, 1, v228
    v_lshl_add_u32 v218, v232, 6, v230
    v_xor_b32 v232, 2, v228
    v_lshl_add_u32 v219, v232, 6, v230
    v_xor_b32 v232, 3, v228
    v_lshl_add_u32 v220, v232, 6, v230
    v_lshl_add_u32 v221, v224, 19, v223
    v_lshl_add_u32 v223, v224, 13, v223
    v_add_u32 v222, 65536, v223
    v_cmp_eq_u32 vcc, 0, v229
    v_mov_b32 v230, 0x3f803f80
    s_nop 0
    v_cndmask_b32 v230, 0, v230, vcc
    v_accvgpr_write_b32 a240, v230
    v_accvgpr_write_b32 a244, 0
    v_accvgpr_write_b32 a241, v230
    v_accvgpr_write_b32 a245, 0
    v_accvgpr_write_b32 a242, v230
    v_accvgpr_write_b32 a246, 0
    v_accvgpr_write_b32 a243, v230
    v_accvgpr_write_b32 a247, 0
    s_nop 1
    v_mfma_f32_32x32x16_bf16 v[0:15], a[244:247], a[244:247], 0
    v_mfma_f32_32x32x16_bf16 v[16:31], a[244:247], a[244:247], 0
    v_mfma_f32_32x32x16_bf16 v[32:47], a[244:247], a[244:247], 0
    v_mfma_f32_32x32x16_bf16 v[48:63], a[244:247], a[244:247], 0
    v_mfma_f32_32x32x16_bf16 v[64:79], a[244:247], a[244:247], 0
    v_mfma_f32_32x32x16_bf16 v[80:95], a[244:247], a[244:247], 0
    v_mfma_f32_32x32x16_bf16 v[96:111], a[244:247], a[244:247], 0
    v_mfma_f32_32x32x16_bf16 v[112:127], a[244:247], a[244:247], 0
    v_mfma_f32_32x32x16_bf16 v[128:143], a[244:247], a[244:247], 0
    v_mfma_f32_32x32x16_bf16 v[144:159], a[244:247], a[244:247], 0
    v_mfma_f32_32x32x16_bf16 v[160:175], a[244:247], a[244:247], 0
    v_mfma_f32_32x32x16_bf16 v[176:191], a[244:247], a[244:247], 0
    v_mfma_f32_32x32x16_bf16 a[0:15], a[244:247], a[244:247], 0
    v_mfma_f32_32x32x16_bf16 a[16:31], a[244:247], a[244:247], 0
    v_mfma_f32_32x32x16_bf16 a[32:47], a[244:247], a[244:247], 0
    v_mfma_f32_32x32x16_bf16 a[48:63], a[244:247], a[244:247], 0
    s_add_u32 m0, s60, 106656
    s_nop 0
    buffer_load_dwordx4 v214, s[16:19], s48 offen offset:0 nt lds
    buffer_load_dwordx4 v215, s[16:19], s48 offen offset:1024 nt lds
    s_add_u32 s48, s48, 262144
    s_add_u32 m0, s60, 98432
    s_nop 0
    buffer_load_dwordx4 v214, s[16:19], s47 offen offset:0 nt lds
    buffer_load_dwordx4 v215, s[16:19], s47 offen offset:1024 nt lds
    s_add_u32 s47, s47, 262144
    s_waitcnt vmcnt(7)
    s_barrier
    ds_read_b128 a[208:211], v209 offset:0
    ds_read_b128 a[212:215], v209 offset:2048
    ds_read_b128 a[216:219], v209 offset:4096
    ds_read_b128 a[220:223], v209 offset:6144
    ds_read_b64_tr_b16 a[144:145], v217 offset:57568
    ds_read_b64_tr_b16 a[146:147], v217 offset:58592
    ds_read_b64_tr_b16 a[148:149], v217 offset:57576
    ds_read_b64_tr_b16 a[150:151], v217 offset:58600
    ds_read_b64_tr_b16 a[152:153], v218 offset:57568
    ds_read_b64_tr_b16 a[154:155], v218 offset:58592
    ds_read_b64_tr_b16 a[156:157], v218 offset:57576
    ds_read_b64_tr_b16 a[158:159], v218 offset:58600
    ds_read_b64_tr_b16 a[160:161], v219 offset:57568
    ds_read_b64_tr_b16 a[162:163], v219 offset:58592
    ds_read_b64_tr_b16 a[164:165], v219 offset:57576
    ds_read_b64_tr_b16 a[166:167], v219 offset:58600
    ds_read_b64_tr_b16 a[168:169], v220 offset:57568
    ds_read_b64_tr_b16 a[170:171], v220 offset:58592
    ds_read_b64_tr_b16 a[172:173], v220 offset:57576
    ds_read_b64_tr_b16 a[174:175], v220 offset:58600
    s_mov_b32 s45, 0
    s_mov_b32 s50, 65536
    s_waitcnt lgkmcnt(0)
    v_mfma_f32_16x16x32_bf16 a[0:3], a[144:147], a[208:211], a[0:3]
    s_add_u32 m0, s60, 90208
    ds_read_b64_tr_b16 a[176:177], v217 offset:49344
    v_mfma_f32_16x16x32_bf16 a[32:35], a[144:147], a[212:215], a[32:35]
    ds_read_b64_tr_b16 a[178:179], v217 offset:50368
    buffer_load_dwordx4 v214, s[16:19], s48 offen offset:0 nt lds
    v_mfma_f32_16x16x32_bf16 v[128:131], a[144:147], a[216:219], v[128:131]
    ds_read_b64_tr_b16 a[180:181], v217 offset:49352
    v_mfma_f32_16x16x32_bf16 v[160:163], a[144:147], a[220:223], v[160:163]
    ds_read_b64_tr_b16 a[182:183], v217 offset:50376
    buffer_load_dwordx4 v215, s[16:19], s48 offen offset:1024 nt lds
    v_mfma_f32_16x16x32_bf16 a[4:7], a[148:151], a[208:211], a[4:7]
    s_add_u32 s48, s48, 262144
    s_add_u32 m0, s60, 81984
    ds_read_b64_tr_b16 a[184:185], v218 offset:49344
    v_mfma_f32_16x16x32_bf16 a[36:39], a[148:151], a[212:215], a[36:39]
    ds_read_b64_tr_b16 a[186:187], v218 offset:50368
    buffer_load_dwordx4 v214, s[16:19], s47 offen offset:0 nt lds
    v_mfma_f32_16x16x32_bf16 v[132:135], a[148:151], a[216:219], v[132:135]
    ds_read_b64_tr_b16 a[188:189], v218 offset:49352
    v_mfma_f32_16x16x32_bf16 v[164:167], a[148:151], a[220:223], v[164:167]
    ds_read_b64_tr_b16 a[190:191], v218 offset:50376
    buffer_load_dwordx4 v215, s[16:19], s47 offen offset:1024 nt lds
    v_mfma_f32_16x16x32_bf16 a[8:11], a[152:155], a[208:211], a[8:11]
    s_add_u32 s47, s47, 262144
    s_add_u32 m0, s49, 32768
    ds_read_b64_tr_b16 a[192:193], v219 offset:49344
    v_mfma_f32_16x16x32_bf16 a[40:43], a[152:155], a[212:215], a[40:43]
    ds_read_b64_tr_b16 a[194:195], v219 offset:50368
    buffer_load_dwordx4 v210, s[12:15], s46 offen offset:0 nt lds
    v_mfma_f32_16x16x32_bf16 v[136:139], a[152:155], a[216:219], v[136:139]
    ds_read_b64_tr_b16 a[196:197], v219 offset:49352
    v_mfma_f32_16x16x32_bf16 v[168:171], a[152:155], a[220:223], v[168:171]
    ds_read_b64_tr_b16 a[198:199], v219 offset:50376
    buffer_load_dwordx4 v211, s[12:15], s46 offen offset:1024 nt lds
    v_mfma_f32_16x16x32_bf16 a[12:15], a[156:159], a[208:211], a[12:15]
    ds_read_b64_tr_b16 a[200:201], v220 offset:49344
    v_mfma_f32_16x16x32_bf16 a[44:47], a[156:159], a[212:215], a[44:47]
    ds_read_b64_tr_b16 a[202:203], v220 offset:50368
    buffer_load_dwordx4 v212, s[12:15], s46 offen offset:2048 nt lds
    v_mfma_f32_16x16x32_bf16 v[140:143], a[156:159], a[216:219], v[140:143]
    ds_read_b64_tr_b16 a[204:205], v220 offset:49352
    v_mfma_f32_16x16x32_bf16 v[172:175], a[156:159], a[220:223], v[172:175]
    ds_read_b64_tr_b16 a[206:207], v220 offset:50376
    buffer_load_dwordx4 v213, s[12:15], s46 offen offset:3072 nt lds
    v_mfma_f32_16x16x32_bf16 a[16:19], a[160:163], a[208:211], a[16:19]
    s_add_u32 s46, s46, 32768
    s_add_u32 m0, s49, 36864
    v_mfma_f32_16x16x32_bf16 a[48:51], a[160:163], a[212:215], a[48:51]
    buffer_load_dwordx4 v210, s[12:15], s46 offen offset:0 nt lds
    v_mfma_f32_16x16x32_bf16 v[144:147], a[160:163], a[216:219], v[144:147]
    v_mfma_f32_16x16x32_bf16 v[176:179], a[160:163], a[220:223], v[176:179]
    buffer_load_dwordx4 v211, s[12:15], s46 offen offset:1024 nt lds
    v_mfma_f32_16x16x32_bf16 a[20:23], a[164:167], a[208:211], a[20:23]
    v_mfma_f32_16x16x32_bf16 a[52:55], a[164:167], a[212:215], a[52:55]
    buffer_load_dwordx4 v212, s[12:15], s46 offen offset:2048 nt lds
    v_mfma_f32_16x16x32_bf16 v[148:151], a[164:167], a[216:219], v[148:151]
    v_mfma_f32_16x16x32_bf16 v[180:183], a[164:167], a[220:223], v[180:183]
    buffer_load_dwordx4 v213, s[12:15], s46 offen offset:3072 nt lds
    v_mfma_f32_16x16x32_bf16 a[24:27], a[168:171], a[208:211], a[24:27]
    s_sub_u32 s46, s46, 32640
    s_add_u32 m0, s60, 73760
    v_mfma_f32_16x16x32_bf16 a[56:59], a[168:171], a[212:215], a[56:59]
    buffer_load_dwordx4 v214, s[16:19], s48 offen offset:0 nt lds
    v_mfma_f32_16x16x32_bf16 v[152:155], a[168:171], a[216:219], v[152:155]
    v_mfma_f32_16x16x32_bf16 v[184:187], a[168:171], a[220:223], v[184:187]
    buffer_load_dwordx4 v215, s[16:19], s48 offen offset:1024 nt lds
    v_mfma_f32_16x16x32_bf16 a[28:31], a[172:175], a[208:211], a[28:31]
    s_add_u32 s48, s48, 262144
    s_add_u32 m0, s60, 65536
    v_mfma_f32_16x16x32_bf16 a[60:63], a[172:175], a[212:215], a[60:63]
    buffer_load_dwordx4 v214, s[16:19], s47 offen offset:0 nt lds
    v_mfma_f32_16x16x32_bf16 v[156:159], a[172:175], a[216:219], v[156:159]
    v_mfma_f32_16x16x32_bf16 v[188:191], a[172:175], a[220:223], v[188:191]
    buffer_load_dwordx4 v215, s[16:19], s47 offen offset:1024 nt lds
    s_add_u32 s47, s47, 262144
    s_waitcnt vmcnt(16) lgkmcnt(0)
    s_branch K1_QENTRY
.p2align 6
K1_QLOOP:
    s_waitcnt lgkmcnt(0)
    v_mfma_f32_16x16x32_bf16 a[0:3], a[144:147], a[208:211], a[0:3]
    ds_read_b64_tr_b16 a[176:177], v217 offset:49344
    v_mfma_f32_16x16x32_bf16 a[32:35], a[144:147], a[212:215], a[32:35]
    ds_read_b64_tr_b16 a[178:179], v217 offset:50368
    v_mfma_f32_16x16x32_bf16 v[128:131], a[144:147], a[216:219], v[128:131]
    ds_read_b64_tr_b16 a[180:181], v217 offset:49352
    v_mfma_f32_16x16x32_bf16 v[160:163], a[144:147], a[220:223], v[160:163]
    ds_read_b64_tr_b16 a[182:183], v217 offset:50376
    v_mfma_f32_16x16x32_bf16 a[4:7], a[148:151], a[208:211], a[4:7]
    ds_read_b64_tr_b16 a[184:185], v218 offset:49344
    v_mfma_f32_16x16x32_bf16 a[36:39], a[148:151], a[212:215], a[36:39]
    ds_read_b64_tr_b16 a[186:187], v218 offset:50368
    v_mfma_f32_16x16x32_bf16 v[132:135], a[148:151], a[216:219], v[132:135]
    ds_read_b64_tr_b16 a[188:189], v218 offset:49352
    v_mfma_f32_16x16x32_bf16 v[164:167], a[148:151], a[220:223], v[164:167]
    ds_read_b64_tr_b16 a[190:191], v218 offset:50376
    v_mfma_f32_16x16x32_bf16 a[8:11], a[152:155], a[208:211], a[8:11]
    ds_read_b64_tr_b16 a[192:193], v219 offset:49344
    v_mfma_f32_16x16x32_bf16 a[40:43], a[152:155], a[212:215], a[40:43]
    ds_read_b64_tr_b16 a[194:195], v219 offset:50368
    v_mfma_f32_16x16x32_bf16 v[136:139], a[152:155], a[216:219], v[136:139]
    ds_read_b64_tr_b16 a[196:197], v219 offset:49352
    v_mfma_f32_16x16x32_bf16 v[168:171], a[152:155], a[220:223], v[168:171]
    ds_read_b64_tr_b16 a[198:199], v219 offset:50376
    v_mfma_f32_16x16x32_bf16 a[12:15], a[156:159], a[208:211], a[12:15]
    ds_read_b64_tr_b16 a[200:201], v220 offset:49344
    v_mfma_f32_16x16x32_bf16 a[44:47], a[156:159], a[212:215], a[44:47]
    ds_read_b64_tr_b16 a[202:203], v220 offset:50368
    v_mfma_f32_16x16x32_bf16 v[140:143], a[156:159], a[216:219], v[140:143]
    ds_read_b64_tr_b16 a[204:205], v220 offset:49352
    v_mfma_f32_16x16x32_bf16 v[172:175], a[156:159], a[220:223], v[172:175]
    ds_read_b64_tr_b16 a[206:207], v220 offset:50376
    v_mfma_f32_16x16x32_bf16 a[16:19], a[160:163], a[208:211], a[16:19]
    v_mfma_f32_16x16x32_bf16 a[48:51], a[160:163], a[212:215], a[48:51]
    v_mfma_f32_16x16x32_bf16 v[144:147], a[160:163], a[216:219], v[144:147]
    v_mfma_f32_16x16x32_bf16 v[176:179], a[160:163], a[220:223], v[176:179]
    v_mfma_f32_16x16x32_bf16 a[20:23], a[164:167], a[208:211], a[20:23]
    v_mfma_f32_16x16x32_bf16 a[52:55], a[164:167], a[212:215], a[52:55]
    v_mfma_f32_16x16x32_bf16 v[148:151], a[164:167], a[216:219], v[148:151]
    v_mfma_f32_16x16x32_bf16 v[180:183], a[164:167], a[220:223], v[180:183]
    v_mfma_f32_16x16x32_bf16 a[24:27], a[168:171], a[208:211], a[24:27]
    v_mfma_f32_16x16x32_bf16 a[56:59], a[168:171], a[212:215], a[56:59]
    v_mfma_f32_16x16x32_bf16 v[152:155], a[168:171], a[216:219], v[152:155]
    v_mfma_f32_16x16x32_bf16 v[184:187], a[168:171], a[220:223], v[184:187]
    v_mfma_f32_16x16x32_bf16 a[28:31], a[172:175], a[208:211], a[28:31]
    v_mfma_f32_16x16x32_bf16 a[60:63], a[172:175], a[212:215], a[60:63]
    v_mfma_f32_16x16x32_bf16 v[156:159], a[172:175], a[216:219], v[156:159]
    v_mfma_f32_16x16x32_bf16 v[188:191], a[172:175], a[220:223], v[188:191]
    s_waitcnt vmcnt(16) lgkmcnt(0)
K1_QENTRY:
    s_barrier
    v_mfma_f32_16x16x32_bf16 v[0:3], a[176:179], a[208:211], v[0:3]
    s_add_u32 m0, s60, 123104
    ds_read_b128 a[224:227], v216 offset:0
    v_mfma_f32_16x16x32_bf16 v[32:35], a[176:179], a[212:215], v[32:35]
    ds_read_b128 a[228:231], v216 offset:2048
    v_mfma_f32_16x16x32_bf16 v[64:67], a[176:179], a[216:219], v[64:67]
    ds_read_b128 a[232:235], v216 offset:4096
    buffer_load_dwordx4 v214, s[16:19], s48 offen offset:0 nt lds
    v_mfma_f32_16x16x32_bf16 v[96:99], a[176:179], a[220:223], v[96:99]
    ds_read_b128 a[236:239], v216 offset:6144
    v_mfma_f32_16x16x32_bf16 v[4:7], a[180:183], a[208:211], v[4:7]
    ds_read_b64_tr_b16 a[144:145], v217 offset:41120
    v_mfma_f32_16x16x32_bf16 v[36:39], a[180:183], a[212:215], v[36:39]
    ds_read_b64_tr_b16 a[146:147], v217 offset:42144
    v_mfma_f32_16x16x32_bf16 v[68:71], a[180:183], a[216:219], v[68:71]
    ds_read_b64_tr_b16 a[148:149], v217 offset:41128
    v_mfma_f32_16x16x32_bf16 v[100:103], a[180:183], a[220:223], v[100:103]
    ds_read_b64_tr_b16 a[150:151], v217 offset:42152
    v_mfma_f32_16x16x32_bf16 v[8:11], a[184:187], a[208:211], v[8:11]
    ds_read_b64_tr_b16 a[152:153], v218 offset:41120
    v_mfma_f32_16x16x32_bf16 v[40:43], a[184:187], a[212:215], v[40:43]
    ds_read_b64_tr_b16 a[154:155], v218 offset:42144
    buffer_load_dwordx4 v215, s[16:19], s48 offen offset:1024 nt lds
    v_mfma_f32_16x16x32_bf16 v[72:75], a[184:187], a[216:219], v[72:75]
    s_add_u32 s48, s48, 262144
    ds_read_b64_tr_b16 a[156:157], v218 offset:41128
    v_mfma_f32_16x16x32_bf16 v[104:107], a[184:187], a[220:223], v[104:107]
    s_add_u32 m0, s60, 114880
    ds_read_b64_tr_b16 a[158:159], v218 offset:42152
    v_mfma_f32_16x16x32_bf16 v[12:15], a[188:191], a[208:211], v[12:15]
    ds_read_b64_tr_b16 a[160:161], v219 offset:41120
    v_mfma_f32_16x16x32_bf16 v[44:47], a[188:191], a[212:215], v[44:47]
    ds_read_b64_tr_b16 a[162:163], v219 offset:42144
    v_mfma_f32_16x16x32_bf16 v[76:79], a[188:191], a[216:219], v[76:79]
    ds_read_b64_tr_b16 a[164:165], v219 offset:41128
    v_mfma_f32_16x16x32_bf16 v[108:111], a[188:191], a[220:223], v[108:111]
    ds_read_b64_tr_b16 a[166:167], v219 offset:42152
    v_mfma_f32_16x16x32_bf16 v[16:19], a[192:195], a[208:211], v[16:19]
    ds_read_b64_tr_b16 a[168:169], v220 offset:41120
    buffer_load_dwordx4 v214, s[16:19], s47 offen offset:0 nt lds
    v_mfma_f32_16x16x32_bf16 v[48:51], a[192:195], a[212:215], v[48:51]
    ds_read_b64_tr_b16 a[170:171], v220 offset:42144
    v_mfma_f32_16x16x32_bf16 v[80:83], a[192:195], a[216:219], v[80:83]
    ds_read_b64_tr_b16 a[172:173], v220 offset:41128
    v_mfma_f32_16x16x32_bf16 v[112:115], a[192:195], a[220:223], v[112:115]
    ds_read_b64_tr_b16 a[174:175], v220 offset:42152
    v_mfma_f32_16x16x32_bf16 v[20:23], a[196:199], a[208:211], v[20:23]
    v_mfma_f32_16x16x32_bf16 v[52:55], a[196:199], a[212:215], v[52:55]
    v_mfma_f32_16x16x32_bf16 v[84:87], a[196:199], a[216:219], v[84:87]
    v_mfma_f32_16x16x32_bf16 v[116:119], a[196:199], a[220:223], v[116:119]
    buffer_load_dwordx4 v215, s[16:19], s47 offen offset:1024 nt lds
    v_mfma_f32_16x16x32_bf16 v[24:27], a[200:203], a[208:211], v[24:27]
    s_add_u32 s47, s47, 262144
    v_mfma_f32_16x16x32_bf16 v[56:59], a[200:203], a[212:215], v[56:59]
    v_mfma_f32_16x16x32_bf16 v[88:91], a[200:203], a[216:219], v[88:91]
    v_mfma_f32_16x16x32_bf16 v[120:123], a[200:203], a[220:223], v[120:123]
    v_mfma_f32_16x16x32_bf16 v[28:31], a[204:207], a[208:211], v[28:31]
    v_mfma_f32_16x16x32_bf16 v[60:63], a[204:207], a[212:215], v[60:63]
    v_mfma_f32_16x16x32_bf16 v[92:95], a[204:207], a[216:219], v[92:95]
    v_mfma_f32_16x16x32_bf16 v[124:127], a[204:207], a[220:223], v[124:127]
    s_waitcnt lgkmcnt(0)
    v_mfma_f32_16x16x32_bf16 a[0:3], a[144:147], a[224:227], a[0:3]
    s_add_u32 m0, s49, 0
    ds_read_b64_tr_b16 a[176:177], v217 offset:32896
    v_mfma_f32_16x16x32_bf16 a[32:35], a[144:147], a[228:231], a[32:35]
    ds_read_b64_tr_b16 a[178:179], v217 offset:33920
    v_mfma_f32_16x16x32_bf16 v[128:131], a[144:147], a[232:235], v[128:131]
    ds_read_b64_tr_b16 a[180:181], v217 offset:32904
    buffer_load_dwordx4 v210, s[12:15], s46 offen offset:0 nt lds
    v_mfma_f32_16x16x32_bf16 v[160:163], a[144:147], a[236:239], v[160:163]
    ds_read_b64_tr_b16 a[182:183], v217 offset:33928
    v_mfma_f32_16x16x32_bf16 a[4:7], a[148:151], a[224:227], a[4:7]
    ds_read_b64_tr_b16 a[184:185], v218 offset:32896
    v_mfma_f32_16x16x32_bf16 a[36:39], a[148:151], a[228:231], a[36:39]
    ds_read_b64_tr_b16 a[186:187], v218 offset:33920
    v_mfma_f32_16x16x32_bf16 v[132:135], a[148:151], a[232:235], v[132:135]
    ds_read_b64_tr_b16 a[188:189], v218 offset:32904
    buffer_load_dwordx4 v211, s[12:15], s46 offen offset:1024 nt lds
    v_mfma_f32_16x16x32_bf16 v[164:167], a[148:151], a[236:239], v[164:167]
    ds_read_b64_tr_b16 a[190:191], v218 offset:33928
    v_mfma_f32_16x16x32_bf16 a[8:11], a[152:155], a[224:227], a[8:11]
    ds_read_b64_tr_b16 a[192:193], v219 offset:32896
    v_mfma_f32_16x16x32_bf16 a[40:43], a[152:155], a[228:231], a[40:43]
    ds_read_b64_tr_b16 a[194:195], v219 offset:33920
    v_mfma_f32_16x16x32_bf16 v[136:139], a[152:155], a[232:235], v[136:139]
    ds_read_b64_tr_b16 a[196:197], v219 offset:32904
    buffer_load_dwordx4 v212, s[12:15], s46 offen offset:2048 nt lds
    v_mfma_f32_16x16x32_bf16 v[168:171], a[152:155], a[236:239], v[168:171]
    ds_read_b64_tr_b16 a[198:199], v219 offset:33928
    v_mfma_f32_16x16x32_bf16 a[12:15], a[156:159], a[224:227], a[12:15]
    ds_read_b64_tr_b16 a[200:201], v220 offset:32896
    v_mfma_f32_16x16x32_bf16 a[44:47], a[156:159], a[228:231], a[44:47]
    ds_read_b64_tr_b16 a[202:203], v220 offset:33920
    v_mfma_f32_16x16x32_bf16 v[140:143], a[156:159], a[232:235], v[140:143]
    ds_read_b64_tr_b16 a[204:205], v220 offset:32904
    buffer_load_dwordx4 v213, s[12:15], s46 offen offset:3072 nt lds
    v_mfma_f32_16x16x32_bf16 v[172:175], a[156:159], a[236:239], v[172:175]
    s_add_u32 s46, s46, 32768
    ds_read_b64_tr_b16 a[206:207], v220 offset:33928
    v_mfma_f32_16x16x32_bf16 a[16:19], a[160:163], a[224:227], a[16:19]
    s_add_u32 m0, s49, 4096
    v_mfma_f32_16x16x32_bf16 a[48:51], a[160:163], a[228:231], a[48:51]
    v_mfma_f32_16x16x32_bf16 v[144:147], a[160:163], a[232:235], v[144:147]
    buffer_load_dwordx4 v210, s[12:15], s46 offen offset:0 nt lds
    v_mfma_f32_16x16x32_bf16 v[176:179], a[160:163], a[236:239], v[176:179]
    v_mfma_f32_16x16x32_bf16 a[20:23], a[164:167], a[224:227], a[20:23]
    v_mfma_f32_16x16x32_bf16 a[52:55], a[164:167], a[228:231], a[52:55]
    v_mfma_f32_16x16x32_bf16 v[148:151], a[164:167], a[232:235], v[148:151]
    buffer_load_dwordx4 v211, s[12:15], s46 offen offset:1024 nt lds
    v_mfma_f32_16x16x32_bf16 v[180:183], a[164:167], a[236:239], v[180:183]
    v_mfma_f32_16x16x32_bf16 a[24:27], a[168:171], a[224:227], a[24:27]
    v_mfma_f32_16x16x32_bf16 a[56:59], a[168:171], a[228:231], a[56:59]
    v_mfma_f32_16x16x32_bf16 v[152:155], a[168:171], a[232:235], v[152:155]
    buffer_load_dwordx4 v212, s[12:15], s46 offen offset:2048 nt lds
    v_mfma_f32_16x16x32_bf16 v[184:187], a[168:171], a[236:239], v[184:187]
    v_mfma_f32_16x16x32_bf16 a[28:31], a[172:175], a[224:227], a[28:31]
    v_mfma_f32_16x16x32_bf16 a[60:63], a[172:175], a[228:231], a[60:63]
    v_mfma_f32_16x16x32_bf16 v[156:159], a[172:175], a[232:235], v[156:159]
    buffer_load_dwordx4 v213, s[12:15], s46 offen offset:3072 nt lds
    v_mfma_f32_16x16x32_bf16 v[188:191], a[172:175], a[236:239], v[188:191]
    s_sub_u32 s46, s46, 32640
    s_waitcnt vmcnt(16) lgkmcnt(0)
    s_barrier
    v_mfma_f32_16x16x32_bf16 v[0:3], a[176:179], a[224:227], v[0:3]
    s_add_u32 m0, s60, 106656
    ds_read_b128 a[208:211], v209 offset:32768
    v_mfma_f32_16x16x32_bf16 v[32:35], a[176:179], a[228:231], v[32:35]
    ds_read_b128 a[212:215], v209 offset:34816
    v_mfma_f32_16x16x32_bf16 v[64:67], a[176:179], a[232:235], v[64:67]
    ds_read_b128 a[216:219], v209 offset:36864
    buffer_load_dwordx4 v214, s[16:19], s48 offen offset:0 nt lds
    v_mfma_f32_16x16x32_bf16 v[96:99], a[176:179], a[236:239], v[96:99]
    ds_read_b128 a[220:223], v209 offset:38912
    v_mfma_f32_16x16x32_bf16 v[4:7], a[180:183], a[224:227], v[4:7]
    ds_read_b64_tr_b16 a[144:145], v217 offset:24672
    v_mfma_f32_16x16x32_bf16 v[36:39], a[180:183], a[228:231], v[36:39]
    ds_read_b64_tr_b16 a[146:147], v217 offset:25696
    v_mfma_f32_16x16x32_bf16 v[68:71], a[180:183], a[232:235], v[68:71]
    ds_read_b64_tr_b16 a[148:149], v217 offset:24680
    v_mfma_f32_16x16x32_bf16 v[100:103], a[180:183], a[236:239], v[100:103]
    ds_read_b64_tr_b16 a[150:151], v217 offset:25704
    v_mfma_f32_16x16x32_bf16 v[8:11], a[184:187], a[224:227], v[8:11]
    ds_read_b64_tr_b16 a[152:153], v218 offset:24672
    v_mfma_f32_16x16x32_bf16 v[40:43], a[184:187], a[228:231], v[40:43]
    ds_read_b64_tr_b16 a[154:155], v218 offset:25696
    buffer_load_dwordx4 v215, s[16:19], s48 offen offset:1024 nt lds
    v_mfma_f32_16x16x32_bf16 v[72:75], a[184:187], a[232:235], v[72:75]
    s_add_u32 s48, s48, 262144
    ds_read_b64_tr_b16 a[156:157], v218 offset:24680
    v_mfma_f32_16x16x32_bf16 v[104:107], a[184:187], a[236:239], v[104:107]
    s_add_u32 m0, s60, 98432
    ds_read_b64_tr_b16 a[158:159], v218 offset:25704
    v_mfma_f32_16x16x32_bf16 v[12:15], a[188:191], a[224:227], v[12:15]
    ds_read_b64_tr_b16 a[160:161], v219 offset:24672
    v_mfma_f32_16x16x32_bf16 v[44:47], a[188:191], a[228:231], v[44:47]
    ds_read_b64_tr_b16 a[162:163], v219 offset:25696
    v_mfma_f32_16x16x32_bf16 v[76:79], a[188:191], a[232:235], v[76:79]
    ds_read_b64_tr_b16 a[164:165], v219 offset:24680
    v_mfma_f32_16x16x32_bf16 v[108:111], a[188:191], a[236:239], v[108:111]
    ds_read_b64_tr_b16 a[166:167], v219 offset:25704
    v_mfma_f32_16x16x32_bf16 v[16:19], a[192:195], a[224:227], v[16:19]
    ds_read_b64_tr_b16 a[168:169], v220 offset:24672
    buffer_load_dwordx4 v214, s[16:19], s47 offen offset:0 nt lds
    v_mfma_f32_16x16x32_bf16 v[48:51], a[192:195], a[228:231], v[48:51]
    ds_read_b64_tr_b16 a[170:171], v220 offset:25696
    v_mfma_f32_16x16x32_bf16 v[80:83], a[192:195], a[232:235], v[80:83]
    ds_read_b64_tr_b16 a[172:173], v220 offset:24680
    v_mfma_f32_16x16x32_bf16 v[112:115], a[192:195], a[236:239], v[112:115]
    ds_read_b64_tr_b16 a[174:175], v220 offset:25704
    v_mfma_f32_16x16x32_bf16 v[20:23], a[196:199], a[224:227], v[20:23]
    v_mfma_f32_16x16x32_bf16 v[52:55], a[196:199], a[228:231], v[52:55]
    v_mfma_f32_16x16x32_bf16 v[84:87], a[196:199], a[232:235], v[84:87]
    v_mfma_f32_16x16x32_bf16 v[116:119], a[196:199], a[236:239], v[116:119]
    buffer_load_dwordx4 v215, s[16:19], s47 offen offset:1024 nt lds
    v_mfma_f32_16x16x32_bf16 v[24:27], a[200:203], a[224:227], v[24:27]
    s_add_u32 s47, s47, 262144
    v_mfma_f32_16x16x32_bf16 v[56:59], a[200:203], a[228:231], v[56:59]
    v_mfma_f32_16x16x32_bf16 v[88:91], a[200:203], a[232:235], v[88:91]
    v_mfma_f32_16x16x32_bf16 v[120:123], a[200:203], a[236:239], v[120:123]
    v_mfma_f32_16x16x32_bf16 v[28:31], a[204:207], a[224:227], v[28:31]
    v_mfma_f32_16x16x32_bf16 v[60:63], a[204:207], a[228:231], v[60:63]
    v_mfma_f32_16x16x32_bf16 v[92:95], a[204:207], a[232:235], v[92:95]
    v_mfma_f32_16x16x32_bf16 v[124:127], a[204:207], a[236:239], v[124:127]
    s_waitcnt lgkmcnt(0)
    v_mfma_f32_16x16x32_bf16 a[0:3], a[144:147], a[208:211], a[0:3]
    ds_read_b64_tr_b16 a[176:177], v217 offset:16448
    v_mfma_f32_16x16x32_bf16 a[32:35], a[144:147], a[212:215], a[32:35]
    ds_read_b64_tr_b16 a[178:179], v217 offset:17472
    v_mfma_f32_16x16x32_bf16 v[128:131], a[144:147], a[216:219], v[128:131]
    ds_read_b64_tr_b16 a[180:181], v217 offset:16456
    v_mfma_f32_16x16x32_bf16 v[160:163], a[144:147], a[220:223], v[160:163]
    ds_read_b64_tr_b16 a[182:183], v217 offset:17480
    v_mfma_f32_16x16x32_bf16 a[4:7], a[148:151], a[208:211], a[4:7]
    ds_read_b64_tr_b16 a[184:185], v218 offset:16448
    v_mfma_f32_16x16x32_bf16 a[36:39], a[148:151], a[212:215], a[36:39]
    ds_read_b64_tr_b16 a[186:187], v218 offset:17472
    v_mfma_f32_16x16x32_bf16 v[132:135], a[148:151], a[216:219], v[132:135]
    ds_read_b64_tr_b16 a[188:189], v218 offset:16456
    v_mfma_f32_16x16x32_bf16 v[164:167], a[148:151], a[220:223], v[164:167]
    ds_read_b64_tr_b16 a[190:191], v218 offset:17480
    v_mfma_f32_16x16x32_bf16 a[8:11], a[152:155], a[208:211], a[8:11]
    ds_read_b64_tr_b16 a[192:193], v219 offset:16448
    v_mfma_f32_16x16x32_bf16 a[40:43], a[152:155], a[212:215], a[40:43]
    ds_read_b64_tr_b16 a[194:195], v219 offset:17472
    v_mfma_f32_16x16x32_bf16 v[136:139], a[152:155], a[216:219], v[136:139]
    ds_read_b64_tr_b16 a[196:197], v219 offset:16456
    v_mfma_f32_16x16x32_bf16 v[168:171], a[152:155], a[220:223], v[168:171]
    ds_read_b64_tr_b16 a[198:199], v219 offset:17480
    v_mfma_f32_16x16x32_bf16 a[12:15], a[156:159], a[208:211], a[12:15]
    ds_read_b64_tr_b16 a[200:201], v220 offset:16448
    v_mfma_f32_16x16x32_bf16 a[44:47], a[156:159], a[212:215], a[44:47]
    ds_read_b64_tr_b16 a[202:203], v220 offset:17472
    v_mfma_f32_16x16x32_bf16 v[140:143], a[156:159], a[216:219], v[140:143]
    ds_read_b64_tr_b16 a[204:205], v220 offset:16456
    v_mfma_f32_16x16x32_bf16 v[172:175], a[156:159], a[220:223], v[172:175]
    ds_read_b64_tr_b16 a[206:207], v220 offset:17480
    v_mfma_f32_16x16x32_bf16 a[16:19], a[160:163], a[208:211], a[16:19]
    v_mfma_f32_16x16x32_bf16 a[48:51], a[160:163], a[212:215], a[48:51]
    v_mfma_f32_16x16x32_bf16 v[144:147], a[160:163], a[216:219], v[144:147]
    v_mfma_f32_16x16x32_bf16 v[176:179], a[160:163], a[220:223], v[176:179]
    v_mfma_f32_16x16x32_bf16 a[20:23], a[164:167], a[208:211], a[20:23]
    v_mfma_f32_16x16x32_bf16 a[52:55], a[164:167], a[212:215], a[52:55]
    v_mfma_f32_16x16x32_bf16 v[148:151], a[164:167], a[216:219], v[148:151]
    v_mfma_f32_16x16x32_bf16 v[180:183], a[164:167], a[220:223], v[180:183]
    v_mfma_f32_16x16x32_bf16 a[24:27], a[168:171], a[208:211], a[24:27]
    v_mfma_f32_16x16x32_bf16 a[56:59], a[168:171], a[212:215], a[56:59]
    v_mfma_f32_16x16x32_bf16 v[152:155], a[168:171], a[216:219], v[152:155]
    v_mfma_f32_16x16x32_bf16 v[184:187], a[168:171], a[220:223], v[184:187]
    v_mfma_f32_16x16x32_bf16 a[28:31], a[172:175], a[208:211], a[28:31]
    v_mfma_f32_16x16x32_bf16 a[60:63], a[172:175], a[212:215], a[60:63]
    v_mfma_f32_16x16x32_bf16 v[156:159], a[172:175], a[216:219], v[156:159]
    v_mfma_f32_16x16x32_bf16 v[188:191], a[172:175], a[220:223], v[188:191]
    s_waitcnt vmcnt(16) lgkmcnt(0)
    s_barrier
    v_mfma_f32_16x16x32_bf16 v[0:3], a[176:179], a[208:211], v[0:3]
    s_add_u32 m0, s60, 90208
    ds_read_b128 a[224:227], v216 offset:32768
    v_mfma_f32_16x16x32_bf16 v[32:35], a[176:179], a[212:215], v[32:35]
    ds_read_b128 a[228:231], v216 offset:34816
    v_mfma_f32_16x16x32_bf16 v[64:67], a[176:179], a[216:219], v[64:67]
    ds_read_b128 a[232:235], v216 offset:36864
    buffer_load_dwordx4 v214, s[16:19], s48 offen offset:0 nt lds
    v_mfma_f32_16x16x32_bf16 v[96:99], a[176:179], a[220:223], v[96:99]
    ds_read_b128 a[236:239], v216 offset:38912
    v_mfma_f32_16x16x32_bf16 v[4:7], a[180:183], a[208:211], v[4:7]
    ds_read_b64_tr_b16 a[144:145], v217 offset:8224
    v_mfma_f32_16x16x32_bf16 v[36:39], a[180:183], a[212:215], v[36:39]
    ds_read_b64_tr_b16 a[146:147], v217 offset:9248
    v_mfma_f32_16x16x32_bf16 v[68:71], a[180:183], a[216:219], v[68:71]
    ds_read_b64_tr_b16 a[148:149], v217 offset:8232
    v_mfma_f32_16x16x32_bf16 v[100:103], a[180:183], a[220:223], v[100:103]
    ds_read_b64_tr_b16 a[150:151], v217 offset:9256
    v_mfma_f32_16x16x32_bf16 v[8:11], a[184:187], a[208:211], v[8:11]
    ds_read_b64_tr_b16 a[152:153], v218 offset:8224
    v_mfma_f32_16x16x32_bf16 v[40:43], a[184:187], a[212:215], v[40:43]
    ds_read_b64_tr_b16 a[154:155], v218 offset:9248
    buffer_load_dwordx4 v215, s[16:19], s48 offen offset:1024 nt lds
    v_mfma_f32_16x16x32_bf16 v[72:75], a[184:187], a[216:219], v[72:75]
    s_add_u32 s48, s48, 262144
    ds_read_b64_tr_b16 a[156:157], v218 offset:8232
    v_mfma_f32_16x16x32_bf16 v[104:107], a[184:187], a[220:223], v[104:107]
    s_add_u32 m0, s60, 81984
    ds_read_b64_tr_b16 a[158:159], v218 offset:9256
    v_mfma_f32_16x16x32_bf16 v[12:15], a[188:191], a[208:211], v[12:15]
    ds_read_b64_tr_b16 a[160:161], v219 offset:8224
    v_mfma_f32_16x16x32_bf16 v[44:47], a[188:191], a[212:215], v[44:47]
    ds_read_b64_tr_b16 a[162:163], v219 offset:9248
    v_mfma_f32_16x16x32_bf16 v[76:79], a[188:191], a[216:219], v[76:79]
    ds_read_b64_tr_b16 a[164:165], v219 offset:8232
    v_mfma_f32_16x16x32_bf16 v[108:111], a[188:191], a[220:223], v[108:111]
    ds_read_b64_tr_b16 a[166:167], v219 offset:9256
    v_mfma_f32_16x16x32_bf16 v[16:19], a[192:195], a[208:211], v[16:19]
    ds_read_b64_tr_b16 a[168:169], v220 offset:8224
    buffer_load_dwordx4 v214, s[16:19], s47 offen offset:0 nt lds
    v_mfma_f32_16x16x32_bf16 v[48:51], a[192:195], a[212:215], v[48:51]
    ds_read_b64_tr_b16 a[170:171], v220 offset:9248
    v_mfma_f32_16x16x32_bf16 v[80:83], a[192:195], a[216:219], v[80:83]
    ds_read_b64_tr_b16 a[172:173], v220 offset:8232
    v_mfma_f32_16x16x32_bf16 v[112:115], a[192:195], a[220:223], v[112:115]
    ds_read_b64_tr_b16 a[174:175], v220 offset:9256
    v_mfma_f32_16x16x32_bf16 v[20:23], a[196:199], a[208:211], v[20:23]
    v_mfma_f32_16x16x32_bf16 v[52:55], a[196:199], a[212:215], v[52:55]
    v_mfma_f32_16x16x32_bf16 v[84:87], a[196:199], a[216:219], v[84:87]
    v_mfma_f32_16x16x32_bf16 v[116:119], a[196:199], a[220:223], v[116:119]
    buffer_load_dwordx4 v215, s[16:19], s47 offen offset:1024 nt lds
    v_mfma_f32_16x16x32_bf16 v[24:27], a[200:203], a[208:211], v[24:27]
    s_add_u32 s47, s47, 262144
    v_mfma_f32_16x16x32_bf16 v[56:59], a[200:203], a[212:215], v[56:59]
    v_mfma_f32_16x16x32_bf16 v[88:91], a[200:203], a[216:219], v[88:91]
    v_mfma_f32_16x16x32_bf16 v[120:123], a[200:203], a[220:223], v[120:123]
    v_mfma_f32_16x16x32_bf16 v[28:31], a[204:207], a[208:211], v[28:31]
    v_mfma_f32_16x16x32_bf16 v[60:63], a[204:207], a[212:215], v[60:63]
    v_mfma_f32_16x16x32_bf16 v[92:95], a[204:207], a[216:219], v[92:95]
    v_mfma_f32_16x16x32_bf16 v[124:127], a[204:207], a[220:223], v[124:127]
    s_waitcnt lgkmcnt(0)
    v_mfma_f32_16x16x32_bf16 a[0:3], a[144:147], a[224:227], a[0:3]
    s_add_u32 m0, s49, 32768
    ds_read_b64_tr_b16 a[176:177], v217 offset:0
    v_mfma_f32_16x16x32_bf16 a[32:35], a[144:147], a[228:231], a[32:35]
    ds_read_b64_tr_b16 a[178:179], v217 offset:1024
    v_mfma_f32_16x16x32_bf16 v[128:131], a[144:147], a[232:235], v[128:131]
    ds_read_b64_tr_b16 a[180:181], v217 offset:8
    buffer_load_dwordx4 v210, s[12:15], s46 offen offset:0 nt lds
    v_mfma_f32_16x16x32_bf16 v[160:163], a[144:147], a[236:239], v[160:163]
    ds_read_b64_tr_b16 a[182:183], v217 offset:1032
    v_mfma_f32_16x16x32_bf16 a[4:7], a[148:151], a[224:227], a[4:7]
    ds_read_b64_tr_b16 a[184:185], v218 offset:0
    v_mfma_f32_16x16x32_bf16 a[36:39], a[148:151], a[228:231], a[36:39]
    ds_read_b64_tr_b16 a[186:187], v218 offset:1024
    v_mfma_f32_16x16x32_bf16 v[132:135], a[148:151], a[232:235], v[132:135]
    ds_read_b64_tr_b16 a[188:189], v218 offset:8
    buffer_load_dwordx4 v211, s[12:15], s46 offen offset:1024 nt lds
    v_mfma_f32_16x16x32_bf16 v[164:167], a[148:151], a[236:239], v[164:167]
    ds_read_b64_tr_b16 a[190:191], v218 offset:1032
    v_mfma_f32_16x16x32_bf16 a[8:11], a[152:155], a[224:227], a[8:11]
    ds_read_b64_tr_b16 a[192:193], v219 offset:0
    v_mfma_f32_16x16x32_bf16 a[40:43], a[152:155], a[228:231], a[40:43]
    ds_read_b64_tr_b16 a[194:195], v219 offset:1024
    v_mfma_f32_16x16x32_bf16 v[136:139], a[152:155], a[232:235], v[136:139]
    ds_read_b64_tr_b16 a[196:197], v219 offset:8
    buffer_load_dwordx4 v212, s[12:15], s46 offen offset:2048 nt lds
    v_mfma_f32_16x16x32_bf16 v[168:171], a[152:155], a[236:239], v[168:171]
    ds_read_b64_tr_b16 a[198:199], v219 offset:1032
    v_mfma_f32_16x16x32_bf16 a[12:15], a[156:159], a[224:227], a[12:15]
    ds_read_b64_tr_b16 a[200:201], v220 offset:0
    v_mfma_f32_16x16x32_bf16 a[44:47], a[156:159], a[228:231], a[44:47]
    ds_read_b64_tr_b16 a[202:203], v220 offset:1024
    v_mfma_f32_16x16x32_bf16 v[140:143], a[156:159], a[232:235], v[140:143]
    ds_read_b64_tr_b16 a[204:205], v220 offset:8
    buffer_load_dwordx4 v213, s[12:15], s46 offen offset:3072 nt lds
    v_mfma_f32_16x16x32_bf16 v[172:175], a[156:159], a[236:239], v[172:175]
    s_add_u32 s46, s46, 32768
    ds_read_b64_tr_b16 a[206:207], v220 offset:1032
    v_mfma_f32_16x16x32_bf16 a[16:19], a[160:163], a[224:227], a[16:19]
    s_add_u32 m0, s49, 36864
    v_mfma_f32_16x16x32_bf16 a[48:51], a[160:163], a[228:231], a[48:51]
    v_mfma_f32_16x16x32_bf16 v[144:147], a[160:163], a[232:235], v[144:147]
    buffer_load_dwordx4 v210, s[12:15], s46 offen offset:0 nt lds
    v_mfma_f32_16x16x32_bf16 v[176:179], a[160:163], a[236:239], v[176:179]
    v_mfma_f32_16x16x32_bf16 a[20:23], a[164:167], a[224:227], a[20:23]
    v_mfma_f32_16x16x32_bf16 a[52:55], a[164:167], a[228:231], a[52:55]
    v_mfma_f32_16x16x32_bf16 v[148:151], a[164:167], a[232:235], v[148:151]
    buffer_load_dwordx4 v211, s[12:15], s46 offen offset:1024 nt lds
    v_mfma_f32_16x16x32_bf16 v[180:183], a[164:167], a[236:239], v[180:183]
    v_mfma_f32_16x16x32_bf16 a[24:27], a[168:171], a[224:227], a[24:27]
    v_mfma_f32_16x16x32_bf16 a[56:59], a[168:171], a[228:231], a[56:59]
    v_mfma_f32_16x16x32_bf16 v[152:155], a[168:171], a[232:235], v[152:155]
    buffer_load_dwordx4 v212, s[12:15], s46 offen offset:2048 nt lds
    v_mfma_f32_16x16x32_bf16 v[184:187], a[168:171], a[236:239], v[184:187]
    v_mfma_f32_16x16x32_bf16 a[28:31], a[172:175], a[224:227], a[28:31]
    v_mfma_f32_16x16x32_bf16 a[60:63], a[172:175], a[228:231], a[60:63]
    v_mfma_f32_16x16x32_bf16 v[156:159], a[172:175], a[232:235], v[156:159]
    buffer_load_dwordx4 v213, s[12:15], s46 offen offset:3072 nt lds
    v_mfma_f32_16x16x32_bf16 v[188:191], a[172:175], a[236:239], v[188:191]
    s_sub_u32 s46, s46, 32640
    s_waitcnt vmcnt(16) lgkmcnt(0)
    s_barrier
    v_mfma_f32_16x16x32_bf16 v[0:3], a[176:179], a[224:227], v[0:3]
    s_add_u32 m0, s60, 73760
    ds_read_b128 a[208:211], v209 offset:0
    v_mfma_f32_16x16x32_bf16 v[32:35], a[176:179], a[228:231], v[32:35]
    ds_read_b128 a[212:215], v209 offset:2048
    v_mfma_f32_16x16x32_bf16 v[64:67], a[176:179], a[232:235], v[64:67]
    ds_read_b128 a[216:219], v209 offset:4096
    buffer_load_dwordx4 v214, s[16:19], s48 offen offset:0 nt lds
    v_mfma_f32_16x16x32_bf16 v[96:99], a[176:179], a[236:239], v[96:99]
    ds_read_b128 a[220:223], v209 offset:6144
    v_mfma_f32_16x16x32_bf16 v[4:7], a[180:183], a[224:227], v[4:7]
    ds_read_b64_tr_b16 a[144:145], v217 offset:57568
    v_mfma_f32_16x16x32_bf16 v[36:39], a[180:183], a[228:231], v[36:39]
    ds_read_b64_tr_b16 a[146:147], v217 offset:58592
    v_mfma_f32_16x16x32_bf16 v[68:71], a[180:183], a[232:235], v[68:71]
    ds_read_b64_tr_b16 a[148:149], v217 offset:57576
    v_mfma_f32_16x16x32_bf16 v[100:103], a[180:183], a[236:239], v[100:103]
    ds_read_b64_tr_b16 a[150:151], v217 offset:58600
    v_mfma_f32_16x16x32_bf16 v[8:11], a[184:187], a[224:227], v[8:11]
    ds_read_b64_tr_b16 a[152:153], v218 offset:57568
    v_mfma_f32_16x16x32_bf16 v[40:43], a[184:187], a[228:231], v[40:43]
    ds_read_b64_tr_b16 a[154:155], v218 offset:58592
    buffer_load_dwordx4 v215, s[16:19], s48 offen offset:1024 nt lds
    v_mfma_f32_16x16x32_bf16 v[72:75], a[184:187], a[232:235], v[72:75]
    s_add_u32 s48, s48, 262144
    ds_read_b64_tr_b16 a[156:157], v218 offset:57576
    v_mfma_f32_16x16x32_bf16 v[104:107], a[184:187], a[236:239], v[104:107]
    s_add_u32 m0, s60, 65536
    ds_read_b64_tr_b16 a[158:159], v218 offset:58600
    v_mfma_f32_16x16x32_bf16 v[12:15], a[188:191], a[224:227], v[12:15]
    ds_read_b64_tr_b16 a[160:161], v219 offset:57568
    v_mfma_f32_16x16x32_bf16 v[44:47], a[188:191], a[228:231], v[44:47]
    ds_read_b64_tr_b16 a[162:163], v219 offset:58592
    v_mfma_f32_16x16x32_bf16 v[76:79], a[188:191], a[232:235], v[76:79]
    ds_read_b64_tr_b16 a[164:165], v219 offset:57576
    v_mfma_f32_16x16x32_bf16 v[108:111], a[188:191], a[236:239], v[108:111]
    ds_read_b64_tr_b16 a[166:167], v219 offset:58600
    v_mfma_f32_16x16x32_bf16 v[16:19], a[192:195], a[224:227], v[16:19]
    ds_read_b64_tr_b16 a[168:169], v220 offset:57568
    buffer_load_dwordx4 v214, s[16:19], s47 offen offset:0 nt lds
    v_mfma_f32_16x16x32_bf16 v[48:51], a[192:195], a[228:231], v[48:51]
    ds_read_b64_tr_b16 a[170:171], v220 offset:58592
    v_mfma_f32_16x16x32_bf16 v[80:83], a[192:195], a[232:235], v[80:83]
    ds_read_b64_tr_b16 a[172:173], v220 offset:57576
    v_mfma_f32_16x16x32_bf16 v[112:115], a[192:195], a[236:239], v[112:115]
    ds_read_b64_tr_b16 a[174:175], v220 offset:58600
    v_mfma_f32_16x16x32_bf16 v[20:23], a[196:199], a[224:227], v[20:23]
    v_mfma_f32_16x16x32_bf16 v[52:55], a[196:199], a[228:231], v[52:55]
    v_mfma_f32_16x16x32_bf16 v[84:87], a[196:199], a[232:235], v[84:87]
    v_mfma_f32_16x16x32_bf16 v[116:119], a[196:199], a[236:239], v[116:119]
    buffer_load_dwordx4 v215, s[16:19], s47 offen offset:1024 nt lds
    v_mfma_f32_16x16x32_bf16 v[24:27], a[200:203], a[224:227], v[24:27]
    s_add_u32 s47, s47, 262144
    v_mfma_f32_16x16x32_bf16 v[56:59], a[200:203], a[228:231], v[56:59]
    s_add_u32 s45, s45, 1
    v_mfma_f32_16x16x32_bf16 v[88:91], a[200:203], a[232:235], v[88:91]
    s_cmp_lt_u32 s45, 3
    v_mfma_f32_16x16x32_bf16 v[120:123], a[200:203], a[236:239], v[120:123]
    v_mfma_f32_16x16x32_bf16 v[28:31], a[204:207], a[224:227], v[28:31]
    v_mfma_f32_16x16x32_bf16 v[60:63], a[204:207], a[228:231], v[60:63]
    v_mfma_f32_16x16x32_bf16 v[92:95], a[204:207], a[232:235], v[92:95]
    v_mfma_f32_16x16x32_bf16 v[124:127], a[204:207], a[236:239], v[124:127]
    s_cbranch_scc1 K1_QLOOP
    s_waitcnt lgkmcnt(0)
    v_mfma_f32_16x16x32_bf16 a[0:3], a[144:147], a[208:211], a[0:3]
    s_mov_b32 s3, 0
    ds_read_b64_tr_b16 a[176:177], v217 offset:49344
    v_mfma_f32_16x16x32_bf16 a[32:35], a[144:147], a[212:215], a[32:35]
    s_add_u32 m0, s100, 147456
    ds_read_b64_tr_b16 a[178:179], v217 offset:50368
    v_mfma_f32_16x16x32_bf16 v[128:131], a[144:147], a[216:219], v[128:131]
    ds_read_b64_tr_b16 a[180:181], v217 offset:49352
    buffer_load_dwordx4 v204, s[4:7], s3 offen nt lds
    v_mfma_f32_16x16x32_bf16 v[160:163], a[144:147], a[220:223], v[160:163]
    s_mov_b32 s3, 4096
    s_and_b32 s54, s2, 3
    ds_read_b64_tr_b16 a[182:183], v217 offset:50376
    v_mfma_f32_16x16x32_bf16 a[4:7], a[148:151], a[208:211], a[4:7]
    s_add_u32 m0, s100, 151552
    s_lshl_b32 s54, s54, 20
    ds_read_b64_tr_b16 a[184:185], v218 offset:49344
    v_mfma_f32_16x16x32_bf16 a[36:39], a[148:151], a[212:215], a[36:39]
    s_bfe_u32 s59, s2, 0x20003
    s_lshl_b32 s59, s59, 8
    ds_read_b64_tr_b16 a[186:187], v218 offset:50368
    v_mfma_f32_16x16x32_bf16 v[132:135], a[148:151], a[216:219], v[132:135]
    s_add_u32 s54, s54, s59
    s_sub_u32 s18, 1048576, s59
    ds_read_b64_tr_b16 a[188:189], v218 offset:49352
    v_mfma_f32_16x16x32_bf16 v[164:167], a[148:151], a[220:223], v[164:167]
    s_and_b32 s52, s2, 3
    s_lshl_b32 s52, s52, 2
    ds_read_b64_tr_b16 a[190:191], v218 offset:50376
    v_mfma_f32_16x16x32_bf16 a[8:11], a[152:155], a[208:211], a[8:11]
    s_lshl_b32 s53, s100, 3
    s_lshl_b32 s59, s100, 7
    ds_read_b64_tr_b16 a[192:193], v219 offset:49344
    v_mfma_f32_16x16x32_bf16 a[40:43], a[152:155], a[212:215], a[40:43]
    ds_read_b64_tr_b16 a[194:195], v219 offset:50368
    v_mbcnt_lo_u32_b32 v210, -1, 0
    v_mfma_f32_16x16x32_bf16 v[136:139], a[152:155], a[216:219], v[136:139]
    ds_read_b64_tr_b16 a[196:197], v219 offset:49352
    v_mbcnt_hi_u32_b32 v210, -1, v210
    v_mfma_f32_16x16x32_bf16 v[168:171], a[152:155], a[220:223], v[168:171]
    ds_read_b64_tr_b16 a[198:199], v219 offset:50376
    v_lshlrev_b32 v214, 20, v210
    v_mfma_f32_16x16x32_bf16 a[12:15], a[156:159], a[208:211], a[12:15]
    ds_read_b64_tr_b16 a[200:201], v220 offset:49344
    v_lshrrev_b32 v211, 4, v210
    v_mfma_f32_16x16x32_bf16 a[44:47], a[156:159], a[212:215], a[44:47]
    ds_read_b64_tr_b16 a[202:203], v220 offset:50368
    v_and_b32 v210, 15, v210
    v_mfma_f32_16x16x32_bf16 v[140:143], a[156:159], a[216:219], v[140:143]
    ds_read_b64_tr_b16 a[204:205], v220 offset:49352
    v_lshlrev_b32 v212, 1, v211
    v_mfma_f32_16x16x32_bf16 v[172:175], a[156:159], a[220:223], v[172:175]
    ds_read_b64_tr_b16 a[206:207], v220 offset:50376
    v_xor_b32 v212, v212, v210
    v_mfma_f32_16x16x32_bf16 a[16:19], a[160:163], a[208:211], a[16:19]
    v_xor_b32 v212, s52, v212
    v_lshlrev_b32 v212, 4, v212
    v_mfma_f32_16x16x32_bf16 a[48:51], a[160:163], a[212:215], a[48:51]
    v_lshl_add_u32 v212, v211, 10, v212
    v_add_u32 v205, s53, v212
    v_mfma_f32_16x16x32_bf16 v[144:147], a[160:163], a[216:219], v[144:147]
    buffer_load_dwordx4 v204, s[4:7], s3 offen nt lds
    v_xor_b32 v206, 128, v205
    v_mfma_f32_16x16x32_bf16 v[176:179], a[160:163], a[220:223], v[176:179]
    v_add_u32 v206, 3072, v206
    v_lshlrev_b32 v212, 11, v210
    v_mfma_f32_16x16x32_bf16 a[20:23], a[164:167], a[208:211], a[20:23]
    v_and_b32 v213, 1, v211
    v_lshl_add_u32 v212, v213, 5, v212
    v_mfma_f32_16x16x32_bf16 a[52:55], a[164:167], a[212:215], a[52:55]
    v_lshrrev_b32 v213, 1, v211
    v_lshl_add_u32 v212, v213, 4, v212
    v_mfma_f32_16x16x32_bf16 v[148:151], a[164:167], a[216:219], v[148:151]
    v_add_u32 v207, s59, v212
    v_mfma_f32_16x16x32_bf16 v[180:183], a[164:167], a[220:223], v[180:183]
    v_mfma_f32_16x16x32_bf16 a[24:27], a[168:171], a[208:211], a[24:27]
    v_mfma_f32_16x16x32_bf16 a[56:59], a[168:171], a[212:215], a[56:59]
    v_mfma_f32_16x16x32_bf16 v[152:155], a[168:171], a[216:219], v[152:155]
    v_mfma_f32_16x16x32_bf16 v[184:187], a[168:171], a[220:223], v[184:187]
    v_mfma_f32_16x16x32_bf16 a[28:31], a[172:175], a[208:211], a[28:31]
    v_mfma_f32_16x16x32_bf16 a[60:63], a[172:175], a[212:215], a[60:63]
    v_mfma_f32_16x16x32_bf16 v[156:159], a[172:175], a[216:219], v[156:159]
    v_mfma_f32_16x16x32_bf16 v[188:191], a[172:175], a[220:223], v[188:191]
    s_add_u32 s16, s36, s54
    s_addc_u32 s17, s37, 0
    s_waitcnt vmcnt(18) lgkmcnt(0)
    s_barrier
    s_load_dwordx2 s[32:33], s[0:1], 88
    s_memrealtime s[34:35]
    v_mfma_f32_16x16x32_bf16 v[0:3], a[176:179], a[208:211], v[0:3]
    s_mov_b32 s3, 8192
    ds_read_b128 a[224:227], v216 offset:0
    v_mfma_f32_16x16x32_bf16 v[32:35], a[176:179], a[212:215], v[32:35]
    s_add_u32 m0, s100, 155648
    ds_read_b128 a[228:231], v216 offset:2048
    v_mfma_f32_16x16x32_bf16 v[64:67], a[176:179], a[216:219], v[64:67]
    ds_read_b128 a[232:235], v216 offset:4096
    buffer_load_dwordx4 v204, s[4:7], s3 offen nt lds
    v_mfma_f32_16x16x32_bf16 v[96:99], a[176:179], a[220:223], v[96:99]
    s_mov_b32 s3, 12288
    ds_read_b128 a[236:239], v216 offset:6144
    v_mfma_f32_16x16x32_bf16 v[4:7], a[180:183], a[208:211], v[4:7]
    s_add_u32 m0, s100, 159744
    ds_read_b64_tr_b16 a[144:145], v217 offset:41120
    v_mfma_f32_16x16x32_bf16 v[36:39], a[180:183], a[212:215], v[36:39]
    ds_read_b64_tr_b16 a[146:147], v217 offset:42144
    v_mfma_f32_16x16x32_bf16 v[68:71], a[180:183], a[216:219], v[68:71]
    ds_read_b64_tr_b16 a[148:149], v217 offset:41128
    v_mfma_f32_16x16x32_bf16 v[100:103], a[180:183], a[220:223], v[100:103]
    ds_read_b64_tr_b16 a[150:151], v217 offset:42152
    v_mfma_f32_16x16x32_bf16 v[8:11], a[184:187], a[208:211], v[8:11]
    ds_read_b64_tr_b16 a[152:153], v218 offset:41120
    v_mfma_f32_16x16x32_bf16 v[40:43], a[184:187], a[212:215], v[40:43]
    ds_read_b64_tr_b16 a[154:155], v218 offset:42144
    v_mfma_f32_16x16x32_bf16 v[72:75], a[184:187], a[216:219], v[72:75]
    ds_read_b64_tr_b16 a[156:157], v218 offset:41128
    v_mfma_f32_16x16x32_bf16 v[104:107], a[184:187], a[220:223], v[104:107]
    ds_read_b64_tr_b16 a[158:159], v218 offset:42152
    v_mfma_f32_16x16x32_bf16 v[12:15], a[188:191], a[208:211], v[12:15]
    ds_read_b64_tr_b16 a[160:161], v219 offset:41120
    v_mfma_f32_16x16x32_bf16 v[44:47], a[188:191], a[212:215], v[44:47]
    ds_read_b64_tr_b16 a[162:163], v219 offset:42144
    v_mfma_f32_16x16x32_bf16 v[76:79], a[188:191], a[216:219], v[76:79]
    ds_read_b64_tr_b16 a[164:165], v219 offset:41128
    v_mfma_f32_16x16x32_bf16 v[108:111], a[188:191], a[220:223], v[108:111]
    ds_read_b64_tr_b16 a[166:167], v219 offset:42152
    v_mfma_f32_16x16x32_bf16 v[16:19], a[192:195], a[208:211], v[16:19]
    ds_read_b64_tr_b16 a[168:169], v220 offset:41120
    v_mfma_f32_16x16x32_bf16 v[48:51], a[192:195], a[212:215], v[48:51]
    ds_read_b64_tr_b16 a[170:171], v220 offset:42144
    v_mfma_f32_16x16x32_bf16 v[80:83], a[192:195], a[216:219], v[80:83]
    ds_read_b64_tr_b16 a[172:173], v220 offset:41128
    buffer_load_dwordx4 v204, s[4:7], s3 offen nt lds
    v_mfma_f32_16x16x32_bf16 v[112:115], a[192:195], a[220:223], v[112:115]
    ds_read_b64_tr_b16 a[174:175], v220 offset:42152
    v_mfma_f32_16x16x32_bf16 v[20:23], a[196:199], a[208:211], v[20:23]
    v_mfma_f32_16x16x32_bf16 v[52:55], a[196:199], a[212:215], v[52:55]
    v_mfma_f32_16x16x32_bf16 v[84:87], a[196:199], a[216:219], v[84:87]
    v_mfma_f32_16x16x32_bf16 v[116:119], a[196:199], a[220:223], v[116:119]
    v_mfma_f32_16x16x32_bf16 v[24:27], a[200:203], a[208:211], v[24:27]
    v_mfma_f32_16x16x32_bf16 v[56:59], a[200:203], a[212:215], v[56:59]
    v_mfma_f32_16x16x32_bf16 v[88:91], a[200:203], a[216:219], v[88:91]
    v_mfma_f32_16x16x32_bf16 v[120:123], a[200:203], a[220:223], v[120:123]
    v_mfma_f32_16x16x32_bf16 v[28:31], a[204:207], a[208:211], v[28:31]
    v_mfma_f32_16x16x32_bf16 v[60:63], a[204:207], a[212:215], v[60:63]
    v_mfma_f32_16x16x32_bf16 v[92:95], a[204:207], a[216:219], v[92:95]
    v_mfma_f32_16x16x32_bf16 v[124:127], a[204:207], a[220:223], v[124:127]
    s_waitcnt lgkmcnt(0)
    v_mfma_f32_16x16x32_bf16 a[0:3], a[144:147], a[224:227], a[0:3]
    s_mov_b32 s3, 16384
    ds_read_b64_tr_b16 a[176:177], v217 offset:32896
    v_mfma_f32_16x16x32_bf16 a[32:35], a[144:147], a[228:231], a[32:35]
    s_add_u32 m0, s100, 131072
    ds_read_b64_tr_b16 a[178:179], v217 offset:33920
    v_mfma_f32_16x16x32_bf16 v[128:131], a[144:147], a[232:235], v[128:131]
    ds_read_b64_tr_b16 a[180:181], v217 offset:32904
    buffer_load_dwordx4 v204, s[4:7], s3 offen nt lds
    v_mfma_f32_16x16x32_bf16 v[160:163], a[144:147], a[236:239], v[160:163]
    s_mov_b32 s3, 20480
    s_mov_b32 s12, s32
    ds_read_b64_tr_b16 a[182:183], v217 offset:33928
    v_mfma_f32_16x16x32_bf16 a[4:7], a[148:151], a[224:227], a[4:7]
    s_add_u32 m0, s100, 135168
    s_mov_b32 s13, s33
    ds_read_b64_tr_b16 a[184:185], v218 offset:32896
    v_mfma_f32_16x16x32_bf16 a[36:39], a[148:151], a[228:231], a[36:39]
    s_mov_b32 s14, 4
    s_andn2_b32 s54, s34, 30
    ds_read_b64_tr_b16 a[186:187], v218 offset:33920
    v_mfma_f32_16x16x32_bf16 v[132:135], a[148:151], a[232:235], v[132:135]
    s_or_b32 s54, s54, 1
    ds_read_b64_tr_b16 a[188:189], v218 offset:32904
    v_mov_b32 v212, s54
    v_mfma_f32_16x16x32_bf16 v[164:167], a[148:151], a[236:239], v[164:167]
    ds_read_b64_tr_b16 a[190:191], v218 offset:33928
    v_mov_b32 v213, 0
    v_mfma_f32_16x16x32_bf16 a[8:11], a[152:155], a[224:227], a[8:11]
    ds_read_b64_tr_b16 a[192:193], v219 offset:32896
    v_mfma_f32_16x16x32_bf16 a[40:43], a[152:155], a[228:231], a[40:43]
    ds_read_b64_tr_b16 a[194:195], v219 offset:33920
    v_mfma_f32_16x16x32_bf16 v[136:139], a[152:155], a[232:235], v[136:139]
    ds_read_b64_tr_b16 a[196:197], v219 offset:32904
    v_mfma_f32_16x16x32_bf16 v[168:171], a[152:155], a[236:239], v[168:171]
    ds_read_b64_tr_b16 a[198:199], v219 offset:33928
    v_mfma_f32_16x16x32_bf16 a[12:15], a[156:159], a[224:227], a[12:15]
    ds_read_b64_tr_b16 a[200:201], v220 offset:32896
    v_mfma_f32_16x16x32_bf16 a[44:47], a[156:159], a[228:231], a[44:47]
    ds_read_b64_tr_b16 a[202:203], v220 offset:33920
    v_mfma_f32_16x16x32_bf16 v[140:143], a[156:159], a[232:235], v[140:143]
    ds_read_b64_tr_b16 a[204:205], v220 offset:32904
    v_mfma_f32_16x16x32_bf16 v[172:175], a[156:159], a[236:239], v[172:175]
    ds_read_b64_tr_b16 a[206:207], v220 offset:33928
    v_mfma_f32_16x16x32_bf16 a[16:19], a[160:163], a[224:227], a[16:19]
    v_mfma_f32_16x16x32_bf16 a[48:51], a[160:163], a[228:231], a[48:51]
    v_mfma_f32_16x16x32_bf16 v[144:147], a[160:163], a[232:235], v[144:147]
    buffer_load_dwordx4 v204, s[4:7], s3 offen nt lds
    v_mfma_f32_16x16x32_bf16 v[176:179], a[160:163], a[236:239], v[176:179]
    v_mfma_f32_16x16x32_bf16 a[20:23], a[164:167], a[224:227], a[20:23]
    v_mfma_f32_16x16x32_bf16 a[52:55], a[164:167], a[228:231], a[52:55]
    v_mfma_f32_16x16x32_bf16 v[148:151], a[164:167], a[232:235], v[148:151]
    v_mfma_f32_16x16x32_bf16 v[180:183], a[164:167], a[236:239], v[180:183]
    v_mfma_f32_16x16x32_bf16 a[24:27], a[168:171], a[224:227], a[24:27]
    v_mfma_f32_16x16x32_bf16 a[56:59], a[168:171], a[228:231], a[56:59]
    v_mfma_f32_16x16x32_bf16 v[152:155], a[168:171], a[232:235], v[152:155]
    v_mfma_f32_16x16x32_bf16 v[184:187], a[168:171], a[236:239], v[184:187]
    v_mfma_f32_16x16x32_bf16 a[28:31], a[172:175], a[224:227], a[28:31]
    v_mfma_f32_16x16x32_bf16 a[60:63], a[172:175], a[228:231], a[60:63]
    v_mfma_f32_16x16x32_bf16 v[156:159], a[172:175], a[232:235], v[156:159]
    v_mfma_f32_16x16x32_bf16 v[188:191], a[172:175], a[236:239], v[188:191]
    s_waitcnt vmcnt(10) lgkmcnt(0)
    s_barrier
    v_mfma_f32_16x16x32_bf16 v[0:3], a[176:179], a[224:227], v[0:3]
    s_mov_b32 s3, 24576
    ds_read_b128 a[208:211], v209 offset:32768
    v_mfma_f32_16x16x32_bf16 v[32:35], a[176:179], a[228:231], v[32:35]
    s_add_u32 m0, s100, 139264
    ds_read_b128 a[212:215], v209 offset:34816
    v_mfma_f32_16x16x32_bf16 v[64:67], a[176:179], a[232:235], v[64:67]
    ds_read_b128 a[216:219], v209 offset:36864
    buffer_load_dwordx4 v204, s[4:7], s3 offen nt lds
    v_mfma_f32_16x16x32_bf16 v[96:99], a[176:179], a[236:239], v[96:99]
    s_mov_b32 s3, 28672
    ds_read_b128 a[220:223], v209 offset:38912
    v_mfma_f32_16x16x32_bf16 v[4:7], a[180:183], a[224:227], v[4:7]
    s_add_u32 m0, s100, 143360
    ds_read_b64_tr_b16 a[144:145], v217 offset:24672
    v_mfma_f32_16x16x32_bf16 v[36:39], a[180:183], a[228:231], v[36:39]
    ds_read_b64_tr_b16 a[146:147], v217 offset:25696
    v_mfma_f32_16x16x32_bf16 v[68:71], a[180:183], a[232:235], v[68:71]
    ds_read_b64_tr_b16 a[148:149], v217 offset:24680
    v_mfma_f32_16x16x32_bf16 v[100:103], a[180:183], a[236:239], v[100:103]
    ds_read_b64_tr_b16 a[150:151], v217 offset:25704
    v_mfma_f32_16x16x32_bf16 v[8:11], a[184:187], a[224:227], v[8:11]
    ds_read_b64_tr_b16 a[152:153], v218 offset:24672
    v_mfma_f32_16x16x32_bf16 v[40:43], a[184:187], a[228:231], v[40:43]
    ds_read_b64_tr_b16 a[154:155], v218 offset:25696
    v_mfma_f32_16x16x32_bf16 v[72:75], a[184:187], a[232:235], v[72:75]
    ds_read_b64_tr_b16 a[156:157], v218 offset:24680
    v_mfma_f32_16x16x32_bf16 v[104:107], a[184:187], a[236:239], v[104:107]
    ds_read_b64_tr_b16 a[158:159], v218 offset:25704
    v_mfma_f32_16x16x32_bf16 v[12:15], a[188:191], a[224:227], v[12:15]
    ds_read_b64_tr_b16 a[160:161], v219 offset:24672
    v_mfma_f32_16x16x32_bf16 v[44:47], a[188:191], a[228:231], v[44:47]
    ds_read_b64_tr_b16 a[162:163], v219 offset:25696
    v_mfma_f32_16x16x32_bf16 v[76:79], a[188:191], a[232:235], v[76:79]
    ds_read_b64_tr_b16 a[164:165], v219 offset:24680
    v_mfma_f32_16x16x32_bf16 v[108:111], a[188:191], a[236:239], v[108:111]
    ds_read_b64_tr_b16 a[166:167], v219 offset:25704
    v_mfma_f32_16x16x32_bf16 v[16:19], a[192:195], a[224:227], v[16:19]
    ds_read_b64_tr_b16 a[168:169], v220 offset:24672
    v_mfma_f32_16x16x32_bf16 v[48:51], a[192:195], a[228:231], v[48:51]
    ds_read_b64_tr_b16 a[170:171], v220 offset:25696
    v_mfma_f32_16x16x32_bf16 v[80:83], a[192:195], a[232:235], v[80:83]
    ds_read_b64_tr_b16 a[172:173], v220 offset:24680
    buffer_load_dwordx4 v204, s[4:7], s3 offen nt lds
    v_mfma_f32_16x16x32_bf16 v[112:115], a[192:195], a[236:239], v[112:115]
    ds_read_b64_tr_b16 a[174:175], v220 offset:25704
    v_mfma_f32_16x16x32_bf16 v[20:23], a[196:199], a[224:227], v[20:23]
    v_mfma_f32_16x16x32_bf16 v[52:55], a[196:199], a[228:231], v[52:55]
    v_mfma_f32_16x16x32_bf16 v[84:87], a[196:199], a[232:235], v[84:87]
    v_mfma_f32_16x16x32_bf16 v[116:119], a[196:199], a[236:239], v[116:119]
    v_mfma_f32_16x16x32_bf16 v[24:27], a[200:203], a[224:227], v[24:27]
    v_mfma_f32_16x16x32_bf16 v[56:59], a[200:203], a[228:231], v[56:59]
    v_mfma_f32_16x16x32_bf16 v[88:91], a[200:203], a[232:235], v[88:91]
    v_mfma_f32_16x16x32_bf16 v[120:123], a[200:203], a[236:239], v[120:123]
    v_mfma_f32_16x16x32_bf16 v[28:31], a[204:207], a[224:227], v[28:31]
    v_mfma_f32_16x16x32_bf16 v[60:63], a[204:207], a[228:231], v[60:63]
    v_mfma_f32_16x16x32_bf16 v[92:95], a[204:207], a[232:235], v[92:95]
    v_mfma_f32_16x16x32_bf16 v[124:127], a[204:207], a[236:239], v[124:127]
    s_waitcnt vmcnt(8) lgkmcnt(0)
    s_barrier
    v_mfma_f32_16x16x32_bf16 a[0:3], a[144:147], a[208:211], a[0:3]
    s_mov_b32 s3, 0
    ds_read_b128 a[224:227], v216 offset:32768
    v_mfma_f32_16x16x32_bf16 a[32:35], a[144:147], a[212:215], a[32:35]
    s_add_u32 m0, s100, 0
    ds_read_b128 a[228:231], v216 offset:34816
    v_mfma_f32_16x16x32_bf16 v[128:131], a[144:147], a[216:219], v[128:131]
    ds_read_b128 a[232:235], v216 offset:36864
    buffer_load_dwordx4 v208, s[8:11], s3 offen nt lds
    v_mfma_f32_16x16x32_bf16 v[160:163], a[144:147], a[220:223], v[160:163]
    s_mov_b32 s3, 4096
    ds_read_b128 a[236:239], v216 offset:38912
    v_mfma_f32_16x16x32_bf16 a[4:7], a[148:151], a[208:211], a[4:7]
    s_add_u32 m0, s100, 4096
    ds_read_b64_tr_b16 a[176:177], v217 offset:8224
    v_mfma_f32_16x16x32_bf16 a[36:39], a[148:151], a[212:215], a[36:39]
    ds_read_b64_tr_b16 a[178:179], v217 offset:9248
    v_mfma_f32_16x16x32_bf16 v[132:135], a[148:151], a[216:219], v[132:135]
    ds_read_b64_tr_b16 a[180:181], v217 offset:8232
    v_mfma_f32_16x16x32_bf16 v[164:167], a[148:151], a[220:223], v[164:167]
    ds_read_b64_tr_b16 a[182:183], v217 offset:9256
    v_mfma_f32_16x16x32_bf16 a[8:11], a[152:155], a[208:211], a[8:11]
    ds_read_b64_tr_b16 a[184:185], v218 offset:8224
    v_mfma_f32_16x16x32_bf16 a[40:43], a[152:155], a[212:215], a[40:43]
    ds_read_b64_tr_b16 a[186:187], v218 offset:9248
    v_mfma_f32_16x16x32_bf16 v[136:139], a[152:155], a[216:219], v[136:139]
    ds_read_b64_tr_b16 a[188:189], v218 offset:8232
    v_mfma_f32_16x16x32_bf16 v[168:171], a[152:155], a[220:223], v[168:171]
    ds_read_b64_tr_b16 a[190:191], v218 offset:9256
    v_mfma_f32_16x16x32_bf16 a[12:15], a[156:159], a[208:211], a[12:15]
    ds_read_b64_tr_b16 a[192:193], v219 offset:8224
    v_mfma_f32_16x16x32_bf16 a[44:47], a[156:159], a[212:215], a[44:47]
    ds_read_b64_tr_b16 a[194:195], v219 offset:9248
    v_mfma_f32_16x16x32_bf16 v[140:143], a[156:159], a[216:219], v[140:143]
    ds_read_b64_tr_b16 a[196:197], v219 offset:8232
    v_mfma_f32_16x16x32_bf16 v[172:175], a[156:159], a[220:223], v[172:175]
    ds_read_b64_tr_b16 a[198:199], v219 offset:9256
    v_mfma_f32_16x16x32_bf16 a[16:19], a[160:163], a[208:211], a[16:19]
    ds_read_b64_tr_b16 a[200:201], v220 offset:8224
    v_mfma_f32_16x16x32_bf16 a[48:51], a[160:163], a[212:215], a[48:51]
    ds_read_b64_tr_b16 a[202:203], v220 offset:9248
    v_mfma_f32_16x16x32_bf16 v[144:147], a[160:163], a[216:219], v[144:147]
    ds_read_b64_tr_b16 a[204:205], v220 offset:8232
    buffer_load_dwordx4 v208, s[8:11], s3 offen nt lds
    v_mfma_f32_16x16x32_bf16 v[176:179], a[160:163], a[220:223], v[176:179]
    ds_read_b64_tr_b16 a[206:207], v220 offset:9256
    v_mfma_f32_16x16x32_bf16 a[20:23], a[164:167], a[208:211], a[20:23]
    v_mfma_f32_16x16x32_bf16 a[52:55], a[164:167], a[212:215], a[52:55]
    v_mfma_f32_16x16x32_bf16 v[148:151], a[164:167], a[216:219], v[148:151]
    v_mfma_f32_16x16x32_bf16 v[180:183], a[164:167], a[220:223], v[180:183]
    v_mfma_f32_16x16x32_bf16 a[24:27], a[168:171], a[208:211], a[24:27]
    v_mfma_f32_16x16x32_bf16 a[56:59], a[168:171], a[212:215], a[56:59]
    v_mfma_f32_16x16x32_bf16 v[152:155], a[168:171], a[216:219], v[152:155]
    v_mfma_f32_16x16x32_bf16 v[184:187], a[168:171], a[220:223], v[184:187]
    v_mfma_f32_16x16x32_bf16 a[28:31], a[172:175], a[208:211], a[28:31]
    v_mfma_f32_16x16x32_bf16 a[60:63], a[172:175], a[212:215], a[60:63]
    v_mfma_f32_16x16x32_bf16 v[156:159], a[172:175], a[216:219], v[156:159]
    v_mfma_f32_16x16x32_bf16 v[188:191], a[172:175], a[220:223], v[188:191]
    s_waitcnt lgkmcnt(0)
    v_mfma_f32_16x16x32_bf16 v[128:131], a[176:179], a[232:235], v[128:131]
    s_mov_b32 s3, 8192
    ds_read_b64_tr_b16 a[144:145], v217 offset:16448
    v_mfma_f32_16x16x32_bf16 v[132:135], a[180:183], a[232:235], v[132:135]
    s_add_u32 m0, s100, 8192
    ds_read_b64_tr_b16 a[146:147], v217 offset:17472
    v_mfma_f32_16x16x32_bf16 v[136:139], a[184:187], a[232:235], v[136:139]
    ds_read_b64_tr_b16 a[148:149], v217 offset:16456
    buffer_load_dwordx4 v208, s[8:11], s3 offen nt lds
    v_mfma_f32_16x16x32_bf16 v[140:143], a[188:191], a[232:235], v[140:143]
    s_mov_b32 s3, 12288
    ds_read_b64_tr_b16 a[150:151], v217 offset:17480
    v_mfma_f32_16x16x32_bf16 v[144:147], a[192:195], a[232:235], v[144:147]
    s_add_u32 m0, s100, 12288
    ds_read_b64_tr_b16 a[152:153], v218 offset:16448
    v_mfma_f32_16x16x32_bf16 v[148:151], a[196:199], a[232:235], v[148:151]
    ds_read_b64_tr_b16 a[154:155], v218 offset:17472
    v_mfma_f32_16x16x32_bf16 v[152:155], a[200:203], a[232:235], v[152:155]
    ds_read_b64_tr_b16 a[156:157], v218 offset:16456
    v_mfma_f32_16x16x32_bf16 v[156:159], a[204:207], a[232:235], v[156:159]
    ds_read_b64_tr_b16 a[158:159], v218 offset:17480
    v_mfma_f32_16x16x32_bf16 v[160:163], a[176:179], a[236:239], v[160:163]
    ds_read_b64_tr_b16 a[160:161], v219 offset:16448
    v_mfma_f32_16x16x32_bf16 v[164:167], a[180:183], a[236:239], v[164:167]
    ds_read_b64_tr_b16 a[162:163], v219 offset:17472
    v_mfma_f32_16x16x32_bf16 v[168:171], a[184:187], a[236:239], v[168:171]
    ds_read_b64_tr_b16 a[164:165], v219 offset:16456
    v_mfma_f32_16x16x32_bf16 v[172:175], a[188:191], a[236:239], v[172:175]
    ds_read_b64_tr_b16 a[166:167], v219 offset:17480
    v_mfma_f32_16x16x32_bf16 v[176:179], a[192:195], a[236:239], v[176:179]
    ds_read_b64_tr_b16 a[168:169], v220 offset:16448
    v_mfma_f32_16x16x32_bf16 v[180:183], a[196:199], a[236:239], v[180:183]
    ds_read_b64_tr_b16 a[170:171], v220 offset:17472
    v_mfma_f32_16x16x32_bf16 v[184:187], a[200:203], a[236:239], v[184:187]
    ds_read_b64_tr_b16 a[172:173], v220 offset:16456
    v_mfma_f32_16x16x32_bf16 v[188:191], a[204:207], a[236:239], v[188:191]
    ds_read_b64_tr_b16 a[174:175], v220 offset:17480
    v_mfma_f32_16x16x32_bf16 a[0:3], a[176:179], a[224:227], a[0:3]
    v_mfma_f32_16x16x32_bf16 a[4:7], a[180:183], a[224:227], a[4:7]
    v_mfma_f32_16x16x32_bf16 a[8:11], a[184:187], a[224:227], a[8:11]
    buffer_load_dwordx4 v208, s[8:11], s3 offen nt lds
    v_mfma_f32_16x16x32_bf16 a[12:15], a[188:191], a[224:227], a[12:15]
    v_mfma_f32_16x16x32_bf16 a[16:19], a[192:195], a[224:227], a[16:19]
    v_mul_f32 v128, s62, v128
    v_mul_f32 v129, s62, v129
    v_mfma_f32_16x16x32_bf16 a[20:23], a[196:199], a[224:227], a[20:23]
    v_mul_f32 v130, s62, v130
    v_mul_f32 v131, s62, v131
    v_mfma_f32_16x16x32_bf16 a[24:27], a[200:203], a[224:227], a[24:27]
    v_mul_f32 v132, s62, v132
    v_mul_f32 v133, s62, v133
    v_mfma_f32_16x16x32_bf16 a[28:31], a[204:207], a[224:227], a[28:31]
    v_mul_f32 v134, s62, v134
    v_mul_f32 v135, s62, v135
    v_mfma_f32_16x16x32_bf16 a[32:35], a[176:179], a[228:231], a[32:35]
    v_cvt_pk_bf16_f32 v224, v128, v129
    v_cvt_pk_bf16_f32 v225, v130, v131
    v_mfma_f32_16x16x32_bf16 a[36:39], a[180:183], a[228:231], a[36:39]
    v_cvt_pk_bf16_f32 v226, v132, v133
    v_cvt_pk_bf16_f32 v227, v134, v135
    v_mfma_f32_16x16x32_bf16 a[40:43], a[184:187], a[228:231], a[40:43]
    v_mul_f32 v136, s62, v136
    v_mul_f32 v137, s62, v137
    v_mfma_f32_16x16x32_bf16 a[44:47], a[188:191], a[228:231], a[44:47]
    v_mul_f32 v138, s62, v138
    v_mul_f32 v139, s62, v139
    v_mfma_f32_16x16x32_bf16 a[48:51], a[192:195], a[228:231], a[48:51]
    v_mul_f32 v140, s62, v140
    v_mul_f32 v141, s62, v141
    v_mfma_f32_16x16x32_bf16 a[52:55], a[196:199], a[228:231], a[52:55]
    v_mul_f32 v142, s62, v142
    v_mul_f32 v143, s62, v143
    v_mfma_f32_16x16x32_bf16 a[56:59], a[200:203], a[228:231], a[56:59]
    v_cvt_pk_bf16_f32 v228, v136, v137
    v_cvt_pk_bf16_f32 v229, v138, v139
    v_mfma_f32_16x16x32_bf16 a[60:63], a[204:207], a[228:231], a[60:63]
    v_cvt_pk_bf16_f32 v230, v140, v141
    v_cvt_pk_bf16_f32 v231, v142, v143
    s_waitcnt lgkmcnt(0)
    v_mfma_f32_16x16x32_bf16 v[0:3], a[144:147], a[208:211], v[0:3]
    s_mov_b32 s3, 32768
    ds_read_b64_tr_b16 a[176:177], v217 offset:0
    v_mul_f32 v144, s62, v144
    v_mfma_f32_16x16x32_bf16 v[32:35], a[144:147], a[212:215], v[32:35]
    s_add_u32 m0, s100, 114688
    ds_read_b64_tr_b16 a[178:179], v217 offset:1024
    v_mul_f32 v145, s62, v145
    v_mfma_f32_16x16x32_bf16 v[64:67], a[144:147], a[216:219], v[64:67]
    ds_read_b64_tr_b16 a[180:181], v217 offset:8
    buffer_load_dwordx4 v204, s[4:7], s3 offen nt lds
    v_mfma_f32_16x16x32_bf16 v[96:99], a[144:147], a[220:223], v[96:99]
    s_mov_b32 s3, 36864
    ds_read_b64_tr_b16 a[182:183], v217 offset:1032
    v_mul_f32 v146, s62, v146
    v_mfma_f32_16x16x32_bf16 v[4:7], a[148:151], a[208:211], v[4:7]
    s_add_u32 m0, s100, 118784
    ds_read_b64_tr_b16 a[184:185], v218 offset:0
    v_mul_f32 v147, s62, v147
    v_mfma_f32_16x16x32_bf16 v[36:39], a[148:151], a[212:215], v[36:39]
    ds_read_b64_tr_b16 a[186:187], v218 offset:1024
    v_mul_f32 v148, s62, v148
    v_mfma_f32_16x16x32_bf16 v[68:71], a[148:151], a[216:219], v[68:71]
    ds_read_b64_tr_b16 a[188:189], v218 offset:8
    v_mul_f32 v149, s62, v149
    v_mfma_f32_16x16x32_bf16 v[100:103], a[148:151], a[220:223], v[100:103]
    ds_read_b64_tr_b16 a[190:191], v218 offset:1032
    v_mul_f32 v150, s62, v150
    v_mfma_f32_16x16x32_bf16 v[8:11], a[152:155], a[208:211], v[8:11]
    ds_read_b64_tr_b16 a[192:193], v219 offset:0
    v_mul_f32 v151, s62, v151
    v_mfma_f32_16x16x32_bf16 v[40:43], a[152:155], a[212:215], v[40:43]
    ds_read_b64_tr_b16 a[194:195], v219 offset:1024
    v_cvt_pk_bf16_f32 v232, v144, v145
    v_mfma_f32_16x16x32_bf16 v[72:75], a[152:155], a[216:219], v[72:75]
    ds_read_b64_tr_b16 a[196:197], v219 offset:8
    v_cvt_pk_bf16_f32 v233, v146, v147
    v_mfma_f32_16x16x32_bf16 v[104:107], a[152:155], a[220:223], v[104:107]
    ds_read_b64_tr_b16 a[198:199], v219 offset:1032
    v_cvt_pk_bf16_f32 v234, v148, v149
    v_mfma_f32_16x16x32_bf16 v[12:15], a[156:159], a[208:211], v[12:15]
    ds_read_b64_tr_b16 a[200:201], v220 offset:0
    v_cvt_pk_bf16_f32 v235, v150, v151
    v_mfma_f32_16x16x32_bf16 v[44:47], a[156:159], a[212:215], v[44:47]
    ds_read_b64_tr_b16 a[202:203], v220 offset:1024
    v_mul_f32 v152, s62, v152
    v_mfma_f32_16x16x32_bf16 v[76:79], a[156:159], a[216:219], v[76:79]
    ds_read_b64_tr_b16 a[204:205], v220 offset:8
    v_mul_f32 v153, s62, v153
    v_mfma_f32_16x16x32_bf16 v[108:111], a[156:159], a[220:223], v[108:111]
    ds_read_b64_tr_b16 a[206:207], v220 offset:1032
    v_mul_f32 v154, s62, v154
    v_mfma_f32_16x16x32_bf16 v[16:19], a[160:163], a[208:211], v[16:19]
    v_mul_f32 v155, s62, v155
    v_mul_f32 v156, s62, v156
    v_mfma_f32_16x16x32_bf16 v[48:51], a[160:163], a[212:215], v[48:51]
    v_mul_f32 v157, s62, v157
    v_mul_f32 v158, s62, v158
    v_mfma_f32_16x16x32_bf16 v[80:83], a[160:163], a[216:219], v[80:83]
    buffer_load_dwordx4 v204, s[4:7], s3 offen nt lds
    v_mul_f32 v159, s62, v159
    v_mfma_f32_16x16x32_bf16 v[112:115], a[160:163], a[220:223], v[112:115]
    v_cvt_pk_bf16_f32 v236, v152, v153
    v_cvt_pk_bf16_f32 v237, v154, v155
    v_mfma_f32_16x16x32_bf16 v[20:23], a[164:167], a[208:211], v[20:23]
    v_cvt_pk_bf16_f32 v238, v156, v157
    v_cvt_pk_bf16_f32 v239, v158, v159
    v_mfma_f32_16x16x32_bf16 v[52:55], a[164:167], a[212:215], v[52:55]
    v_mul_f32 v160, s62, v160
    v_mul_f32 v161, s62, v161
    v_mfma_f32_16x16x32_bf16 v[84:87], a[164:167], a[216:219], v[84:87]
    v_mul_f32 v162, s62, v162
    v_mul_f32 v163, s62, v163
    v_mfma_f32_16x16x32_bf16 v[116:119], a[164:167], a[220:223], v[116:119]
    v_mul_f32 v164, s62, v164
    v_mul_f32 v165, s62, v165
    v_mfma_f32_16x16x32_bf16 v[24:27], a[168:171], a[208:211], v[24:27]
    v_mul_f32 v166, s62, v166
    v_mul_f32 v167, s62, v167
    v_mfma_f32_16x16x32_bf16 v[56:59], a[168:171], a[212:215], v[56:59]
    v_cvt_pk_bf16_f32 v240, v160, v161
    v_cvt_pk_bf16_f32 v241, v162, v163
    v_mfma_f32_16x16x32_bf16 v[88:91], a[168:171], a[216:219], v[88:91]
    v_cvt_pk_bf16_f32 v242, v164, v165
    v_cvt_pk_bf16_f32 v243, v166, v167
    v_mfma_f32_16x16x32_bf16 v[120:123], a[168:171], a[220:223], v[120:123]
    v_mul_f32 v168, s62, v168
    v_mul_f32 v169, s62, v169
    v_mfma_f32_16x16x32_bf16 v[28:31], a[172:175], a[208:211], v[28:31]
    v_mul_f32 v170, s62, v170
    v_mul_f32 v171, s62, v171
    v_mfma_f32_16x16x32_bf16 v[60:63], a[172:175], a[212:215], v[60:63]
    v_mul_f32 v172, s62, v172
    v_mul_f32 v173, s62, v173
    v_mfma_f32_16x16x32_bf16 v[92:95], a[172:175], a[216:219], v[92:95]
    v_mul_f32 v174, s62, v174
    v_mul_f32 v175, s62, v175
    v_mfma_f32_16x16x32_bf16 v[124:127], a[172:175], a[220:223], v[124:127]
    v_cvt_pk_bf16_f32 v244, v168, v169
    v_cvt_pk_bf16_f32 v245, v170, v171
    s_waitcnt vmcnt(10) lgkmcnt(0)
    s_barrier
    v_mfma_f32_16x16x32_bf16 v[0:3], a[176:179], a[224:227], v[0:3]
    s_mov_b32 s3, 40960
    ds_read_b128 a[144:147], v192 offset:0
    v_cvt_pk_bf16_f32 v246, v172, v173
    v_mfma_f32_16x16x32_bf16 v[4:7], a[180:183], a[224:227], v[4:7]
    s_add_u32 m0, s100, 122880
    ds_read_b128 a[160:163], v192 offset:4096
    v_cvt_pk_bf16_f32 v247, v174, v175
    v_mfma_f32_16x16x32_bf16 v[8:11], a[184:187], a[224:227], v[8:11]
    ds_read_b128 a[148:151], v193 offset:0
    buffer_load_dwordx4 v204, s[4:7], s3 offen nt lds
    v_mfma_f32_16x16x32_bf16 v[12:15], a[188:191], a[224:227], v[12:15]
    s_mov_b32 s3, 45056
    ds_read_b128 a[164:167], v193 offset:4096
    v_mul_f32 v176, s62, v176
    v_mfma_f32_16x16x32_bf16 v[16:19], a[192:195], a[224:227], v[16:19]
    s_add_u32 m0, s100, 126976
    ds_read_b128 a[152:155], v194 offset:0
    v_mul_f32 v177, s62, v177
    v_mfma_f32_16x16x32_bf16 v[20:23], a[196:199], a[224:227], v[20:23]
    ds_read_b128 a[168:171], v194 offset:4096
    v_mul_f32 v178, s62, v178
    v_mfma_f32_16x16x32_bf16 v[24:27], a[200:203], a[224:227], v[24:27]
    ds_read_b128 a[156:159], v195 offset:0
    v_mul_f32 v179, s62, v179
    v_mfma_f32_16x16x32_bf16 v[28:31], a[204:207], a[224:227], v[28:31]
    ds_read_b128 a[172:175], v195 offset:4096
    v_mul_f32 v180, s62, v180
    v_mfma_f32_16x16x32_bf16 v[32:35], a[176:179], a[228:231], v[32:35]
    v_mul_f32 v181, s62, v181
    v_mul_f32 v182, s62, v182
    v_mfma_f32_16x16x32_bf16 v[36:39], a[180:183], a[228:231], v[36:39]
    v_mul_f32 v183, s62, v183
    v_cvt_pk_bf16_f32 v248, v176, v177
    v_mfma_f32_16x16x32_bf16 v[40:43], a[184:187], a[228:231], v[40:43]
    v_cvt_pk_bf16_f32 v249, v178, v179
    v_cvt_pk_bf16_f32 v250, v180, v181
    v_mfma_f32_16x16x32_bf16 v[44:47], a[188:191], a[228:231], v[44:47]
    v_cvt_pk_bf16_f32 v251, v182, v183
    v_mul_f32 v184, s62, v184
    v_mfma_f32_16x16x32_bf16 v[48:51], a[192:195], a[228:231], v[48:51]
    v_mul_f32 v185, s62, v185
    v_mul_f32 v186, s62, v186
    v_mfma_f32_16x16x32_bf16 v[52:55], a[196:199], a[228:231], v[52:55]
    v_mul_f32 v187, s62, v187
    v_mul_f32 v188, s62, v188
    v_mfma_f32_16x16x32_bf16 v[56:59], a[200:203], a[228:231], v[56:59]
    v_mul_f32 v189, s62, v189
    v_mul_f32 v190, s62, v190
    v_mfma_f32_16x16x32_bf16 v[60:63], a[204:207], a[228:231], v[60:63]
    v_mul_f32 v191, s62, v191
    v_cvt_pk_bf16_f32 v252, v184, v185
    v_mfma_f32_16x16x32_bf16 v[64:67], a[176:179], a[232:235], v[64:67]
    v_cvt_pk_bf16_f32 v253, v186, v187
    v_cvt_pk_bf16_f32 v254, v188, v189
    v_mfma_f32_16x16x32_bf16 v[68:71], a[180:183], a[232:235], v[68:71]
    v_cvt_pk_bf16_f32 v255, v190, v191
    v_accvgpr_read_b32 v128, a0
    v_mfma_f32_16x16x32_bf16 v[72:75], a[184:187], a[232:235], v[72:75]
    buffer_load_dwordx4 v204, s[4:7], s3 offen nt lds
    v_accvgpr_read_b32 v129, a1
    v_mfma_f32_16x16x32_bf16 v[76:79], a[188:191], a[232:235], v[76:79]
    v_accvgpr_read_b32 v130, a2
    v_accvgpr_read_b32 v131, a3
    v_mfma_f32_16x16x32_bf16 v[80:83], a[192:195], a[232:235], v[80:83]
    v_accvgpr_read_b32 v132, a4
    v_accvgpr_read_b32 v133, a5
    v_mfma_f32_16x16x32_bf16 v[84:87], a[196:199], a[232:235], v[84:87]
    v_accvgpr_read_b32 v134, a6
    v_accvgpr_read_b32 v135, a7
    v_mfma_f32_16x16x32_bf16 v[88:91], a[200:203], a[232:235], v[88:91]
    v_mul_f32 v128, s62, v128
    v_mul_f32 v129, s62, v129
    v_mfma_f32_16x16x32_bf16 v[92:95], a[204:207], a[232:235], v[92:95]
    v_mul_f32 v130, s62, v130
    v_mul_f32 v131, s62, v131
    v_mfma_f32_16x16x32_bf16 v[96:99], a[176:179], a[236:239], v[96:99]
    v_mul_f32 v132, s62, v132
    v_mul_f32 v133, s62, v133
    v_mfma_f32_16x16x32_bf16 v[100:103], a[180:183], a[236:239], v[100:103]
    v_mul_f32 v134, s62, v134
    v_mul_f32 v135, s62, v135
    v_mfma_f32_16x16x32_bf16 v[104:107], a[184:187], a[236:239], v[104:107]
    v_cvt_pk_bf16_f32 v136, v128, v129
    v_cvt_pk_bf16_f32 v137, v130, v131
    v_mfma_f32_16x16x32_bf16 v[108:111], a[188:191], a[236:239], v[108:111]
    v_cvt_pk_bf16_f32 v138, v132, v133
    v_cvt_pk_bf16_f32 v139, v134, v135
    v_mfma_f32_16x16x32_bf16 v[112:115], a[192:195], a[236:239], v[112:115]
    ds_write_b128 v222, v[136:139] offset:0
    v_accvgpr_read_b32 v144, a8
    v_mfma_f32_16x16x32_bf16 v[116:119], a[196:199], a[236:239], v[116:119]
    v_accvgpr_read_b32 v145, a9
    v_accvgpr_read_b32 v146, a10
    v_mfma_f32_16x16x32_bf16 v[120:123], a[200:203], a[236:239], v[120:123]
    v_accvgpr_read_b32 v147, a11
    v_accvgpr_read_b32 v148, a12
    v_mfma_f32_16x16x32_bf16 v[124:127], a[204:207], a[236:239], v[124:127]
    v_accvgpr_read_b32 v149, a13
    v_accvgpr_read_b32 v150, a14
    s_mov_b32 s3, 16384
    s_add_u32 m0, s100, 16384
    s_nop 0
    buffer_load_dwordx4 v208, s[8:11], s3 offen nt lds
    v_accvgpr_read_b32 v151, a15
    v_pk_mul_f32 v[144:145], v[144:145], s[62:63]
    v_pk_mul_f32 v[146:147], v[146:147], s[62:63]
    v_pk_mul_f32 v[148:149], v[148:149], s[62:63]
    v_pk_mul_f32 v[150:151], v[150:151], s[62:63]
    v_cvt_pk_bf16_f32 v152, v144, v145
    v_cvt_pk_bf16_f32 v153, v146, v147
    v_cvt_pk_bf16_f32 v154, v148, v149
    v_cvt_pk_bf16_f32 v155, v150, v151
    ds_write_b128 v222, v[152:155] offset:1024
    v_accvgpr_read_b32 v160, a16
    v_accvgpr_read_b32 v161, a17
    v_accvgpr_read_b32 v162, a18
    v_accvgpr_read_b32 v163, a19
    v_accvgpr_read_b32 v164, a20
    v_accvgpr_read_b32 v165, a21
    v_accvgpr_read_b32 v166, a22
    v_accvgpr_read_b32 v167, a23
    v_pk_mul_f32 v[160:161], v[160:161], s[62:63]
    v_pk_mul_f32 v[162:163], v[162:163], s[62:63]
    v_pk_mul_f32 v[164:165], v[164:165], s[62:63]
    v_pk_mul_f32 v[166:167], v[166:167], s[62:63]
    v_cvt_pk_bf16_f32 v168, v160, v161
    v_cvt_pk_bf16_f32 v169, v162, v163
    v_cvt_pk_bf16_f32 v170, v164, v165
    v_cvt_pk_bf16_f32 v171, v166, v167
    ds_write_b128 v222, v[168:171] offset:2048
    v_accvgpr_read_b32 v176, a24
    v_accvgpr_read_b32 v177, a25
    v_accvgpr_read_b32 v178, a26
    v_accvgpr_read_b32 v179, a27
    v_accvgpr_read_b32 v180, a28
    v_accvgpr_read_b32 v181, a29
    v_accvgpr_read_b32 v182, a30
    v_accvgpr_read_b32 v183, a31
    v_pk_mul_f32 v[176:177], v[176:177], s[62:63]
    v_pk_mul_f32 v[178:179], v[178:179], s[62:63]
    v_pk_mul_f32 v[180:181], v[180:181], s[62:63]
    v_pk_mul_f32 v[182:183], v[182:183], s[62:63]
    v_cvt_pk_bf16_f32 v184, v176, v177
    v_cvt_pk_bf16_f32 v185, v178, v179
    v_cvt_pk_bf16_f32 v186, v180, v181
    v_cvt_pk_bf16_f32 v187, v182, v183
    ds_write_b128 v222, v[184:187] offset:3072
    v_accvgpr_read_b32 v128, a32
    v_accvgpr_read_b32 v129, a33
    v_accvgpr_read_b32 v130, a34
    v_accvgpr_read_b32 v131, a35
    v_accvgpr_read_b32 v132, a36
    v_accvgpr_read_b32 v133, a37
    v_accvgpr_read_b32 v134, a38
    v_accvgpr_read_b32 v135, a39
    v_pk_mul_f32 v[128:129], v[128:129], s[62:63]
    v_pk_mul_f32 v[130:131], v[130:131], s[62:63]
    v_pk_mul_f32 v[132:133], v[132:133], s[62:63]
    v_pk_mul_f32 v[134:135], v[134:135], s[62:63]
    v_cvt_pk_bf16_f32 v136, v128, v129
    s_mov_b32 s3, 20480
    s_add_u32 m0, s100, 20480
    s_nop 0
    buffer_load_dwordx4 v208, s[8:11], s3 offen nt lds
    v_cvt_pk_bf16_f32 v137, v130, v131
    v_cvt_pk_bf16_f32 v138, v132, v133
    v_cvt_pk_bf16_f32 v139, v134, v135
    ds_write_b128 v222, v[136:139] offset:4096
    v_accvgpr_read_b32 v144, a40
    v_accvgpr_read_b32 v145, a41
    v_accvgpr_read_b32 v146, a42
    v_accvgpr_read_b32 v147, a43
    v_accvgpr_read_b32 v148, a44
    v_accvgpr_read_b32 v149, a45
    v_accvgpr_read_b32 v150, a46
    v_accvgpr_read_b32 v151, a47
    v_pk_mul_f32 v[144:145], v[144:145], s[62:63]
    v_pk_mul_f32 v[146:147], v[146:147], s[62:63]
    v_pk_mul_f32 v[148:149], v[148:149], s[62:63]
    v_pk_mul_f32 v[150:151], v[150:151], s[62:63]
    v_cvt_pk_bf16_f32 v152, v144, v145
    v_cvt_pk_bf16_f32 v153, v146, v147
    v_cvt_pk_bf16_f32 v154, v148, v149
    v_cvt_pk_bf16_f32 v155, v150, v151
    ds_write_b128 v222, v[152:155] offset:5120
    v_accvgpr_read_b32 v160, a48
    v_accvgpr_read_b32 v161, a49
    v_accvgpr_read_b32 v162, a50
    v_accvgpr_read_b32 v163, a51
    v_accvgpr_read_b32 v164, a52
    v_accvgpr_read_b32 v165, a53
    v_accvgpr_read_b32 v166, a54
    v_accvgpr_read_b32 v167, a55
    v_pk_mul_f32 v[160:161], v[160:161], s[62:63]
    v_pk_mul_f32 v[162:163], v[162:163], s[62:63]
    v_pk_mul_f32 v[164:165], v[164:165], s[62:63]
    v_pk_mul_f32 v[166:167], v[166:167], s[62:63]
    v_cvt_pk_bf16_f32 v168, v160, v161
    v_cvt_pk_bf16_f32 v169, v162, v163
    v_cvt_pk_bf16_f32 v170, v164, v165
    v_cvt_pk_bf16_f32 v171, v166, v167
    ds_write_b128 v222, v[168:171] offset:6144
    v_accvgpr_read_b32 v176, a56
    v_accvgpr_read_b32 v177, a57
    v_accvgpr_read_b32 v178, a58
    v_accvgpr_read_b32 v179, a59
    v_accvgpr_read_b32 v180, a60
    v_accvgpr_read_b32 v181, a61
    v_accvgpr_read_b32 v182, a62
    v_accvgpr_read_b32 v183, a63
    v_pk_mul_f32 v[176:177], v[176:177], s[62:63]
    v_pk_mul_f32 v[178:179], v[178:179], s[62:63]
    v_pk_mul_f32 v[180:181], v[180:181], s[62:63]
    v_pk_mul_f32 v[182:183], v[182:183], s[62:63]
    v_cvt_pk_bf16_f32 v184, v176, v177
    v_cvt_pk_bf16_f32 v185, v178, v179
    v_cvt_pk_bf16_f32 v186, v180, v181
    v_cvt_pk_bf16_f32 v187, v182, v183
    ds_write_b128 v222, v[184:187] offset:7168
    s_mov_b32 s3, 24576
    s_add_u32 m0, s100, 24576
    s_nop 0
    buffer_load_dwordx4 v208, s[8:11], s3 offen nt lds
    v_pk_mul_f32 v[0:1], v[0:1], s[62:63]
    v_pk_mul_f32 v[2:3], v[2:3], s[62:63]
    v_pk_mul_f32 v[4:5], v[4:5], s[62:63]
    v_pk_mul_f32 v[6:7], v[6:7], s[62:63]
    v_pk_mul_f32 v[8:9], v[8:9], s[62:63]
    v_pk_mul_f32 v[10:11], v[10:11], s[62:63]
    v_pk_mul_f32 v[12:13], v[12:13], s[62:63]
    v_pk_mul_f32 v[14:15], v[14:15], s[62:63]
    v_pk_mul_f32 v[16:17], v[16:17], s[62:63]
    v_pk_mul_f32 v[18:19], v[18:19], s[62:63]
    v_pk_mul_f32 v[20:21], v[20:21], s[62:63]
    v_pk_mul_f32 v[22:23], v[22:23], s[62:63]
    v_pk_mul_f32 v[24:25], v[24:25], s[62:63]
    v_pk_mul_f32 v[26:27], v[26:27], s[62:63]
    v_pk_mul_f32 v[28:29], v[28:29], s[62:63]
    v_pk_mul_f32 v[30:31], v[30:31], s[62:63]
    s_waitcnt lgkmcnt(0)
    v_cvt_pk_bf16_f32 v128, v0, v1
    v_cvt_pk_bf16_f32 v129, v2, v3
    v_cvt_pk_bf16_f32 v130, v4, v5
    v_cvt_pk_bf16_f32 v131, v6, v7
    v_cvt_pk_bf16_f32 v132, v8, v9
    v_cvt_pk_bf16_f32 v133, v10, v11
    v_cvt_pk_bf16_f32 v134, v12, v13
    v_cvt_pk_bf16_f32 v135, v14, v15
    v_cvt_pk_bf16_f32 v136, v16, v17
    v_cvt_pk_bf16_f32 v137, v18, v19
    v_cvt_pk_bf16_f32 v138, v20, v21
    v_cvt_pk_bf16_f32 v139, v22, v23
    v_cvt_pk_bf16_f32 v140, v24, v25
    v_cvt_pk_bf16_f32 v141, v26, v27
    v_cvt_pk_bf16_f32 v142, v28, v29
    v_cvt_pk_bf16_f32 v143, v30, v31
    s_mov_b32 s3, 28672
    s_add_u32 m0, s100, 28672
    s_nop 0
    buffer_load_dwordx4 v208, s[8:11], s3 offen nt lds
    v_pk_mul_f32 v[32:33], v[32:33], s[62:63]
    v_pk_mul_f32 v[34:35], v[34:35], s[62:63]
    v_pk_mul_f32 v[36:37], v[36:37], s[62:63]
    v_pk_mul_f32 v[38:39], v[38:39], s[62:63]
    v_pk_mul_f32 v[40:41], v[40:41], s[62:63]
    v_pk_mul_f32 v[42:43], v[42:43], s[62:63]
    v_pk_mul_f32 v[44:45], v[44:45], s[62:63]
    v_pk_mul_f32 v[46:47], v[46:47], s[62:63]
    v_pk_mul_f32 v[48:49], v[48:49], s[62:63]
    v_pk_mul_f32 v[50:51], v[50:51], s[62:63]
    v_pk_mul_f32 v[52:53], v[52:53], s[62:63]
    v_pk_mul_f32 v[54:55], v[54:55], s[62:63]
    v_pk_mul_f32 v[56:57], v[56:57], s[62:63]
    v_pk_mul_f32 v[58:59], v[58:59], s[62:63]
    v_pk_mul_f32 v[60:61], v[60:61], s[62:63]
    v_pk_mul_f32 v[62:63], v[62:63], s[62:63]
    v_cvt_pk_bf16_f32 v144, v32, v33
    v_cvt_pk_bf16_f32 v145, v34, v35
    v_cvt_pk_bf16_f32 v146, v36, v37
    v_cvt_pk_bf16_f32 v147, v38, v39
    v_cvt_pk_bf16_f32 v148, v40, v41
    v_cvt_pk_bf16_f32 v149, v42, v43
    v_cvt_pk_bf16_f32 v150, v44, v45
    v_cvt_pk_bf16_f32 v151, v46, v47
    v_cvt_pk_bf16_f32 v152, v48, v49
    v_cvt_pk_bf16_f32 v153, v50, v51
    v_cvt_pk_bf16_f32 v154, v52, v53
    v_cvt_pk_bf16_f32 v155, v54, v55
    v_cvt_pk_bf16_f32 v156, v56, v57
    v_cvt_pk_bf16_f32 v157, v58, v59
    v_cvt_pk_bf16_f32 v158, v60, v61
    v_cvt_pk_bf16_f32 v159, v62, v63
    s_mov_b32 s3, 32768
    s_add_u32 m0, s100, 32768
    s_nop 0
    buffer_load_dwordx4 v208, s[8:11], s3 offen nt lds
    v_pk_mul_f32 v[64:65], v[64:65], s[62:63]
    v_pk_mul_f32 v[66:67], v[66:67], s[62:63]
    v_pk_mul_f32 v[68:69], v[68:69], s[62:63]
    v_pk_mul_f32 v[70:71], v[70:71], s[62:63]
    v_pk_mul_f32 v[72:73], v[72:73], s[62:63]
    v_pk_mul_f32 v[74:75], v[74:75], s[62:63]
    v_pk_mul_f32 v[76:77], v[76:77], s[62:63]
    v_pk_mul_f32 v[78:79], v[78:79], s[62:63]
    v_pk_mul_f32 v[80:81], v[80:81], s[62:63]
    v_pk_mul_f32 v[82:83], v[82:83], s[62:63]
    v_pk_mul_f32 v[84:85], v[84:85], s[62:63]
    v_pk_mul_f32 v[86:87], v[86:87], s[62:63]
    v_pk_mul_f32 v[88:89], v[88:89], s[62:63]
    v_pk_mul_f32 v[90:91], v[90:91], s[62:63]
    v_pk_mul_f32 v[92:93], v[92:93], s[62:63]
    v_pk_mul_f32 v[94:95], v[94:95], s[62:63]
    v_cvt_pk_bf16_f32 v160, v64, v65
    v_cvt_pk_bf16_f32 v161, v66, v67
    v_cvt_pk_bf16_f32 v162, v68, v69
    v_cvt_pk_bf16_f32 v163, v70, v71
    v_cvt_pk_bf16_f32 v164, v72, v73
    v_cvt_pk_bf16_f32 v165, v74, v75
    v_cvt_pk_bf16_f32 v166, v76, v77
    v_cvt_pk_bf16_f32 v167, v78, v79
    v_cvt_pk_bf16_f32 v168, v80, v81
    v_cvt_pk_bf16_f32 v169, v82, v83
    v_cvt_pk_bf16_f32 v170, v84, v85
    v_cvt_pk_bf16_f32 v171, v86, v87
    v_cvt_pk_bf16_f32 v172, v88, v89
    v_cvt_pk_bf16_f32 v173, v90, v91
    v_cvt_pk_bf16_f32 v174, v92, v93
    v_cvt_pk_bf16_f32 v175, v94, v95
    s_mov_b32 s3, 36864
    s_add_u32 m0, s100, 36864
    s_nop 0
    buffer_load_dwordx4 v208, s[8:11], s3 offen nt lds
    v_pk_mul_f32 v[96:97], v[96:97], s[62:63]
    v_pk_mul_f32 v[98:99], v[98:99], s[62:63]
    v_pk_mul_f32 v[100:101], v[100:101], s[62:63]
    v_pk_mul_f32 v[102:103], v[102:103], s[62:63]
    v_pk_mul_f32 v[104:105], v[104:105], s[62:63]
    v_pk_mul_f32 v[106:107], v[106:107], s[62:63]
    v_pk_mul_f32 v[108:109], v[108:109], s[62:63]
    v_pk_mul_f32 v[110:111], v[110:111], s[62:63]
    v_pk_mul_f32 v[112:113], v[112:113], s[62:63]
    v_pk_mul_f32 v[114:115], v[114:115], s[62:63]
    v_pk_mul_f32 v[116:117], v[116:117], s[62:63]
    v_pk_mul_f32 v[118:119], v[118:119], s[62:63]
    v_pk_mul_f32 v[120:121], v[120:121], s[62:63]
    v_pk_mul_f32 v[122:123], v[122:123], s[62:63]
    v_pk_mul_f32 v[124:125], v[124:125], s[62:63]
    v_pk_mul_f32 v[126:127], v[126:127], s[62:63]
    v_cvt_pk_bf16_f32 v176, v96, v97
    v_cvt_pk_bf16_f32 v177, v98, v99
    v_cvt_pk_bf16_f32 v178, v100, v101
    v_cvt_pk_bf16_f32 v179, v102, v103
    v_cvt_pk_bf16_f32 v180, v104, v105
    v_cvt_pk_bf16_f32 v181, v106, v107
    v_cvt_pk_bf16_f32 v182, v108, v109
    v_cvt_pk_bf16_f32 v183, v110, v111
    v_cvt_pk_bf16_f32 v184, v112, v113
    v_cvt_pk_bf16_f32 v185, v114, v115
    v_cvt_pk_bf16_f32 v186, v116, v117
    v_cvt_pk_bf16_f32 v187, v118, v119
    v_cvt_pk_bf16_f32 v188, v120, v121
    v_cvt_pk_bf16_f32 v189, v122, v123
    v_cvt_pk_bf16_f32 v190, v124, v125
    v_cvt_pk_bf16_f32 v191, v126, v127
    s_mov_b32 s46, 49152
    s_mov_b32 s47, 40960
    s_mov_b32 s31, 15
    s_mov_b32 s43, s100
    s_add_u32 s48, s100, 98304
    s_mov_b32 s28, 4369
    s_mov_b32 s29, 17476
    v_mov_b32 v218, v214
    buffer_atomic_cmpswap v[212:213], v218, s[12:15], s100 offen sc1
K1_PRO:
    s_waitcnt lgkmcnt(0)
    v_mfma_f32_16x16x32_bf16 v[0:3], a[144:147], v[128:131], 0
    ds_read_b128 a[176:179], v192 offset:8192
    v_mfma_f32_16x16x32_bf16 v[4:7], a[160:163], v[128:131], 0
    ds_read_b128 a[192:195], v192 offset:12288
    v_mfma_f32_16x16x32_bf16 v[0:3], a[148:151], v[132:135], v[0:3]
    ds_read_b128 a[180:183], v193 offset:8192
    v_mfma_f32_16x16x32_bf16 v[4:7], a[164:167], v[132:135], v[4:7]
    ds_read_b128 a[196:199], v193 offset:12288
    v_mfma_f32_16x16x32_bf16 v[0:3], a[152:155], v[136:139], v[0:3]
    s_xor_b32 s49, s46, 0xc000
    ds_read_b128 a[184:187], v194 offset:8192
    v_mfma_f32_16x16x32_bf16 v[4:7], a[168:171], v[136:139], v[4:7]
    s_and_b32 s49, s49, 0xf000
    ds_read_b128 a[200:203], v194 offset:12288
    v_mfma_f32_16x16x32_bf16 v[0:3], a[156:159], v[140:143], v[0:3]
    s_add_u32 m0, s49, s48
    ds_read_b128 a[188:191], v195 offset:8192
    v_mfma_f32_16x16x32_bf16 v[4:7], a[172:175], v[140:143], v[4:7]
    buffer_load_dwordx4 v204, s[4:7], s46 offen nt lds
    v_mfma_f32_16x16x32_bf16 v[32:35], a[144:147], v[144:147], 0
    s_add_u32 s46, s46, 4096
    ds_read_b128 a[204:207], v195 offset:12288
    v_mfma_f32_16x16x32_bf16 v[36:39], a[160:163], v[144:147], 0
    v_mfma_f32_16x16x32_bf16 v[32:35], a[148:151], v[148:151], v[32:35]
    v_mfma_f32_16x16x32_bf16 v[36:39], a[164:167], v[148:151], v[36:39]
    v_max3_f32 v28, v0, v1, v2
    v_max3_f32 v29, v3, v4, v5
    v_mfma_f32_16x16x32_bf16 v[32:35], a[152:155], v[152:155], v[32:35]
    v_max3_f32 v28, v28, v6, v7
    v_max_f32 v28, v28, v29
    v_mfma_f32_16x16x32_bf16 v[36:39], a[168:171], v[152:155], v[36:39]
    v_mov_b32 v29, v28
    v_mfma_f32_16x16x32_bf16 v[32:35], a[156:159], v[156:159], v[32:35]
    s_nop 0
    v_permlane16_swap_b32 v28, v29
    v_max_f32 v28, v28, v29
    v_mfma_f32_16x16x32_bf16 v[36:39], a[172:175], v[156:159], v[36:39]
    v_mov_b32 v29, v28
    v_mfma_f32_16x16x32_bf16 v[64:67], a[144:147], v[160:163], 0
    s_nop 0
    v_permlane32_swap_b32 v28, v29
    v_max_f32 v28, v28, v29
    v_mfma_f32_16x16x32_bf16 v[68:71], a[160:163], v[160:163], 0
    v_sub_f32 v24, 0, v28
    v_mov_b32 v25, v24
    v_mfma_f32_16x16x32_bf16 v[64:67], a[148:151], v[164:167], v[64:67]
    s_and_b32 s49, s47, 0xf000
    v_mov_b32 v26, v24
    v_mov_b32 v27, v24
    v_mfma_f32_16x16x32_bf16 v[68:71], a[164:167], v[164:167], v[68:71]
    s_add_u32 m0, s49, s43
    v_add_f32 v0, v0, v24
    v_add_f32 v1, v1, v24
    v_mfma_f32_16x16x32_bf16 v[64:67], a[152:155], v[168:171], v[64:67]
    buffer_load_dwordx4 v208, s[8:11], s47 offen nt lds
    v_mfma_f32_16x16x32_bf16 v[68:71], a[168:171], v[168:171], v[68:71]
    s_add_u32 s47, s47, 4096
    v_add_f32 v2, v2, v24
    v_add_f32 v3, v3, v24
    v_mfma_f32_16x16x32_bf16 v[64:67], a[156:159], v[172:175], v[64:67]
    v_add_f32 v4, v4, v24
    v_add_f32 v5, v5, v24
    v_mfma_f32_16x16x32_bf16 v[68:71], a[172:175], v[172:175], v[68:71]
    v_add_f32 v6, v6, v24
    v_add_f32 v7, v7, v24
    v_mfma_f32_16x16x32_bf16 v[96:99], a[144:147], v[176:179], 0
    v_max3_f32 v60, v32, v33, v34
    v_max3_f32 v61, v35, v36, v37
    v_mfma_f32_16x16x32_bf16 v[100:103], a[160:163], v[176:179], 0
    v_max3_f32 v60, v60, v38, v39
    v_max_f32 v60, v60, v61
    v_mfma_f32_16x16x32_bf16 v[96:99], a[148:151], v[180:183], v[96:99]
    v_mov_b32 v61, v60
    v_mfma_f32_16x16x32_bf16 v[100:103], a[164:167], v[180:183], v[100:103]
    s_nop 0
    v_permlane16_swap_b32 v60, v61
    v_max_f32 v60, v60, v61
    v_mfma_f32_16x16x32_bf16 v[96:99], a[152:155], v[184:187], v[96:99]
    v_mov_b32 v61, v60
    v_mfma_f32_16x16x32_bf16 v[100:103], a[168:171], v[184:187], v[100:103]
    s_nop 0
    v_permlane32_swap_b32 v60, v61
    v_max_f32 v60, v60, v61
    v_mfma_f32_16x16x32_bf16 v[96:99], a[156:159], v[188:191], v[96:99]
    s_xor_b32 s49, s46, 0xc000
    v_sub_f32 v56, 0, v60
    v_mov_b32 v57, v56
    v_mfma_f32_16x16x32_bf16 v[100:103], a[172:175], v[188:191], v[100:103]
    s_and_b32 s49, s49, 0xf000
    v_mov_b32 v58, v56
    v_mov_b32 v59, v56
    v_mfma_f32_32x32x16_bf16 a[0:15], a[244:247], a[244:247], 0
    s_add_u32 m0, s49, s48
    v_add_f32 v32, v32, v56
    v_add_f32 v33, v33, v56
    v_add_f32 v34, v34, v56
    v_add_f32 v35, v35, v56
    v_add_f32 v36, v36, v56
    v_add_f32 v37, v37, v56
    v_mfma_f32_32x32x16_bf16 a[16:31], a[244:247], a[244:247], 0
    buffer_load_dwordx4 v204, s[4:7], s46 offen nt lds
    v_mfma_f32_32x32x16_bf16 a[32:47], a[244:247], a[244:247], 0
    s_add_u32 s46, s46, 4096
    v_add_f32 v38, v38, v56
    v_add_f32 v39, v39, v56
    v_max3_f32 v92, v64, v65, v66
    v_max3_f32 v93, v67, v68, v69
    v_max3_f32 v92, v92, v70, v71
    v_max_f32 v92, v92, v93
    v_mfma_f32_32x32x16_bf16 a[48:63], a[244:247], a[244:247], 0
    v_mov_b32 v93, v92
    v_mfma_f32_32x32x16_bf16 a[64:79], a[244:247], a[244:247], 0
    s_nop 0
    v_permlane16_swap_b32 v92, v93
    v_max_f32 v92, v92, v93
    v_mov_b32 v93, v92
    v_mfma_f32_32x32x16_bf16 a[80:95], a[244:247], a[244:247], 0
    s_nop 0
    v_permlane32_swap_b32 v92, v93
    v_max_f32 v92, v92, v93
    v_sub_f32 v88, 0, v92
    v_mov_b32 v89, v88
    v_mov_b32 v90, v88
    v_mov_b32 v91, v88
    v_mfma_f32_32x32x16_bf16 a[96:111], a[244:247], a[244:247], 0
    v_add_f32 v64, v64, v88
    v_add_f32 v65, v65, v88
    v_add_f32 v66, v66, v88
    v_add_f32 v67, v67, v88
    v_add_f32 v68, v68, v88
    v_add_f32 v69, v69, v88
    v_mfma_f32_32x32x16_bf16 a[112:127], a[244:247], a[244:247], 0
    v_add_f32 v70, v70, v88
    v_add_f32 v71, v71, v88
    v_max3_f32 v124, v96, v97, v98
    v_max3_f32 v125, v99, v100, v101
    v_max3_f32 v124, v124, v102, v103
    v_max_f32 v124, v124, v125
    v_mfma_f32_32x32x16_bf16 a[128:143], a[244:247], a[244:247], 0
    v_mov_b32 v125, v124
    s_waitcnt lgkmcnt(0)
    v_mfma_f32_16x16x32_bf16 v[8:11], a[176:179], v[128:131], v[24:27]
    s_and_b32 s49, s47, 0xf000
    v_permlane16_swap_b32 v124, v125
    v_max_f32 v124, v124, v125
    v_mfma_f32_16x16x32_bf16 v[12:15], a[192:195], v[128:131], v[24:27]
    s_add_u32 m0, s49, s43
    v_mov_b32 v125, v124
    v_mfma_f32_16x16x32_bf16 v[8:11], a[180:183], v[132:135], v[8:11]
    buffer_load_dwordx4 v208, s[8:11], s47 offen nt lds
    v_mfma_f32_16x16x32_bf16 v[12:15], a[196:199], v[132:135], v[12:15]
    s_add_u32 s47, s47, 4096
    v_permlane32_swap_b32 v124, v125
    v_max_f32 v124, v124, v125
    v_mfma_f32_16x16x32_bf16 v[8:11], a[184:187], v[136:139], v[8:11]
    v_sub_f32 v120, s61, v124
    v_mov_b32 v121, v120
    v_mfma_f32_16x16x32_bf16 v[12:15], a[200:203], v[136:139], v[12:15]
    v_mov_b32 v122, v120
    v_mov_b32 v123, v120
    v_mfma_f32_16x16x32_bf16 v[8:11], a[188:191], v[140:143], v[8:11]
    v_add_f32 v96, v96, v120
    v_add_f32 v97, v97, v120
    v_mfma_f32_16x16x32_bf16 v[12:15], a[204:207], v[140:143], v[12:15]
    v_add_f32 v98, v98, v120
    v_add_f32 v99, v99, v120
    v_mfma_f32_16x16x32_bf16 v[40:43], a[176:179], v[144:147], v[56:59]
    v_add_f32 v100, v100, v120
    v_add_f32 v101, v101, v120
    v_mfma_f32_16x16x32_bf16 v[44:47], a[192:195], v[144:147], v[56:59]
    v_add_f32 v102, v102, v120
    v_add_f32 v103, v103, v120
    v_mfma_f32_16x16x32_bf16 v[40:43], a[180:183], v[148:151], v[40:43]
    v_exp_f32 v0, v0
    v_mfma_f32_16x16x32_bf16 v[44:47], a[196:199], v[148:151], v[44:47]
    s_xor_b32 s49, s46, 0xc000
    v_exp_f32 v1, v1
    v_mfma_f32_16x16x32_bf16 v[40:43], a[184:187], v[152:155], v[40:43]
    s_and_b32 s49, s49, 0xf000
    v_exp_f32 v2, v2
    v_mfma_f32_16x16x32_bf16 v[44:47], a[200:203], v[152:155], v[44:47]
    s_add_u32 m0, s49, s48
    v_exp_f32 v3, v3
    v_mfma_f32_16x16x32_bf16 v[40:43], a[188:191], v[156:159], v[40:43]
    buffer_load_dwordx4 v204, s[4:7], s46 offen nt lds
    v_mfma_f32_16x16x32_bf16 v[44:47], a[204:207], v[156:159], v[44:47]
    s_add_u32 s46, s46, 4096
    v_cvt_pk_bf16_f32 v16, v0, v1
    v_mfma_f32_16x16x32_bf16 v[72:75], a[176:179], v[160:163], v[88:91]
    v_exp_f32 v4, v4
    v_mfma_f32_16x16x32_bf16 v[76:79], a[192:195], v[160:163], v[88:91]
    v_exp_f32 v5, v5
    v_mfma_f32_16x16x32_bf16 v[72:75], a[180:183], v[164:167], v[72:75]
    v_cvt_pk_bf16_f32 v17, v2, v3
    v_mfma_f32_16x16x32_bf16 v[76:79], a[196:199], v[164:167], v[76:79]
    v_exp_f32 v6, v6
    v_mfma_f32_16x16x32_bf16 v[72:75], a[184:187], v[168:171], v[72:75]
    v_exp_f32 v7, v7
    v_mfma_f32_16x16x32_bf16 v[76:79], a[200:203], v[168:171], v[76:79]
    v_cvt_pk_bf16_f32 v18, v4, v5
    v_mfma_f32_16x16x32_bf16 v[72:75], a[188:191], v[172:175], v[72:75]
    v_exp_f32 v32, v32
    v_mfma_f32_16x16x32_bf16 v[76:79], a[204:207], v[172:175], v[76:79]
    s_xor_b32 s49, s46, 0xc000
    v_exp_f32 v33, v33
    v_mfma_f32_16x16x32_bf16 v[104:107], a[176:179], v[176:179], v[120:123]
    s_and_b32 s49, s49, 0xf000
    v_cvt_pk_bf16_f32 v19, v6, v7
    v_mfma_f32_16x16x32_bf16 v[108:111], a[192:195], v[176:179], v[120:123]
    s_add_u32 m0, s49, s48
    v_exp_f32 v34, v34
    v_mfma_f32_16x16x32_bf16 v[104:107], a[180:183], v[180:183], v[104:107]
    buffer_load_dwordx4 v204, s[4:7], s46 offen nt lds
    v_mfma_f32_16x16x32_bf16 v[108:111], a[196:199], v[180:183], v[108:111]
    s_add_u32 s46, s46, 4096
    v_exp_f32 v35, v35
    v_mfma_f32_16x16x32_bf16 v[104:107], a[184:187], v[184:187], v[104:107]
    v_cvt_pk_bf16_f32 v48, v32, v33
    v_mfma_f32_16x16x32_bf16 v[108:111], a[200:203], v[184:187], v[108:111]
    v_exp_f32 v36, v36
    v_mfma_f32_16x16x32_bf16 v[104:107], a[188:191], v[188:191], v[104:107]
    v_exp_f32 v37, v37
    v_mfma_f32_16x16x32_bf16 v[108:111], a[204:207], v[188:191], v[108:111]
    v_cvt_pk_bf16_f32 v49, v34, v35
    v_subrev_u32 v192, 16384, v192
    v_subrev_u32 v193, 16384, v193
    v_subrev_u32 v194, 16384, v194
    v_subrev_u32 v195, 16384, v195
    s_waitcnt vmcnt(8) lgkmcnt(0)
    s_barrier
    s_xor_b32 s49, s46, 0xc000
    s_and_b32 s49, s49, 0xf000
    s_add_u32 m0, s49, s48
    ds_read_b128 a[144:147], v192 offset:0
    ds_read_b128 a[160:163], v192 offset:4096
    ds_read_b128 a[148:151], v193 offset:0
    ds_read_b128 a[164:167], v193 offset:4096
    buffer_load_dwordx4 v204, s[4:7], s46 offen nt lds
    s_add_u32 s46, s46, 4096
    s_xor_b32 s49, s46, 0xc000
    s_and_b32 s49, s49, 0xf000
    s_add_u32 m0, s49, s48
    ds_read_b128 a[152:155], v194 offset:0
    ds_read_b128 a[168:171], v194 offset:4096
    ds_read_b128 a[156:159], v195 offset:0
    ds_read_b128 a[172:175], v195 offset:4096
    buffer_load_dwordx4 v204, s[4:7], s46 offen nt lds
    s_add_u32 s46, s46, 4096
    s_mov_b32 s52, 32768
    s_mov_b32 s53, 0
    s_mov_b32 s45, 0
    v_exp_f32 v38, v38
    v_exp_f32 v39, v39
    v_cvt_pk_bf16_f32 v50, v36, v37
    v_exp_f32 v64, v64
    v_exp_f32 v65, v65
    v_cvt_pk_bf16_f32 v51, v38, v39
    v_exp_f32 v66, v66
    v_exp_f32 v67, v67
    v_cvt_pk_bf16_f32 v80, v64, v65
    v_exp_f32 v68, v68
    v_exp_f32 v69, v69
    v_cvt_pk_bf16_f32 v81, v66, v67
    v_exp_f32 v70, v70
    v_exp_f32 v71, v71
    v_cvt_pk_bf16_f32 v82, v68, v69
    v_exp_f32 v96, v96
    v_exp_f32 v97, v97
    v_cvt_pk_bf16_f32 v83, v70, v71
    v_exp_f32 v98, v98
    v_exp_f32 v99, v99
    v_cvt_pk_bf16_f32 v112, v96, v97
    v_exp_f32 v100, v100
    v_exp_f32 v101, v101
    v_cvt_pk_bf16_f32 v113, v98, v99
    v_exp_f32 v102, v102
    v_exp_f32 v103, v103
    v_cvt_pk_bf16_f32 v114, v100, v101
    v_cvt_pk_bf16_f32 v115, v102, v103
    s_waitcnt lgkmcnt(0)
.p2align 6
K1_LOOP:
    v_mfma_f32_16x16x32_bf16 v[0:3], a[144:147], v[128:131], v[24:27]
    v_exp_f32 v8, v8
    v_mfma_f32_16x16x32_bf16 v[32:35], a[144:147], v[144:147], v[56:59]
    ds_read_b64_tr_b16 a[176:177], v196 offset:0
    ds_read_b64_tr_b16 a[178:179], v196 offset:4096
    v_mfma_f32_16x16x32_bf16 v[64:67], a[144:147], v[160:163], v[88:91]
    v_exp_f32 v9, v9
    v_mfma_f32_16x16x32_bf16 v[96:99], a[144:147], v[176:179], v[120:123]
    s_xor_b32 s49, s46, 0xc000
    ds_read_b64_tr_b16 a[180:181], v197 offset:0
    v_cvt_pk_bf16_f32 v20, v8, v9
    v_mfma_f32_16x16x32_bf16 v[4:7], a[160:163], v[128:131], v[24:27]
    s_and_b32 s49, s49, 0xf000
    v_exp_f32 v10, v10
    v_mfma_f32_16x16x32_bf16 v[36:39], a[160:163], v[144:147], v[56:59]
    s_add_u32 m0, s49, s48
    ds_read_b64_tr_b16 a[182:183], v197 offset:4096
    ds_read_b64_tr_b16 a[184:185], v198 offset:0
    v_mfma_f32_16x16x32_bf16 v[68:71], a[160:163], v[160:163], v[88:91]
    s_bitcmp1_b32 s28, s45
    v_exp_f32 v11, v11
    v_mfma_f32_16x16x32_bf16 v[100:103], a[160:163], v[176:179], v[120:123]
    s_cselect_b32 s30, 0x40000000, s46
    ds_read_b64_tr_b16 a[186:187], v198 offset:4096
    v_cvt_pk_bf16_f32 v21, v10, v11
    v_mfma_f32_16x16x32_bf16 v[0:3], a[148:151], v[132:135], v[0:3]
    s_cselect_b32 s101, 0, 4096
    v_exp_f32 v12, v12
    v_mfma_f32_16x16x32_bf16 v[32:35], a[148:151], v[148:151], v[32:35]
    buffer_load_dwordx4 v204, s[4:7], s30 offen nt lds
    v_mfma_f32_16x16x32_bf16 v[64:67], a[148:151], v[164:167], v[64:67]
    s_add_u32 s46, s46, s101
    v_exp_f32 v13, v13
    v_mfma_f32_16x16x32_bf16 v[96:99], a[148:151], v[180:183], v[96:99]
    ds_read_b64_tr_b16 a[188:189], v199 offset:0
    v_cvt_pk_bf16_f32 v22, v12, v13
    v_mfma_f32_16x16x32_bf16 v[4:7], a[164:167], v[132:135], v[4:7]
    v_exp_f32 v14, v14
    v_mfma_f32_16x16x32_bf16 v[36:39], a[164:167], v[148:151], v[36:39]
    ds_read_b64_tr_b16 a[190:191], v199 offset:4096
    ds_read_b64_tr_b16 a[192:193], v200 offset:0
    v_mfma_f32_16x16x32_bf16 v[68:71], a[164:167], v[164:167], v[68:71]
    v_exp_f32 v15, v15
    v_mfma_f32_16x16x32_bf16 v[100:103], a[164:167], v[180:183], v[100:103]
    ds_read_b64_tr_b16 a[194:195], v200 offset:4096
    v_cvt_pk_bf16_f32 v23, v14, v15
    v_mfma_f32_16x16x32_bf16 v[0:3], a[152:155], v[136:139], v[0:3]
    v_exp_f32 v40, v40
    v_mfma_f32_16x16x32_bf16 v[32:35], a[152:155], v[152:155], v[32:35]
    ds_read_b64_tr_b16 a[196:197], v201 offset:0
    ds_read_b64_tr_b16 a[198:199], v201 offset:4096
    v_mfma_f32_16x16x32_bf16 v[64:67], a[152:155], v[168:171], v[64:67]
    v_exp_f32 v41, v41
    v_mfma_f32_16x16x32_bf16 v[96:99], a[152:155], v[184:187], v[96:99]
    ds_read_b64_tr_b16 a[200:201], v202 offset:0
    v_cvt_pk_bf16_f32 v52, v40, v41
    v_mfma_f32_16x16x32_bf16 v[4:7], a[168:171], v[136:139], v[4:7]
    v_exp_f32 v42, v42
    v_mfma_f32_16x16x32_bf16 v[36:39], a[168:171], v[152:155], v[36:39]
    ds_read_b64_tr_b16 a[202:203], v202 offset:4096
    ds_read_b64_tr_b16 a[204:205], v203 offset:0
    v_mfma_f32_16x16x32_bf16 v[68:71], a[168:171], v[168:171], v[68:71]
    s_xor_b32 s49, s46, 0xc000
    v_exp_f32 v43, v43
    v_mfma_f32_16x16x32_bf16 v[100:103], a[168:171], v[184:187], v[100:103]
    s_and_b32 s49, s49, 0xf000
    ds_read_b64_tr_b16 a[206:207], v203 offset:4096
    v_cvt_pk_bf16_f32 v53, v42, v43
    v_mfma_f32_16x16x32_bf16 v[0:3], a[156:159], v[140:143], v[0:3]
    s_add_u32 m0, s49, s48
    v_exp_f32 v44, v44
    v_mfma_f32_16x16x32_bf16 v[32:35], a[156:159], v[156:159], v[32:35]
    buffer_load_dwordx4 v204, s[4:7], s46 offen nt lds
    v_mfma_f32_16x16x32_bf16 v[64:67], a[156:159], v[172:175], v[64:67]
    s_add_u32 s46, s46, 4096
    v_exp_f32 v45, v45
    v_mfma_f32_16x16x32_bf16 v[96:99], a[156:159], v[188:191], v[96:99]
    v_cvt_pk_bf16_f32 v54, v44, v45
    v_mfma_f32_16x16x32_bf16 v[4:7], a[172:175], v[140:143], v[4:7]
    v_exp_f32 v46, v46
    v_mfma_f32_16x16x32_bf16 v[36:39], a[172:175], v[156:159], v[36:39]
    v_mfma_f32_16x16x32_bf16 v[68:71], a[172:175], v[172:175], v[68:71]
    v_exp_f32 v47, v47
    v_mfma_f32_16x16x32_bf16 v[100:103], a[172:175], v[188:191], v[100:103]
    s_waitcnt lgkmcnt(0)
    v_cvt_pk_bf16_f32 v55, v46, v47
    v_mfma_f32_16x16x32_bf16 a[0:3], a[176:179], v[16:19], a[0:3]
    v_exp_f32 v72, v72
    v_mfma_f32_16x16x32_bf16 a[32:35], a[176:179], v[48:51], a[32:35]
    ds_read_b128 a[144:147], v192 offset:8192
    v_mfma_f32_16x16x32_bf16 a[64:67], a[176:179], v[80:83], a[64:67]
    v_exp_f32 v73, v73
    v_mfma_f32_16x16x32_bf16 a[96:99], a[176:179], v[112:115], a[96:99]
    ds_read_b128 a[160:163], v192 offset:12288
    v_cvt_pk_bf16_f32 v84, v72, v73
    v_mfma_f32_16x16x32_bf16 a[4:7], a[180:183], v[16:19], a[4:7]
    v_exp_f32 v74, v74
    v_mfma_f32_16x16x32_bf16 a[36:39], a[180:183], v[48:51], a[36:39]
    ds_read_b128 a[148:151], v193 offset:8192
    v_mfma_f32_16x16x32_bf16 a[68:71], a[180:183], v[80:83], a[68:71]
    v_exp_f32 v75, v75
    v_mfma_f32_16x16x32_bf16 a[100:103], a[180:183], v[112:115], a[100:103]
    s_and_b32 s49, s47, 0xf000
    ds_read_b128 a[164:167], v193 offset:12288
    v_cvt_pk_bf16_f32 v85, v74, v75
    v_mfma_f32_16x16x32_bf16 a[8:11], a[184:187], v[16:19], a[8:11]
    s_add_u32 m0, s49, s43
    v_exp_f32 v76, v76
    v_mfma_f32_16x16x32_bf16 a[40:43], a[184:187], v[48:51], a[40:43]
    buffer_load_dwordx4 v208, s[8:11], s47 offen nt lds
    v_mfma_f32_16x16x32_bf16 a[72:75], a[184:187], v[80:83], a[72:75]
    s_add_u32 s47, s47, 4096
    v_exp_f32 v77, v77
    v_mfma_f32_16x16x32_bf16 a[104:107], a[184:187], v[112:115], a[104:107]
    ds_read_b128 a[152:155], v194 offset:8192
    v_cvt_pk_bf16_f32 v86, v76, v77
    v_mfma_f32_16x16x32_bf16 a[12:15], a[188:191], v[16:19], a[12:15]
    s_sub_u32 s54, s52, 16384
    v_exp_f32 v78, v78
    v_mfma_f32_16x16x32_bf16 a[44:47], a[188:191], v[48:51], a[44:47]
    s_and_b32 s54, s54, 0xffff
    ds_read_b128 a[168:171], v194 offset:12288
    v_mfma_f32_16x16x32_bf16 a[76:79], a[188:191], v[80:83], a[76:79]
    s_sub_u32 s50, s54, s52
    v_exp_f32 v79, v79
    v_mfma_f32_16x16x32_bf16 a[108:111], a[188:191], v[112:115], a[108:111]
    s_mov_b32 s52, s54
    ds_read_b128 a[156:159], v195 offset:8192
    v_cvt_pk_bf16_f32 v87, v78, v79
    v_mfma_f32_16x16x32_bf16 a[16:19], a[192:195], v[16:19], a[16:19]
    s_add_u32 s54, s53, 16384
    v_exp_f32 v104, v104
    v_mfma_f32_16x16x32_bf16 a[48:51], a[192:195], v[48:51], a[48:51]
    s_and_b32 s54, s54, 0xffff
    ds_read_b128 a[172:175], v195 offset:12288
    v_mfma_f32_16x16x32_bf16 a[80:83], a[192:195], v[80:83], a[80:83]
    s_sub_u32 s51, s54, s53
    v_exp_f32 v105, v105
    v_mfma_f32_16x16x32_bf16 a[112:115], a[192:195], v[112:115], a[112:115]
    s_mov_b32 s53, s54
    v_cvt_pk_bf16_f32 v116, v104, v105
    v_mfma_f32_16x16x32_bf16 a[20:23], a[196:199], v[16:19], a[20:23]
    s_add_u32 s45, s45, 1
    v_exp_f32 v106, v106
    v_mfma_f32_16x16x32_bf16 a[52:55], a[196:199], v[48:51], a[52:55]
    v_mfma_f32_16x16x32_bf16 a[84:87], a[196:199], v[80:83], a[84:87]
    v_exp_f32 v107, v107
    v_mfma_f32_16x16x32_bf16 a[116:119], a[196:199], v[112:115], a[116:119]
    s_and_b32 s49, s47, 0xf000
    v_cvt_pk_bf16_f32 v117, v106, v107
    v_mfma_f32_16x16x32_bf16 a[24:27], a[200:203], v[16:19], a[24:27]
    s_add_u32 m0, s49, s43
    v_exp_f32 v108, v108
    v_mfma_f32_16x16x32_bf16 a[56:59], a[200:203], v[48:51], a[56:59]
    buffer_load_dwordx4 v208, s[8:11], s47 offen nt lds
    v_mfma_f32_16x16x32_bf16 a[88:91], a[200:203], v[80:83], a[88:91]
    s_add_u32 s47, s47, 4096
    v_exp_f32 v109, v109
    v_mfma_f32_16x16x32_bf16 a[120:123], a[200:203], v[112:115], a[120:123]
    v_cvt_pk_bf16_f32 v118, v108, v109
    v_mfma_f32_16x16x32_bf16 a[28:31], a[204:207], v[16:19], a[28:31]
    v_exp_f32 v110, v110
    v_mfma_f32_16x16x32_bf16 a[60:63], a[204:207], v[48:51], a[60:63]
    v_mfma_f32_16x16x32_bf16 a[92:95], a[204:207], v[80:83], a[92:95]
    v_exp_f32 v111, v111
    v_mfma_f32_16x16x32_bf16 a[124:127], a[204:207], v[112:115], a[124:127]
    v_cvt_pk_bf16_f32 v119, v110, v111
    v_mfma_f32_16x16x32_bf16 a[128:131], a[240:243], v[16:19], a[128:131]
    v_add_u32 v192, s50, v192
    v_add_u32 v193, s50, v193
    v_mfma_f32_16x16x32_bf16 a[132:135], a[240:243], v[48:51], a[132:135]
    v_add_u32 v194, s50, v194
    v_add_u32 v195, s50, v195
    v_mfma_f32_16x16x32_bf16 a[136:139], a[240:243], v[80:83], a[136:139]
    v_mfma_f32_16x16x32_bf16 a[140:143], a[240:243], v[112:115], a[140:143]
    s_waitcnt lgkmcnt(0)
    v_mfma_f32_16x16x32_bf16 v[8:11], a[144:147], v[128:131], v[24:27]
    v_exp_f32 v0, v0
    v_mfma_f32_16x16x32_bf16 v[40:43], a[144:147], v[144:147], v[56:59]
    ds_read_b64_tr_b16 a[176:177], v196 offset:8192
    ds_read_b64_tr_b16 a[178:179], v196 offset:12288
    v_mfma_f32_16x16x32_bf16 v[72:75], a[144:147], v[160:163], v[88:91]
    v_exp_f32 v1, v1
    v_mfma_f32_16x16x32_bf16 v[104:107], a[144:147], v[176:179], v[120:123]
    ds_read_b64_tr_b16 a[180:181], v197 offset:8192
    v_cvt_pk_bf16_f32 v16, v0, v1
    v_mfma_f32_16x16x32_bf16 v[12:15], a[160:163], v[128:131], v[24:27]
    s_and_b32 s49, s47, 0xf000
    v_exp_f32 v2, v2
    v_mfma_f32_16x16x32_bf16 v[44:47], a[160:163], v[144:147], v[56:59]
    s_add_u32 m0, s49, s43
    ds_read_b64_tr_b16 a[182:183], v197 offset:12288
    ds_read_b64_tr_b16 a[184:185], v198 offset:8192
    v_mfma_f32_16x16x32_bf16 v[76:79], a[160:163], v[160:163], v[88:91]
    s_bitcmp1_b32 s29, s45
    v_exp_f32 v3, v3
    v_mfma_f32_16x16x32_bf16 v[108:111], a[160:163], v[176:179], v[120:123]
    s_cselect_b32 s30, 0x40000000, s47
    ds_read_b64_tr_b16 a[186:187], v198 offset:12288
    v_cvt_pk_bf16_f32 v17, v2, v3
    v_mfma_f32_16x16x32_bf16 v[8:11], a[148:151], v[132:135], v[8:11]
    s_cselect_b32 s101, 0, 4096
    v_exp_f32 v4, v4
    v_mfma_f32_16x16x32_bf16 v[40:43], a[148:151], v[148:151], v[40:43]
    buffer_load_dwordx4 v208, s[8:11], s30 offen nt lds
    v_mfma_f32_16x16x32_bf16 v[72:75], a[148:151], v[164:167], v[72:75]
    s_add_u32 s47, s47, s101
    v_exp_f32 v5, v5
    v_mfma_f32_16x16x32_bf16 v[104:107], a[148:151], v[180:183], v[104:107]
    ds_read_b64_tr_b16 a[188:189], v199 offset:8192
    v_cvt_pk_bf16_f32 v18, v4, v5
    v_mfma_f32_16x16x32_bf16 v[12:15], a[164:167], v[132:135], v[12:15]
    v_exp_f32 v6, v6
    v_mfma_f32_16x16x32_bf16 v[44:47], a[164:167], v[148:151], v[44:47]
    ds_read_b64_tr_b16 a[190:191], v199 offset:12288
    ds_read_b64_tr_b16 a[192:193], v200 offset:8192
    v_mfma_f32_16x16x32_bf16 v[76:79], a[164:167], v[164:167], v[76:79]
    v_exp_f32 v7, v7
    v_mfma_f32_16x16x32_bf16 v[108:111], a[164:167], v[180:183], v[108:111]
    ds_read_b64_tr_b16 a[194:195], v200 offset:12288
    v_cvt_pk_bf16_f32 v19, v6, v7
    v_mfma_f32_16x16x32_bf16 v[8:11], a[152:155], v[136:139], v[8:11]
    v_exp_f32 v32, v32
    v_mfma_f32_16x16x32_bf16 v[40:43], a[152:155], v[152:155], v[40:43]
    ds_read_b64_tr_b16 a[196:197], v201 offset:8192
    ds_read_b64_tr_b16 a[198:199], v201 offset:12288
    v_mfma_f32_16x16x32_bf16 v[72:75], a[152:155], v[168:171], v[72:75]
    v_exp_f32 v33, v33
    v_mfma_f32_16x16x32_bf16 v[104:107], a[152:155], v[184:187], v[104:107]
    ds_read_b64_tr_b16 a[200:201], v202 offset:8192
    v_cvt_pk_bf16_f32 v48, v32, v33
    v_mfma_f32_16x16x32_bf16 v[12:15], a[168:171], v[136:139], v[12:15]
    v_exp_f32 v34, v34
    v_mfma_f32_16x16x32_bf16 v[44:47], a[168:171], v[152:155], v[44:47]
    ds_read_b64_tr_b16 a[202:203], v202 offset:12288
    ds_read_b64_tr_b16 a[204:205], v203 offset:8192
    v_mfma_f32_16x16x32_bf16 v[76:79], a[168:171], v[168:171], v[76:79]
    v_exp_f32 v35, v35
    v_mfma_f32_16x16x32_bf16 v[108:111], a[168:171], v[184:187], v[108:111]
    s_and_b32 s49, s47, 0xf000
    ds_read_b64_tr_b16 a[206:207], v203 offset:12288
    v_cvt_pk_bf16_f32 v49, v34, v35
    v_mfma_f32_16x16x32_bf16 v[8:11], a[156:159], v[140:143], v[8:11]
    s_add_u32 m0, s49, s43
    v_exp_f32 v36, v36
    v_mfma_f32_16x16x32_bf16 v[40:43], a[156:159], v[156:159], v[40:43]
    buffer_load_dwordx4 v208, s[8:11], s47 offen nt lds
    v_mfma_f32_16x16x32_bf16 v[72:75], a[156:159], v[172:175], v[72:75]
    s_add_u32 s47, s47, 4096
    v_exp_f32 v37, v37
    v_mfma_f32_16x16x32_bf16 v[104:107], a[156:159], v[188:191], v[104:107]
    v_cvt_pk_bf16_f32 v50, v36, v37
    v_mfma_f32_16x16x32_bf16 v[12:15], a[172:175], v[140:143], v[12:15]
    v_exp_f32 v38, v38
    v_mfma_f32_16x16x32_bf16 v[44:47], a[172:175], v[156:159], v[44:47]
    v_mfma_f32_16x16x32_bf16 v[76:79], a[172:175], v[172:175], v[76:79]
    v_exp_f32 v39, v39
    v_mfma_f32_16x16x32_bf16 v[108:111], a[172:175], v[188:191], v[108:111]
    s_waitcnt vmcnt(8) lgkmcnt(0)
    v_cvt_pk_bf16_f32 v51, v38, v39
    s_barrier
    v_mfma_f32_16x16x32_bf16 a[0:3], a[176:179], v[20:23], a[0:3]
    v_exp_f32 v64, v64
    v_mfma_f32_16x16x32_bf16 a[32:35], a[176:179], v[52:55], a[32:35]
    ds_read_b128 a[144:147], v192 offset:0
    v_mfma_f32_16x16x32_bf16 a[64:67], a[176:179], v[84:87], a[64:67]
    v_exp_f32 v65, v65
    v_mfma_f32_16x16x32_bf16 a[96:99], a[176:179], v[116:119], a[96:99]
    ds_read_b128 a[160:163], v192 offset:4096
    v_cvt_pk_bf16_f32 v80, v64, v65
    v_mfma_f32_16x16x32_bf16 a[4:7], a[180:183], v[20:23], a[4:7]
    v_exp_f32 v66, v66
    v_mfma_f32_16x16x32_bf16 a[36:39], a[180:183], v[52:55], a[36:39]
    ds_read_b128 a[148:151], v193 offset:0
    v_mfma_f32_16x16x32_bf16 a[68:71], a[180:183], v[84:87], a[68:71]
    s_xor_b32 s49, s46, 0xc000
    v_exp_f32 v67, v67
    v_mfma_f32_16x16x32_bf16 a[100:103], a[180:183], v[116:119], a[100:103]
    s_and_b32 s49, s49, 0xf000
    ds_read_b128 a[164:167], v193 offset:4096
    v_cvt_pk_bf16_f32 v81, v66, v67
    v_mfma_f32_16x16x32_bf16 a[8:11], a[184:187], v[20:23], a[8:11]
    s_add_u32 m0, s49, s48
    v_exp_f32 v68, v68
    v_mfma_f32_16x16x32_bf16 a[40:43], a[184:187], v[52:55], a[40:43]
    buffer_load_dwordx4 v204, s[4:7], s46 offen nt lds
    v_mfma_f32_16x16x32_bf16 a[72:75], a[184:187], v[84:87], a[72:75]
    s_add_u32 s46, s46, 4096
    v_exp_f32 v69, v69
    v_mfma_f32_16x16x32_bf16 a[104:107], a[184:187], v[116:119], a[104:107]
    ds_read_b128 a[152:155], v194 offset:0
    v_cvt_pk_bf16_f32 v82, v68, v69
    v_mfma_f32_16x16x32_bf16 a[12:15], a[188:191], v[20:23], a[12:15]
    v_exp_f32 v70, v70
    v_mfma_f32_16x16x32_bf16 a[44:47], a[188:191], v[52:55], a[44:47]
    ds_read_b128 a[168:171], v194 offset:4096
    v_mfma_f32_16x16x32_bf16 a[76:79], a[188:191], v[84:87], a[76:79]
    v_exp_f32 v71, v71
    v_mfma_f32_16x16x32_bf16 a[108:111], a[188:191], v[116:119], a[108:111]
    ds_read_b128 a[156:159], v195 offset:0
    v_cvt_pk_bf16_f32 v83, v70, v71
    v_mfma_f32_16x16x32_bf16 a[16:19], a[192:195], v[20:23], a[16:19]
    v_exp_f32 v96, v96
    v_mfma_f32_16x16x32_bf16 a[48:51], a[192:195], v[52:55], a[48:51]
    ds_read_b128 a[172:175], v195 offset:4096
    v_mfma_f32_16x16x32_bf16 a[80:83], a[192:195], v[84:87], a[80:83]
    v_exp_f32 v97, v97
    v_mfma_f32_16x16x32_bf16 a[112:115], a[192:195], v[116:119], a[112:115]
    v_cvt_pk_bf16_f32 v112, v96, v97
    v_mfma_f32_16x16x32_bf16 a[20:23], a[196:199], v[20:23], a[20:23]
    v_exp_f32 v98, v98
    v_mfma_f32_16x16x32_bf16 a[52:55], a[196:199], v[52:55], a[52:55]
    v_add_u32 v196, s51, v196
    v_add_u32 v197, s51, v197
    v_mfma_f32_16x16x32_bf16 a[84:87], a[196:199], v[84:87], a[84:87]
    s_xor_b32 s49, s46, 0xc000
    v_exp_f32 v99, v99
    v_mfma_f32_16x16x32_bf16 a[116:119], a[196:199], v[116:119], a[116:119]
    s_and_b32 s49, s49, 0xf000
    v_cvt_pk_bf16_f32 v113, v98, v99
    v_add_u32 v198, s51, v198
    v_mfma_f32_16x16x32_bf16 a[24:27], a[200:203], v[20:23], a[24:27]
    s_add_u32 m0, s49, s48
    v_exp_f32 v100, v100
    v_mfma_f32_16x16x32_bf16 a[56:59], a[200:203], v[52:55], a[56:59]
    buffer_load_dwordx4 v204, s[4:7], s46 offen nt lds
    v_mfma_f32_16x16x32_bf16 a[88:91], a[200:203], v[84:87], a[88:91]
    s_add_u32 s46, s46, 4096
    v_exp_f32 v101, v101
    v_mfma_f32_16x16x32_bf16 a[120:123], a[200:203], v[116:119], a[120:123]
    v_cvt_pk_bf16_f32 v114, v100, v101
    v_add_u32 v199, s51, v199
    v_mfma_f32_16x16x32_bf16 a[28:31], a[204:207], v[20:23], a[28:31]
    v_exp_f32 v102, v102
    v_mfma_f32_16x16x32_bf16 a[60:63], a[204:207], v[52:55], a[60:63]
    v_add_u32 v200, s51, v200
    v_add_u32 v201, s51, v201
    v_mfma_f32_16x16x32_bf16 a[92:95], a[204:207], v[84:87], a[92:95]
    v_exp_f32 v103, v103
    v_mfma_f32_16x16x32_bf16 a[124:127], a[204:207], v[116:119], a[124:127]
    v_cvt_pk_bf16_f32 v115, v102, v103
    v_add_u32 v202, s51, v202
    v_mfma_f32_16x16x32_bf16 a[128:131], a[240:243], v[20:23], a[128:131]
    v_add_u32 v203, s51, v203
    v_mfma_f32_16x16x32_bf16 a[132:135], a[240:243], v[52:55], a[132:135]
    v_mfma_f32_16x16x32_bf16 a[136:139], a[240:243], v[84:87], a[136:139]
    s_cmp_lt_u32 s45, s31
    v_mfma_f32_16x16x32_bf16 a[140:143], a[240:243], v[116:119], a[140:143]
    s_waitcnt lgkmcnt(0)
    s_cbranch_scc1 K1_LOOP
    s_cmp_eq_u32 s41, 1
    s_cbranch_scc1 K1_FINAL
    ds_read_b64_tr_b16 a[176:177], v196 offset:0
    ds_read_b64_tr_b16 a[178:179], v196 offset:4096
    ds_read_b64_tr_b16 a[180:181], v197 offset:0
    ds_read_b64_tr_b16 a[182:183], v197 offset:4096
    ds_read_b64_tr_b16 a[184:185], v198 offset:0
    ds_read_b64_tr_b16 a[186:187], v198 offset:4096
    ds_read_b64_tr_b16 a[188:189], v199 offset:0
    ds_read_b64_tr_b16 a[190:191], v199 offset:4096
    ds_read_b64_tr_b16 a[192:193], v200 offset:0
    ds_read_b64_tr_b16 a[194:195], v200 offset:4096
    ds_read_b64_tr_b16 a[196:197], v201 offset:0
    ds_read_b64_tr_b16 a[198:199], v201 offset:4096
    ds_read_b64_tr_b16 a[200:201], v202 offset:0
    ds_read_b64_tr_b16 a[202:203], v202 offset:4096
    ds_read_b64_tr_b16 a[204:205], v203 offset:0
    ds_read_b64_tr_b16 a[206:207], v203 offset:4096
    v_exp_f32 v8, v8
    v_exp_f32 v9, v9
    v_exp_f32 v10, v10
    v_exp_f32 v11, v11
    v_cvt_pk_bf16_f32 v20, v8, v9
    v_exp_f32 v12, v12
    v_exp_f32 v13, v13
    v_cvt_pk_bf16_f32 v21, v10, v11
    v_exp_f32 v14, v14
    s_waitcnt lgkmcnt(0)
    v_mfma_f32_16x16x32_bf16 a[0:3], a[176:179], v[16:19], a[0:3]
    ds_read_b64_tr_b16 a[208:209], v196 offset:8192
    ds_read_b64_tr_b16 a[210:211], v196 offset:12288
    v_mfma_f32_16x16x32_bf16 a[32:35], a[176:179], v[48:51], a[32:35]
    ds_read_b64_tr_b16 a[212:213], v197 offset:8192
    ds_read_b64_tr_b16 a[214:215], v197 offset:12288
    v_mfma_f32_16x16x32_bf16 a[64:67], a[176:179], v[80:83], a[64:67]
    ds_read_b64_tr_b16 a[216:217], v198 offset:8192
    ds_read_b64_tr_b16 a[218:219], v198 offset:12288
    v_mfma_f32_16x16x32_bf16 a[96:99], a[176:179], v[112:115], a[96:99]
    ds_read_b64_tr_b16 a[220:221], v199 offset:8192
    ds_read_b64_tr_b16 a[222:223], v199 offset:12288
    v_mfma_f32_16x16x32_bf16 a[4:7], a[180:183], v[16:19], a[4:7]
    ds_read_b64_tr_b16 a[224:225], v200 offset:8192
    ds_read_b64_tr_b16 a[226:227], v200 offset:12288
    v_mfma_f32_16x16x32_bf16 a[36:39], a[180:183], v[48:51], a[36:39]
    ds_read_b64_tr_b16 a[228:229], v201 offset:8192
    ds_read_b64_tr_b16 a[230:231], v201 offset:12288
    v_mfma_f32_16x16x32_bf16 a[68:71], a[180:183], v[80:83], a[68:71]
    s_xor_b32 s49, s46, 0xc000
    ds_read_b64_tr_b16 a[232:233], v202 offset:8192
    ds_read_b64_tr_b16 a[234:235], v202 offset:12288
    v_mfma_f32_16x16x32_bf16 a[100:103], a[180:183], v[112:115], a[100:103]
    s_and_b32 s49, s49, 0xf000
    ds_read_b64_tr_b16 a[236:237], v203 offset:8192
    ds_read_b64_tr_b16 a[238:239], v203 offset:12288
    v_mfma_f32_16x16x32_bf16 a[8:11], a[184:187], v[16:19], a[8:11]
    s_add_u32 m0, s49, s48
    v_exp_f32 v15, v15
    v_mfma_f32_16x16x32_bf16 a[40:43], a[184:187], v[48:51], a[40:43]
    buffer_load_dwordx4 v204, s[4:7], s46 offen nt lds
    v_mfma_f32_16x16x32_bf16 a[72:75], a[184:187], v[80:83], a[72:75]
    s_add_u32 s46, s46, 4096
    v_cvt_pk_bf16_f32 v22, v12, v13
    v_mfma_f32_16x16x32_bf16 a[104:107], a[184:187], v[112:115], a[104:107]
    v_exp_f32 v40, v40
    v_mfma_f32_16x16x32_bf16 a[12:15], a[188:191], v[16:19], a[12:15]
    v_exp_f32 v41, v41
    v_mfma_f32_16x16x32_bf16 a[44:47], a[188:191], v[48:51], a[44:47]
    v_cvt_pk_bf16_f32 v23, v14, v15
    v_mfma_f32_16x16x32_bf16 a[76:79], a[188:191], v[80:83], a[76:79]
    v_exp_f32 v42, v42
    v_mfma_f32_16x16x32_bf16 a[108:111], a[188:191], v[112:115], a[108:111]
    v_exp_f32 v43, v43
    v_mfma_f32_16x16x32_bf16 a[16:19], a[192:195], v[16:19], a[16:19]
    v_cvt_pk_bf16_f32 v52, v40, v41
    v_mfma_f32_16x16x32_bf16 a[48:51], a[192:195], v[48:51], a[48:51]
    s_xor_b32 s49, s46, 0xc000
    v_exp_f32 v44, v44
    v_mfma_f32_16x16x32_bf16 a[80:83], a[192:195], v[80:83], a[80:83]
    s_and_b32 s49, s49, 0xf000
    v_exp_f32 v45, v45
    v_mfma_f32_16x16x32_bf16 a[112:115], a[192:195], v[112:115], a[112:115]
    s_add_u32 m0, s49, s48
    v_cvt_pk_bf16_f32 v53, v42, v43
    v_mfma_f32_16x16x32_bf16 a[20:23], a[196:199], v[16:19], a[20:23]
    buffer_load_dwordx4 v204, s[4:7], s46 offen nt lds
    v_mfma_f32_16x16x32_bf16 a[52:55], a[196:199], v[48:51], a[52:55]
    s_add_u32 s46, s46, 4096
    v_exp_f32 v46, v46
    v_mfma_f32_16x16x32_bf16 a[84:87], a[196:199], v[80:83], a[84:87]
    v_exp_f32 v47, v47
    v_mfma_f32_16x16x32_bf16 a[116:119], a[196:199], v[112:115], a[116:119]
    v_cvt_pk_bf16_f32 v54, v44, v45
    v_mfma_f32_16x16x32_bf16 a[24:27], a[200:203], v[16:19], a[24:27]
    v_exp_f32 v72, v72
    v_mfma_f32_16x16x32_bf16 a[56:59], a[200:203], v[48:51], a[56:59]
    v_exp_f32 v73, v73
    v_mfma_f32_16x16x32_bf16 a[88:91], a[200:203], v[80:83], a[88:91]
    v_cvt_pk_bf16_f32 v55, v46, v47
    v_mfma_f32_16x16x32_bf16 a[120:123], a[200:203], v[112:115], a[120:123]
    v_exp_f32 v74, v74
    v_mfma_f32_16x16x32_bf16 a[28:31], a[204:207], v[16:19], a[28:31]
    v_exp_f32 v75, v75
    v_mfma_f32_16x16x32_bf16 a[60:63], a[204:207], v[48:51], a[60:63]
    s_and_b32 s49, s47, 0xf000
    v_cvt_pk_bf16_f32 v84, v72, v73
    v_mfma_f32_16x16x32_bf16 a[92:95], a[204:207], v[80:83], a[92:95]
    s_add_u32 m0, s49, s43
    v_exp_f32 v76, v76
    v_mfma_f32_16x16x32_bf16 a[124:127], a[204:207], v[112:115], a[124:127]
    buffer_load_dwordx4 v208, s[8:11], s47 offen nt lds
    v_mfma_f32_16x16x32_bf16 a[128:131], a[240:243], v[16:19], a[128:131]
    s_add_u32 s47, s47, 4096
    v_exp_f32 v77, v77
    v_mfma_f32_16x16x32_bf16 a[132:135], a[240:243], v[48:51], a[132:135]
    v_cvt_pk_bf16_f32 v85, v74, v75
    v_mfma_f32_16x16x32_bf16 a[136:139], a[240:243], v[80:83], a[136:139]
    v_exp_f32 v78, v78
    v_mfma_f32_16x16x32_bf16 a[140:143], a[240:243], v[112:115], a[140:143]
    v_exp_f32 v79, v79
    v_cvt_pk_bf16_f32 v86, v76, v77
    v_exp_f32 v104, v104
    v_exp_f32 v105, v105
    v_cvt_pk_bf16_f32 v87, v78, v79
    v_exp_f32 v106, v106
    v_exp_f32 v107, v107
    v_cvt_pk_bf16_f32 v116, v104, v105
    v_exp_f32 v108, v108
    v_exp_f32 v109, v109
    v_cvt_pk_bf16_f32 v117, v106, v107
    v_exp_f32 v110, v110
    v_exp_f32 v111, v111
    v_cvt_pk_bf16_f32 v118, v108, v109
    v_cvt_pk_bf16_f32 v119, v110, v111
    s_waitcnt lgkmcnt(0)
    v_mfma_f32_16x16x32_bf16 a[128:131], a[240:243], v[20:23], a[128:131]
    v_subrev_u32 v196, 49152, v196
    v_subrev_u32 v197, 49152, v197
    v_mfma_f32_16x16x32_bf16 a[132:135], a[240:243], v[52:55], a[132:135]
    s_and_b32 s49, s47, 0xf000
    v_subrev_u32 v198, 49152, v198
    v_subrev_u32 v199, 49152, v199
    v_mfma_f32_16x16x32_bf16 a[136:139], a[240:243], v[84:87], a[136:139]
    s_add_u32 m0, s49, s43
    v_subrev_u32 v200, 49152, v200
    v_subrev_u32 v201, 49152, v201
    v_mfma_f32_16x16x32_bf16 a[140:143], a[240:243], v[116:119], a[140:143]
    s_mov_b32 s59, 0x53800000
    buffer_load_dwordx4 v208, s[8:11], s47 offen nt lds
    v_mfma_f32_16x16x32_bf16 a[0:3], a[208:211], v[20:23], a[0:3]
    s_add_u32 s47, s47, 4096
    v_subrev_u32 v202, 49152, v202
    v_subrev_u32 v203, 49152, v203
    v_mfma_f32_16x16x32_bf16 a[4:7], a[212:215], v[20:23], a[4:7]
    v_mfma_f32_16x16x32_bf16 a[8:11], a[216:219], v[20:23], a[8:11]
    v_mfma_f32_16x16x32_bf16 a[12:15], a[220:223], v[20:23], a[12:15]
    v_mfma_f32_16x16x32_bf16 a[16:19], a[224:227], v[20:23], a[16:19]
    v_mfma_f32_16x16x32_bf16 a[20:23], a[228:231], v[20:23], a[20:23]
    v_accvgpr_read_b32 v210, a128
    v_accvgpr_read_b32 v212, a132
    v_mfma_f32_16x16x32_bf16 a[24:27], a[232:235], v[20:23], a[24:27]
    v_accvgpr_read_b32 v214, a136
    v_accvgpr_read_b32 v216, a140
    v_mfma_f32_16x16x32_bf16 a[28:31], a[236:239], v[20:23], a[28:31]
    s_and_b32 s49, s47, 0xf000
    v_cmp_nge_f32 s[32:33], s59, v210
    v_cmp_nge_f32 s[34:35], s59, v212
    v_mfma_f32_16x16x32_bf16 a[32:35], a[208:211], v[52:55], a[32:35]
    s_add_u32 m0, s49, s43
    v_cmp_nge_f32 s[36:37], s59, v214
    v_cmp_nge_f32 vcc, s59, v216
    v_mfma_f32_16x16x32_bf16 a[36:39], a[212:215], v[52:55], a[36:39]
    buffer_load_dwordx4 v208, s[8:11], s47 offen nt lds
    v_mfma_f32_16x16x32_bf16 a[40:43], a[216:219], v[52:55], a[40:43]
    s_add_u32 s47, s47, 4096
    v_rcp_f32 v210, v210
    v_mfma_f32_16x16x32_bf16 a[44:47], a[220:223], v[52:55], a[44:47]
    v_rcp_f32 v212, v212
    v_mfma_f32_16x16x32_bf16 a[48:51], a[224:227], v[52:55], a[48:51]
    s_or_b64 s[32:33], s[32:33], s[34:35]
    v_rcp_f32 v214, v214
    v_mfma_f32_16x16x32_bf16 a[52:55], a[228:231], v[52:55], a[52:55]
    s_or_b64 s[36:37], s[36:37], vcc
    v_rcp_f32 v216, v216
    v_mfma_f32_16x16x32_bf16 a[56:59], a[232:235], v[52:55], a[56:59]
    s_or_b64 s[32:33], s[32:33], s[36:37]
    v_mov_b32 v211, v210
    v_mov_b32 v213, v212
    s_cbranch_scc1 K1_SLOW
    v_mfma_f32_16x16x32_bf16 a[60:63], a[236:239], v[52:55], a[60:63]
    v_mov_b32 v215, v214
    v_mov_b32 v217, v216
    v_mfma_f32_16x16x32_bf16 a[64:67], a[208:211], v[84:87], a[64:67]
    ds_read_b128 v[128:131], v222 offset:0
    ds_read_b128 v[132:135], v222 offset:1024
    v_mfma_f32_16x16x32_bf16 a[68:71], a[212:215], v[84:87], a[68:71]
    ds_read_b128 v[136:139], v222 offset:2048
    ds_read_b128 v[140:143], v222 offset:3072
    v_mfma_f32_16x16x32_bf16 a[72:75], a[216:219], v[84:87], a[72:75]
    ds_read_b128 v[144:147], v222 offset:4096
    ds_read_b128 v[148:151], v222 offset:5120
    v_mfma_f32_16x16x32_bf16 a[76:79], a[220:223], v[84:87], a[76:79]
    ds_read_b128 v[152:155], v222 offset:6144
    ds_read_b128 v[156:159], v222 offset:7168
    v_mfma_f32_16x16x32_bf16 a[80:83], a[224:227], v[84:87], a[80:83]
    v_mov_b32 v160, v224
    v_mov_b32 v161, v225
    v_mfma_f32_16x16x32_bf16 a[84:87], a[228:231], v[84:87], a[84:87]
    v_mov_b32 v162, v226
    v_mov_b32 v163, v227
    v_mfma_f32_16x16x32_bf16 a[88:91], a[232:235], v[84:87], a[88:91]
    v_mov_b32 v164, v228
    v_mov_b32 v165, v229
    v_mfma_f32_16x16x32_bf16 a[92:95], a[236:239], v[84:87], a[92:95]
    v_mov_b32 v166, v230
    v_mov_b32 v167, v231
    v_mfma_f32_16x16x32_bf16 a[96:99], a[208:211], v[116:119], a[96:99]
    v_mov_b32 v168, v232
    v_mov_b32 v169, v233
    v_mfma_f32_16x16x32_bf16 a[100:103], a[212:215], v[116:119], a[100:103]
    v_mov_b32 v170, v234
    v_mov_b32 v171, v235
    v_mfma_f32_16x16x32_bf16 a[104:107], a[216:219], v[116:119], a[104:107]
    v_mov_b32 v172, v236
    v_mov_b32 v173, v237
    v_mfma_f32_16x16x32_bf16 a[108:111], a[220:223], v[116:119], a[108:111]
    v_mov_b32 v174, v238
    v_mov_b32 v175, v239
    v_mfma_f32_16x16x32_bf16 a[112:115], a[224:227], v[116:119], a[112:115]
    v_mov_b32 v176, v240
    v_mov_b32 v177, v241
    v_mfma_f32_16x16x32_bf16 a[116:119], a[228:231], v[116:119], a[116:119]
    v_mov_b32 v178, v242
    v_mov_b32 v179, v243
    v_mfma_f32_16x16x32_bf16 a[120:123], a[232:235], v[116:119], a[120:123]
    v_mov_b32 v180, v244
    v_mov_b32 v181, v245
    v_mfma_f32_16x16x32_bf16 a[124:127], a[236:239], v[116:119], a[124:127]
    v_mov_b32 v182, v246
    v_mov_b32 v183, v247
    v_mov_b32 v184, v248
    v_mov_b32 v185, v249
    v_mov_b32 v186, v250
    v_mov_b32 v187, v251
    v_mov_b32 v188, v252
    v_mov_b32 v189, v253
    v_mov_b32 v190, v254
    v_mov_b32 v191, v255
K1_SLOW_RET:
    s_waitcnt lgkmcnt(0)
    s_and_b32 s49, s47, 0xf000
    s_add_u32 m0, s49, s43
    s_nop 0
    buffer_load_dwordx4 v208, s[8:11], s47 offen nt lds
    s_add_u32 s47, s47, 4096
    v_accvgpr_read_b32 v0, a0
    v_accvgpr_read_b32 v1, a1
    v_accvgpr_read_b32 v2, a2
    v_accvgpr_read_b32 v3, a3
    v_accvgpr_read_b32 v4, a4
    v_accvgpr_read_b32 v5, a5
    v_accvgpr_read_b32 v6, a6
    v_accvgpr_read_b32 v7, a7
    v_pk_mul_f32 v[0:1], v[0:1], v[210:211]
    v_pk_mul_f32 v[2:3], v[2:3], v[210:211]
    v_pk_mul_f32 v[4:5], v[4:5], v[210:211]
    v_pk_mul_f32 v[6:7], v[6:7], v[210:211]
    v_cvt_pk_bf16_f32 v64, v0, v1
    v_cvt_pk_bf16_f32 v65, v2, v3
    v_cvt_pk_bf16_f32 v66, v4, v5
    v_cvt_pk_bf16_f32 v67, v6, v7
    ds_write_b128 v222, v[64:67] offset:0
    v_accvgpr_read_b32 v8, a8
    v_accvgpr_read_b32 v9, a9
    v_accvgpr_read_b32 v10, a10
    v_accvgpr_read_b32 v11, a11
    v_accvgpr_read_b32 v12, a12
    v_accvgpr_read_b32 v13, a13
    v_accvgpr_read_b32 v14, a14
    v_accvgpr_read_b32 v15, a15
    v_pk_mul_f32 v[8:9], v[8:9], v[210:211]
    v_pk_mul_f32 v[10:11], v[10:11], v[210:211]
    v_pk_mul_f32 v[12:13], v[12:13], v[210:211]
    v_pk_mul_f32 v[14:15], v[14:15], v[210:211]
    v_cvt_pk_bf16_f32 v68, v8, v9
    v_cvt_pk_bf16_f32 v69, v10, v11
    v_cvt_pk_bf16_f32 v70, v12, v13
    v_cvt_pk_bf16_f32 v71, v14, v15
    ds_write_b128 v222, v[68:71] offset:1024
    v_accvgpr_read_b32 v32, a16
    v_accvgpr_read_b32 v33, a17
    v_accvgpr_read_b32 v34, a18
    v_accvgpr_read_b32 v35, a19
    v_accvgpr_read_b32 v36, a20
    v_accvgpr_read_b32 v37, a21
    v_accvgpr_read_b32 v38, a22
    v_accvgpr_read_b32 v39, a23
    v_pk_mul_f32 v[32:33], v[32:33], v[210:211]
    v_pk_mul_f32 v[34:35], v[34:35], v[210:211]
    v_pk_mul_f32 v[36:37], v[36:37], v[210:211]
    v_pk_mul_f32 v[38:39], v[38:39], v[210:211]
    v_cvt_pk_bf16_f32 v72, v32, v33
    v_cvt_pk_bf16_f32 v73, v34, v35
    v_cvt_pk_bf16_f32 v74, v36, v37
    v_cvt_pk_bf16_f32 v75, v38, v39
    ds_write_b128 v222, v[72:75] offset:2048
    v_accvgpr_read_b32 v40, a24
    v_accvgpr_read_b32 v41, a25
    v_accvgpr_read_b32 v42, a26
    v_accvgpr_read_b32 v43, a27
    v_accvgpr_read_b32 v44, a28
    v_accvgpr_read_b32 v45, a29
    v_accvgpr_read_b32 v46, a30
    v_accvgpr_read_b32 v47, a31
    v_pk_mul_f32 v[40:41], v[40:41], v[210:211]
    v_pk_mul_f32 v[42:43], v[42:43], v[210:211]
    v_pk_mul_f32 v[44:45], v[44:45], v[210:211]
    v_pk_mul_f32 v[46:47], v[46:47], v[210:211]
    v_cvt_pk_bf16_f32 v76, v40, v41
    v_cvt_pk_bf16_f32 v77, v42, v43
    v_cvt_pk_bf16_f32 v78, v44, v45
    v_cvt_pk_bf16_f32 v79, v46, v47
    ds_write_b128 v222, v[76:79] offset:3072
    v_accvgpr_read_b32 v0, a32
    v_accvgpr_read_b32 v1, a33
    v_accvgpr_read_b32 v2, a34
    v_accvgpr_read_b32 v3, a35
    v_accvgpr_read_b32 v4, a36
    v_accvgpr_read_b32 v5, a37
    v_accvgpr_read_b32 v6, a38
    v_accvgpr_read_b32 v7, a39
    v_pk_mul_f32 v[0:1], v[0:1], v[212:213]
    v_pk_mul_f32 v[2:3], v[2:3], v[212:213]
    v_pk_mul_f32 v[4:5], v[4:5], v[212:213]
    v_pk_mul_f32 v[6:7], v[6:7], v[212:213]
    v_cvt_pk_bf16_f32 v64, v0, v1
    v_cvt_pk_bf16_f32 v65, v2, v3
    v_cvt_pk_bf16_f32 v66, v4, v5
    v_cvt_pk_bf16_f32 v67, v6, v7
    ds_write_b128 v222, v[64:67] offset:4096
    v_accvgpr_read_b32 v8, a40
    v_accvgpr_read_b32 v9, a41
    v_accvgpr_read_b32 v10, a42
    v_accvgpr_read_b32 v11, a43
    v_accvgpr_read_b32 v12, a44
    s_and_b32 s49, s47, 0xf000
    s_add_u32 m0, s49, s43
    s_nop 0
    buffer_load_dwordx4 v208, s[8:11], s47 offen nt lds
    s_add_u32 s47, s47, 4096
    v_accvgpr_read_b32 v13, a45
    v_accvgpr_read_b32 v14, a46
    v_accvgpr_read_b32 v15, a47
    v_pk_mul_f32 v[8:9], v[8:9], v[212:213]
    v_pk_mul_f32 v[10:11], v[10:11], v[212:213]
    v_pk_mul_f32 v[12:13], v[12:13], v[212:213]
    v_pk_mul_f32 v[14:15], v[14:15], v[212:213]
    v_cvt_pk_bf16_f32 v68, v8, v9
    v_cvt_pk_bf16_f32 v69, v10, v11
    v_cvt_pk_bf16_f32 v70, v12, v13
    v_cvt_pk_bf16_f32 v71, v14, v15
    ds_write_b128 v222, v[68:71] offset:5120
    v_accvgpr_read_b32 v32, a48
    v_accvgpr_read_b32 v33, a49
    v_accvgpr_read_b32 v34, a50
    v_accvgpr_read_b32 v35, a51
    v_accvgpr_read_b32 v36, a52
    v_accvgpr_read_b32 v37, a53
    v_accvgpr_read_b32 v38, a54
    v_accvgpr_read_b32 v39, a55
    v_pk_mul_f32 v[32:33], v[32:33], v[212:213]
    v_pk_mul_f32 v[34:35], v[34:35], v[212:213]
    v_pk_mul_f32 v[36:37], v[36:37], v[212:213]
    v_pk_mul_f32 v[38:39], v[38:39], v[212:213]
    v_cvt_pk_bf16_f32 v72, v32, v33
    v_cvt_pk_bf16_f32 v73, v34, v35
    v_cvt_pk_bf16_f32 v74, v36, v37
    v_cvt_pk_bf16_f32 v75, v38, v39
    ds_write_b128 v222, v[72:75] offset:6144
    v_accvgpr_read_b32 v40, a56
    v_accvgpr_read_b32 v41, a57
    v_accvgpr_read_b32 v42, a58
    v_accvgpr_read_b32 v43, a59
    v_accvgpr_read_b32 v44, a60
    v_accvgpr_read_b32 v45, a61
    v_accvgpr_read_b32 v46, a62
    v_accvgpr_read_b32 v47, a63
    v_pk_mul_f32 v[40:41], v[40:41], v[212:213]
    v_pk_mul_f32 v[42:43], v[42:43], v[212:213]
    v_pk_mul_f32 v[44:45], v[44:45], v[212:213]
    v_pk_mul_f32 v[46:47], v[46:47], v[212:213]
    v_cvt_pk_bf16_f32 v76, v40, v41
    v_cvt_pk_bf16_f32 v77, v42, v43
    v_cvt_pk_bf16_f32 v78, v44, v45
    v_cvt_pk_bf16_f32 v79, v46, v47
    ds_write_b128 v222, v[76:79] offset:7168
    v_accvgpr_read_b32 v0, a64
    v_accvgpr_read_b32 v1, a65
    v_accvgpr_read_b32 v2, a66
    v_accvgpr_read_b32 v3, a67
    v_accvgpr_read_b32 v4, a68
    v_accvgpr_read_b32 v5, a69
    v_accvgpr_read_b32 v6, a70
    v_accvgpr_read_b32 v7, a71
    v_pk_mul_f32 v[0:1], v[0:1], v[214:215]
    v_pk_mul_f32 v[2:3], v[2:3], v[214:215]
    v_pk_mul_f32 v[4:5], v[4:5], v[214:215]
    v_pk_mul_f32 v[6:7], v[6:7], v[214:215]
    v_cvt_pk_bf16_f32 v224, v0, v1
    v_cvt_pk_bf16_f32 v225, v2, v3
    v_cvt_pk_bf16_f32 v226, v4, v5
    v_cvt_pk_bf16_f32 v227, v6, v7
    v_accvgpr_read_b32 v8, a72
    v_accvgpr_read_b32 v9, a73
    v_accvgpr_read_b32 v10, a74
    v_accvgpr_read_b32 v11, a75
    v_accvgpr_read_b32 v12, a76
    v_accvgpr_read_b32 v13, a77
    v_accvgpr_read_b32 v14, a78
    v_accvgpr_read_b32 v15, a79
    v_pk_mul_f32 v[8:9], v[8:9], v[214:215]
    v_pk_mul_f32 v[10:11], v[10:11], v[214:215]
    v_pk_mul_f32 v[12:13], v[12:13], v[214:215]
    v_pk_mul_f32 v[14:15], v[14:15], v[214:215]
    v_cvt_pk_bf16_f32 v228, v8, v9
    v_cvt_pk_bf16_f32 v229, v10, v11
    v_cvt_pk_bf16_f32 v230, v12, v13
    v_cvt_pk_bf16_f32 v231, v14, v15
    v_accvgpr_read_b32 v32, a80
    v_accvgpr_read_b32 v33, a81
    v_accvgpr_read_b32 v34, a82
    v_accvgpr_read_b32 v35, a83
    v_accvgpr_read_b32 v36, a84
    v_accvgpr_read_b32 v37, a85
    v_accvgpr_read_b32 v38, a86
    v_accvgpr_read_b32 v39, a87
    v_pk_mul_f32 v[32:33], v[32:33], v[214:215]
    v_pk_mul_f32 v[34:35], v[34:35], v[214:215]
    v_pk_mul_f32 v[36:37], v[36:37], v[214:215]
    v_pk_mul_f32 v[38:39], v[38:39], v[214:215]
    s_and_b32 s49, s47, 0xf000
    s_add_u32 m0, s49, s43
    s_nop 0
    buffer_load_dwordx4 v208, s[8:11], s47 offen nt lds
    s_add_u32 s47, s47, 4096
    v_cvt_pk_bf16_f32 v232, v32, v33
    v_cvt_pk_bf16_f32 v233, v34, v35
    v_cvt_pk_bf16_f32 v234, v36, v37
    v_cvt_pk_bf16_f32 v235, v38, v39
    v_accvgpr_read_b32 v40, a88
    v_accvgpr_read_b32 v41, a89
    v_accvgpr_read_b32 v42, a90
    v_accvgpr_read_b32 v43, a91
    v_accvgpr_read_b32 v44, a92
    v_accvgpr_read_b32 v45, a93
    v_accvgpr_read_b32 v46, a94
    v_accvgpr_read_b32 v47, a95
    v_pk_mul_f32 v[40:41], v[40:41], v[214:215]
    v_pk_mul_f32 v[42:43], v[42:43], v[214:215]
    v_pk_mul_f32 v[44:45], v[44:45], v[214:215]
    v_pk_mul_f32 v[46:47], v[46:47], v[214:215]
    v_cvt_pk_bf16_f32 v236, v40, v41
    v_cvt_pk_bf16_f32 v237, v42, v43
    v_cvt_pk_bf16_f32 v238, v44, v45
    v_cvt_pk_bf16_f32 v239, v46, v47
    ds_read_b128 a[208:211], v222 offset:0
    ds_read_b128 a[212:215], v222 offset:1024
    ds_read_b128 a[216:219], v222 offset:2048
    ds_read_b128 a[220:223], v222 offset:3072
    ds_read_b128 a[224:227], v222 offset:4096
    ds_read_b128 a[228:231], v222 offset:5120
    ds_read_b128 a[232:235], v222 offset:6144
    ds_read_b128 a[236:239], v222 offset:7168
    v_accvgpr_read_b32 v0, a96
    v_accvgpr_read_b32 v1, a97
    v_accvgpr_read_b32 v2, a98
    v_accvgpr_read_b32 v3, a99
    v_accvgpr_read_b32 v4, a100
    v_accvgpr_read_b32 v5, a101
    v_accvgpr_read_b32 v6, a102
    v_accvgpr_read_b32 v7, a103
    v_pk_mul_f32 v[0:1], v[0:1], v[216:217]
    v_pk_mul_f32 v[2:3], v[2:3], v[216:217]
    v_pk_mul_f32 v[4:5], v[4:5], v[216:217]
    v_pk_mul_f32 v[6:7], v[6:7], v[216:217]
    v_cvt_pk_bf16_f32 v240, v0, v1
    v_cvt_pk_bf16_f32 v241, v2, v3
    v_cvt_pk_bf16_f32 v242, v4, v5
    v_cvt_pk_bf16_f32 v243, v6, v7
    v_accvgpr_read_b32 v8, a104
    v_accvgpr_read_b32 v9, a105
    v_accvgpr_read_b32 v10, a106
    v_accvgpr_read_b32 v11, a107
    v_accvgpr_read_b32 v12, a108
    v_accvgpr_read_b32 v13, a109
    v_accvgpr_read_b32 v14, a110
    v_accvgpr_read_b32 v15, a111
    v_pk_mul_f32 v[8:9], v[8:9], v[216:217]
    v_pk_mul_f32 v[10:11], v[10:11], v[216:217]
    v_pk_mul_f32 v[12:13], v[12:13], v[216:217]
    v_pk_mul_f32 v[14:15], v[14:15], v[216:217]
    v_cvt_pk_bf16_f32 v244, v8, v9
    v_cvt_pk_bf16_f32 v245, v10, v11
    v_cvt_pk_bf16_f32 v246, v12, v13
    v_cvt_pk_bf16_f32 v247, v14, v15
    v_accvgpr_read_b32 v32, a112
    v_accvgpr_read_b32 v33, a113
    v_accvgpr_read_b32 v34, a114
    v_accvgpr_read_b32 v35, a115
    v_accvgpr_read_b32 v36, a116
    v_accvgpr_read_b32 v37, a117
    v_accvgpr_read_b32 v38, a118
    v_accvgpr_read_b32 v39, a119
    v_pk_mul_f32 v[32:33], v[32:33], v[216:217]
    v_pk_mul_f32 v[34:35], v[34:35], v[216:217]
    v_pk_mul_f32 v[36:37], v[36:37], v[216:217]
    v_pk_mul_f32 v[38:39], v[38:39], v[216:217]
    v_cvt_pk_bf16_f32 v248, v32, v33
    v_cvt_pk_bf16_f32 v249, v34, v35
    v_cvt_pk_bf16_f32 v250, v36, v37
    v_cvt_pk_bf16_f32 v251, v38, v39
    v_accvgpr_read_b32 v40, a120
    v_accvgpr_read_b32 v41, a121
    v_accvgpr_read_b32 v42, a122
    v_accvgpr_read_b32 v43, a123
    v_accvgpr_read_b32 v44, a124
    v_accvgpr_read_b32 v45, a125
    v_accvgpr_read_b32 v46, a126
    v_accvgpr_read_b32 v47, a127
    v_pk_mul_f32 v[40:41], v[40:41], v[216:217]
    v_pk_mul_f32 v[42:43], v[42:43], v[216:217]
    v_pk_mul_f32 v[44:45], v[44:45], v[216:217]
    v_pk_mul_f32 v[46:47], v[46:47], v[216:217]
    v_cvt_pk_bf16_f32 v252, v40, v41
    v_cvt_pk_bf16_f32 v253, v42, v43
    v_cvt_pk_bf16_f32 v254, v44, v45
    v_cvt_pk_bf16_f32 v255, v46, v47
    buffer_load_dword v219, v218, s[12:15], 0 offen sc1
    s_add_u32 s12, s38, 60817408
    s_addc_u32 s13, s39, 0
    s_mov_b32 s14, 0x40000
    s_lshl_b32 s3, s44, 3
    s_add_u32 s3, s3, s42
    s_lshl_b32 s3, s3, 2
    s_and_b32 s59, s2, 3
    s_add_u32 s3, s3, s59
    s_lshl_b32 s3, s3, 9
    s_lshr_b32 s59, s100, 3
    s_add_u32 s60, s3, s59
    s_mov_b32 s41, 1
    s_mov_b32 s31, 13
    s_mov_b32 s35, 0
    s_mov_b32 s37, 0
    s_mov_b32 s28, 585
    s_mov_b32 s29, 0
    s_bitcmp1_b32 s2, 3
    s_branch K1_PRO
K1_FINAL:
    s_lshl_b32 s53, s100, 1
    s_and_b32 s30, s2, 24
    s_mov_b32 s50, 4096
    v_mfma_f32_16x16x32_bf16 v[0:3], a[144:147], v[128:131], v[24:27]
    v_exp_f32 v8, v8
    v_mfma_f32_16x16x32_bf16 v[32:35], a[144:147], v[144:147], v[56:59]
    ds_read_b64_tr_b16 a[176:177], v196 offset:0
    ds_read_b64_tr_b16 a[178:179], v196 offset:4096
    v_mfma_f32_16x16x32_bf16 v[64:67], a[144:147], v[160:163], v[88:91]
    v_exp_f32 v9, v9
    v_mfma_f32_16x16x32_bf16 v[96:99], a[144:147], v[176:179], v[120:123]
    ds_read_b64_tr_b16 a[180:181], v197 offset:0
    v_cvt_pk_bf16_f32 v20, v8, v9
    v_mfma_f32_16x16x32_bf16 v[4:7], a[160:163], v[128:131], v[24:27]
    v_exp_f32 v10, v10
    v_mfma_f32_16x16x32_bf16 v[36:39], a[160:163], v[144:147], v[56:59]
    buffer_load_dwordx4 a[248:251], v223, s[24:27], 0 offen offset:0
    v_mfma_f32_16x16x32_bf16 v[68:71], a[160:163], v[160:163], v[88:91]
    v_exp_f32 v11, v11
    v_mfma_f32_16x16x32_bf16 v[100:103], a[160:163], v[176:179], v[120:123]
    ds_read_b64_tr_b16 a[182:183], v197 offset:4096
    v_cvt_pk_bf16_f32 v21, v10, v11
    v_mfma_f32_16x16x32_bf16 v[0:3], a[148:151], v[132:135], v[0:3]
    v_exp_f32 v12, v12
    v_mfma_f32_16x16x32_bf16 v[32:35], a[148:151], v[148:151], v[32:35]
    ds_read_b64_tr_b16 a[184:185], v198 offset:0
    ds_read_b64_tr_b16 a[186:187], v198 offset:4096
    v_mfma_f32_16x16x32_bf16 v[64:67], a[148:151], v[164:167], v[64:67]
    v_exp_f32 v13, v13
    v_mfma_f32_16x16x32_bf16 v[96:99], a[148:151], v[180:183], v[96:99]
    ds_read_b64_tr_b16 a[188:189], v199 offset:0
    v_cvt_pk_bf16_f32 v22, v12, v13
    v_mfma_f32_16x16x32_bf16 v[4:7], a[164:167], v[132:135], v[4:7]
    v_exp_f32 v14, v14
    v_mfma_f32_16x16x32_bf16 v[36:39], a[164:167], v[148:151], v[36:39]
    buffer_load_dwordx4 a[248:251], v223, s[24:27], 0 offen offset:1024
    v_mfma_f32_16x16x32_bf16 v[68:71], a[164:167], v[164:167], v[68:71]
    v_exp_f32 v15, v15
    v_mfma_f32_16x16x32_bf16 v[100:103], a[164:167], v[180:183], v[100:103]
    ds_read_b64_tr_b16 a[190:191], v199 offset:4096
    v_cvt_pk_bf16_f32 v23, v14, v15
    v_mfma_f32_16x16x32_bf16 v[0:3], a[152:155], v[136:139], v[0:3]
    v_exp_f32 v40, v40
    v_mfma_f32_16x16x32_bf16 v[32:35], a[152:155], v[152:155], v[32:35]
    ds_read_b64_tr_b16 a[192:193], v200 offset:0
    ds_read_b64_tr_b16 a[194:195], v200 offset:4096
    v_mfma_f32_16x16x32_bf16 v[64:67], a[152:155], v[168:171], v[64:67]
    v_exp_f32 v41, v41
    v_mfma_f32_16x16x32_bf16 v[96:99], a[152:155], v[184:187], v[96:99]
    ds_read_b64_tr_b16 a[196:197], v201 offset:0
    v_cvt_pk_bf16_f32 v52, v40, v41
    v_mfma_f32_16x16x32_bf16 v[4:7], a[168:171], v[136:139], v[4:7]
    v_exp_f32 v42, v42
    v_mfma_f32_16x16x32_bf16 v[36:39], a[168:171], v[152:155], v[36:39]
    ds_read_b64_tr_b16 a[198:199], v201 offset:4096
    ds_read_b64_tr_b16 a[200:201], v202 offset:0
    v_mfma_f32_16x16x32_bf16 v[68:71], a[168:171], v[168:171], v[68:71]
    v_exp_f32 v43, v43
    v_mfma_f32_16x16x32_bf16 v[100:103], a[168:171], v[184:187], v[100:103]
    ds_read_b64_tr_b16 a[202:203], v202 offset:4096
    v_cvt_pk_bf16_f32 v53, v42, v43
    v_mfma_f32_16x16x32_bf16 v[0:3], a[156:159], v[140:143], v[0:3]
    v_exp_f32 v44, v44
    v_mfma_f32_16x16x32_bf16 v[32:35], a[156:159], v[156:159], v[32:35]
    buffer_load_dwordx4 a[248:251], v223, s[24:27], 0 offen offset:2048
    v_mfma_f32_16x16x32_bf16 v[64:67], a[156:159], v[172:175], v[64:67]
    v_exp_f32 v45, v45
    v_mfma_f32_16x16x32_bf16 v[96:99], a[156:159], v[188:191], v[96:99]
    ds_read_b64_tr_b16 a[204:205], v203 offset:0
    v_cvt_pk_bf16_f32 v54, v44, v45
    v_mfma_f32_16x16x32_bf16 v[4:7], a[172:175], v[140:143], v[4:7]
    v_exp_f32 v46, v46
    v_mfma_f32_16x16x32_bf16 v[36:39], a[172:175], v[156:159], v[36:39]
    ds_read_b64_tr_b16 a[206:207], v203 offset:4096
    v_mfma_f32_16x16x32_bf16 v[68:71], a[172:175], v[172:175], v[68:71]
    v_exp_f32 v47, v47
    v_mfma_f32_16x16x32_bf16 v[100:103], a[172:175], v[188:191], v[100:103]
    s_waitcnt lgkmcnt(0)
    v_cvt_pk_bf16_f32 v55, v46, v47
    v_mfma_f32_16x16x32_bf16 a[0:3], a[176:179], v[16:19], a[0:3]
    v_exp_f32 v72, v72
    v_mfma_f32_16x16x32_bf16 a[32:35], a[176:179], v[48:51], a[32:35]
    ds_read_b128 a[144:147], v192 offset:8192
    v_mfma_f32_16x16x32_bf16 a[64:67], a[176:179], v[80:83], a[64:67]
    v_exp_f32 v73, v73
    v_mfma_f32_16x16x32_bf16 a[96:99], a[176:179], v[112:115], a[96:99]
    ds_read_b128 a[160:163], v192 offset:12288
    v_cvt_pk_bf16_f32 v84, v72, v73
    v_mfma_f32_16x16x32_bf16 a[4:7], a[180:183], v[16:19], a[4:7]
    v_exp_f32 v74, v74
    v_mfma_f32_16x16x32_bf16 a[36:39], a[180:183], v[48:51], a[36:39]
    buffer_load_dwordx4 a[248:251], v223, s[24:27], 0 offen offset:3072
    v_mfma_f32_16x16x32_bf16 a[68:71], a[180:183], v[80:83], a[68:71]
    v_exp_f32 v75, v75
    v_mfma_f32_16x16x32_bf16 a[100:103], a[180:183], v[112:115], a[100:103]
    ds_read_b128 a[148:151], v193 offset:8192
    v_cvt_pk_bf16_f32 v85, v74, v75
    v_mfma_f32_16x16x32_bf16 a[8:11], a[184:187], v[16:19], a[8:11]
    v_exp_f32 v76, v76
    v_mfma_f32_16x16x32_bf16 a[40:43], a[184:187], v[48:51], a[40:43]
    ds_read_b128 a[164:167], v193 offset:12288
    v_mfma_f32_16x16x32_bf16 a[72:75], a[184:187], v[80:83], a[72:75]
    v_exp_f32 v77, v77
    v_mfma_f32_16x16x32_bf16 a[104:107], a[184:187], v[112:115], a[104:107]
    ds_read_b128 a[152:155], v194 offset:8192
    v_cvt_pk_bf16_f32 v86, v76, v77
    v_mfma_f32_16x16x32_bf16 a[12:15], a[188:191], v[16:19], a[12:15]
    v_exp_f32 v78, v78
    v_mfma_f32_16x16x32_bf16 a[44:47], a[188:191], v[48:51], a[44:47]
    buffer_load_dwordx4 a[248:251], v223, s[24:27], s50 offen offset:0
    v_mfma_f32_16x16x32_bf16 a[76:79], a[188:191], v[80:83], a[76:79]
    v_exp_f32 v79, v79
    v_mfma_f32_16x16x32_bf16 a[108:111], a[188:191], v[112:115], a[108:111]
    ds_read_b128 a[168:171], v194 offset:12288
    v_cvt_pk_bf16_f32 v87, v78, v79
    v_mfma_f32_16x16x32_bf16 a[16:19], a[192:195], v[16:19], a[16:19]
    v_exp_f32 v104, v104
    v_mfma_f32_16x16x32_bf16 a[48:51], a[192:195], v[48:51], a[48:51]
    ds_read_b128 a[156:159], v195 offset:8192
    v_mfma_f32_16x16x32_bf16 a[80:83], a[192:195], v[80:83], a[80:83]
    v_exp_f32 v105, v105
    v_mfma_f32_16x16x32_bf16 a[112:115], a[192:195], v[112:115], a[112:115]
    ds_read_b128 a[172:175], v195 offset:12288
    v_cvt_pk_bf16_f32 v116, v104, v105
    v_mfma_f32_16x16x32_bf16 a[20:23], a[196:199], v[16:19], a[20:23]
    v_exp_f32 v106, v106
    v_mfma_f32_16x16x32_bf16 a[52:55], a[196:199], v[48:51], a[52:55]
    buffer_load_dwordx4 a[248:251], v223, s[24:27], s50 offen offset:1024
    v_mfma_f32_16x16x32_bf16 a[84:87], a[196:199], v[80:83], a[84:87]
    v_exp_f32 v107, v107
    v_mfma_f32_16x16x32_bf16 a[116:119], a[196:199], v[112:115], a[116:119]
    v_cvt_pk_bf16_f32 v117, v106, v107
    v_mfma_f32_16x16x32_bf16 a[24:27], a[200:203], v[16:19], a[24:27]
    v_exp_f32 v108, v108
    v_mfma_f32_16x16x32_bf16 a[56:59], a[200:203], v[48:51], a[56:59]
    v_mfma_f32_16x16x32_bf16 a[88:91], a[200:203], v[80:83], a[88:91]
    v_exp_f32 v109, v109
    v_mfma_f32_16x16x32_bf16 a[120:123], a[200:203], v[112:115], a[120:123]
    v_cvt_pk_bf16_f32 v118, v108, v109
    v_mfma_f32_16x16x32_bf16 a[28:31], a[204:207], v[16:19], a[28:31]
    v_exp_f32 v110, v110
    v_mfma_f32_16x16x32_bf16 a[60:63], a[204:207], v[48:51], a[60:63]
    buffer_load_dwordx4 a[248:251], v223, s[24:27], s50 offen offset:2048
    v_mfma_f32_16x16x32_bf16 a[92:95], a[204:207], v[80:83], a[92:95]
    v_exp_f32 v111, v111
    v_mfma_f32_16x16x32_bf16 a[124:127], a[204:207], v[112:115], a[124:127]
    v_cvt_pk_bf16_f32 v119, v110, v111
    v_mfma_f32_16x16x32_bf16 a[128:131], a[240:243], v[16:19], a[128:131]
    v_subrev_u32 v192, 16384, v192
    v_subrev_u32 v193, 16384, v193
    v_mfma_f32_16x16x32_bf16 a[132:135], a[240:243], v[48:51], a[132:135]
    v_subrev_u32 v194, 16384, v194
    v_subrev_u32 v195, 16384, v195
    v_mfma_f32_16x16x32_bf16 a[136:139], a[240:243], v[80:83], a[136:139]
    v_mfma_f32_16x16x32_bf16 a[140:143], a[240:243], v[112:115], a[140:143]
    s_waitcnt lgkmcnt(0)
    v_mfma_f32_16x16x32_bf16 v[8:11], a[144:147], v[128:131], v[24:27]
    v_exp_f32 v0, v0
    v_mfma_f32_16x16x32_bf16 v[40:43], a[144:147], v[144:147], v[56:59]
    buffer_load_dwordx4 a[248:251], v223, s[24:27], s50 offen offset:3072
    v_mfma_f32_16x16x32_bf16 v[72:75], a[144:147], v[160:163], v[88:91]
    v_exp_f32 v1, v1
    v_mfma_f32_16x16x32_bf16 v[104:107], a[144:147], v[176:179], v[120:123]
    ds_read_b64_tr_b16 a[176:177], v196 offset:8192
    v_cvt_pk_bf16_f32 v16, v0, v1
    v_mfma_f32_16x16x32_bf16 v[12:15], a[160:163], v[128:131], v[24:27]
    v_exp_f32 v2, v2
    v_mfma_f32_16x16x32_bf16 v[44:47], a[160:163], v[144:147], v[56:59]
    ds_read_b64_tr_b16 a[178:179], v196 offset:12288
    ds_read_b64_tr_b16 a[180:181], v197 offset:8192
    v_mfma_f32_16x16x32_bf16 v[76:79], a[160:163], v[160:163], v[88:91]
    v_exp_f32 v3, v3
    v_mfma_f32_16x16x32_bf16 v[108:111], a[160:163], v[176:179], v[120:123]
    ds_read_b64_tr_b16 a[182:183], v197 offset:12288
    v_cvt_pk_bf16_f32 v17, v2, v3
    v_mfma_f32_16x16x32_bf16 v[8:11], a[148:151], v[132:135], v[8:11]
    v_exp_f32 v4, v4
    v_mfma_f32_16x16x32_bf16 v[40:43], a[148:151], v[148:151], v[40:43]
    ds_read_b64_tr_b16 a[184:185], v198 offset:8192
    ds_read_b64_tr_b16 a[186:187], v198 offset:12288
    v_mfma_f32_16x16x32_bf16 v[72:75], a[148:151], v[164:167], v[72:75]
    v_exp_f32 v5, v5
    v_mfma_f32_16x16x32_bf16 v[104:107], a[148:151], v[180:183], v[104:107]
    ds_read_b64_tr_b16 a[188:189], v199 offset:8192
    v_cvt_pk_bf16_f32 v18, v4, v5
    v_mfma_f32_16x16x32_bf16 v[12:15], a[164:167], v[132:135], v[12:15]
    v_exp_f32 v6, v6
    v_mfma_f32_16x16x32_bf16 v[44:47], a[164:167], v[148:151], v[44:47]
    buffer_store_dwordx4 a[208:211], v221, s[20:23], s55 offen offset:0 sc1
    v_mfma_f32_16x16x32_bf16 v[76:79], a[164:167], v[164:167], v[76:79]
    v_exp_f32 v7, v7
    v_mfma_f32_16x16x32_bf16 v[108:111], a[164:167], v[180:183], v[108:111]
    ds_read_b64_tr_b16 a[190:191], v199 offset:12288
    v_cvt_pk_bf16_f32 v19, v6, v7
    v_mfma_f32_16x16x32_bf16 v[8:11], a[152:155], v[136:139], v[8:11]
    v_exp_f32 v32, v32
    v_mfma_f32_16x16x32_bf16 v[40:43], a[152:155], v[152:155], v[40:43]
    ds_read_b64_tr_b16 a[192:193], v200 offset:8192
    ds_read_b64_tr_b16 a[194:195], v200 offset:12288
    v_mfma_f32_16x16x32_bf16 v[72:75], a[152:155], v[168:171], v[72:75]
    v_exp_f32 v33, v33
    v_mfma_f32_16x16x32_bf16 v[104:107], a[152:155], v[184:187], v[104:107]
    ds_read_b64_tr_b16 a[196:197], v201 offset:8192
    v_cvt_pk_bf16_f32 v48, v32, v33
    v_mfma_f32_16x16x32_bf16 v[12:15], a[168:171], v[136:139], v[12:15]
    v_exp_f32 v34, v34
    v_mfma_f32_16x16x32_bf16 v[44:47], a[168:171], v[152:155], v[44:47]
    ds_read_b64_tr_b16 a[198:199], v201 offset:12288
    ds_read_b64_tr_b16 a[200:201], v202 offset:8192
    v_mfma_f32_16x16x32_bf16 v[76:79], a[168:171], v[168:171], v[76:79]
    v_exp_f32 v35, v35
    v_mfma_f32_16x16x32_bf16 v[108:111], a[168:171], v[184:187], v[108:111]
    ds_read_b64_tr_b16 a[202:203], v202 offset:12288
    v_cvt_pk_bf16_f32 v49, v34, v35
    v_mfma_f32_16x16x32_bf16 v[8:11], a[156:159], v[140:143], v[8:11]
    v_exp_f32 v36, v36
    v_mfma_f32_16x16x32_bf16 v[40:43], a[156:159], v[156:159], v[40:43]
    buffer_store_dwordx4 a[224:227], v221, s[20:23], s56 offen offset:0 sc1
    v_mfma_f32_16x16x32_bf16 v[72:75], a[156:159], v[172:175], v[72:75]
    v_exp_f32 v37, v37
    v_mfma_f32_16x16x32_bf16 v[104:107], a[156:159], v[188:191], v[104:107]
    ds_read_b64_tr_b16 a[204:205], v203 offset:8192
    v_cvt_pk_bf16_f32 v50, v36, v37
    v_mfma_f32_16x16x32_bf16 v[12:15], a[172:175], v[140:143], v[12:15]
    v_exp_f32 v38, v38
    v_mfma_f32_16x16x32_bf16 v[44:47], a[172:175], v[156:159], v[44:47]
    ds_read_b64_tr_b16 a[206:207], v203 offset:12288
    v_mfma_f32_16x16x32_bf16 v[76:79], a[172:175], v[172:175], v[76:79]
    v_exp_f32 v39, v39
    v_mfma_f32_16x16x32_bf16 v[108:111], a[172:175], v[188:191], v[108:111]
    s_waitcnt vmcnt(16) lgkmcnt(0)
    v_cvt_pk_bf16_f32 v51, v38, v39
    s_barrier
    v_mfma_f32_16x16x32_bf16 a[0:3], a[176:179], v[20:23], a[0:3]
    v_exp_f32 v64, v64
    v_mfma_f32_16x16x32_bf16 a[32:35], a[176:179], v[52:55], a[32:35]
    ds_read_b128 a[144:147], v192 offset:0
    v_mfma_f32_16x16x32_bf16 a[64:67], a[176:179], v[84:87], a[64:67]
    v_exp_f32 v65, v65
    v_mfma_f32_16x16x32_bf16 a[96:99], a[176:179], v[116:119], a[96:99]
    ds_read_b128 a[160:163], v192 offset:4096
    v_cvt_pk_bf16_f32 v80, v64, v65
    v_mfma_f32_16x16x32_bf16 a[4:7], a[180:183], v[20:23], a[4:7]
    v_exp_f32 v66, v66
    v_mfma_f32_16x16x32_bf16 a[36:39], a[180:183], v[52:55], a[36:39]
    buffer_store_dwordx4 v[224:227], v221, s[20:23], s57 offen offset:0 sc1
    v_mfma_f32_16x16x32_bf16 a[68:71], a[180:183], v[84:87], a[68:71]
    v_exp_f32 v67, v67
    v_mfma_f32_16x16x32_bf16 a[100:103], a[180:183], v[116:119], a[100:103]
    ds_read_b128 a[148:151], v193 offset:0
    v_cvt_pk_bf16_f32 v81, v66, v67
    v_mfma_f32_16x16x32_bf16 a[8:11], a[184:187], v[20:23], a[8:11]
    v_exp_f32 v68, v68
    v_mfma_f32_16x16x32_bf16 a[40:43], a[184:187], v[52:55], a[40:43]
    ds_read_b128 a[164:167], v193 offset:4096
    v_mfma_f32_16x16x32_bf16 a[72:75], a[184:187], v[84:87], a[72:75]
    v_exp_f32 v69, v69
    v_mfma_f32_16x16x32_bf16 a[104:107], a[184:187], v[116:119], a[104:107]
    ds_read_b128 a[152:155], v194 offset:0
    v_cvt_pk_bf16_f32 v82, v68, v69
    v_mfma_f32_16x16x32_bf16 a[12:15], a[188:191], v[20:23], a[12:15]
    v_exp_f32 v70, v70
    v_mfma_f32_16x16x32_bf16 a[44:47], a[188:191], v[52:55], a[44:47]
    ds_read_b128 a[168:171], v194 offset:4096
    v_mfma_f32_16x16x32_bf16 a[76:79], a[188:191], v[84:87], a[76:79]
    v_exp_f32 v71, v71
    v_mfma_f32_16x16x32_bf16 a[108:111], a[188:191], v[116:119], a[108:111]
    ds_read_b128 a[156:159], v195 offset:0
    v_cvt_pk_bf16_f32 v83, v70, v71
    v_mfma_f32_16x16x32_bf16 a[16:19], a[192:195], v[20:23], a[16:19]
    v_exp_f32 v96, v96
    v_mfma_f32_16x16x32_bf16 a[48:51], a[192:195], v[52:55], a[48:51]
    buffer_store_dwordx4 v[240:243], v221, s[20:23], s58 offen offset:0 sc1
    v_mfma_f32_16x16x32_bf16 a[80:83], a[192:195], v[84:87], a[80:83]
    v_exp_f32 v97, v97
    v_mfma_f32_16x16x32_bf16 a[112:115], a[192:195], v[116:119], a[112:115]
    ds_read_b128 a[172:175], v195 offset:4096
    v_cvt_pk_bf16_f32 v112, v96, v97
    v_mfma_f32_16x16x32_bf16 a[20:23], a[196:199], v[20:23], a[20:23]
    v_exp_f32 v98, v98
    v_mfma_f32_16x16x32_bf16 a[52:55], a[196:199], v[52:55], a[52:55]
    v_add_u32 v196, 16384, v196
    v_add_u32 v197, 16384, v197
    v_mfma_f32_16x16x32_bf16 a[84:87], a[196:199], v[84:87], a[84:87]
    v_exp_f32 v99, v99
    v_mfma_f32_16x16x32_bf16 a[116:119], a[196:199], v[116:119], a[116:119]
    v_cvt_pk_bf16_f32 v113, v98, v99
    v_add_u32 v198, 16384, v198
    v_mfma_f32_16x16x32_bf16 a[24:27], a[200:203], v[20:23], a[24:27]
    v_exp_f32 v100, v100
    v_mfma_f32_16x16x32_bf16 a[56:59], a[200:203], v[52:55], a[56:59]
    v_add_u32 v199, 16384, v199
    v_add_u32 v200, 16384, v200
    v_mfma_f32_16x16x32_bf16 a[88:91], a[200:203], v[84:87], a[88:91]
    v_exp_f32 v101, v101
    v_mfma_f32_16x16x32_bf16 a[120:123], a[200:203], v[116:119], a[120:123]
    v_cvt_pk_bf16_f32 v114, v100, v101
    v_add_u32 v201, 16384, v201
    v_mfma_f32_16x16x32_bf16 a[28:31], a[204:207], v[20:23], a[28:31]
    v_exp_f32 v102, v102
    v_mfma_f32_16x16x32_bf16 a[60:63], a[204:207], v[52:55], a[60:63]
    v_add_u32 v202, 16384, v202
    v_add_u32 v203, 16384, v203
    v_mfma_f32_16x16x32_bf16 a[92:95], a[204:207], v[84:87], a[92:95]
    v_exp_f32 v103, v103
    v_mfma_f32_16x16x32_bf16 a[124:127], a[204:207], v[116:119], a[124:127]
    v_cvt_pk_bf16_f32 v115, v102, v103
    v_mfma_f32_16x16x32_bf16 a[128:131], a[240:243], v[20:23], a[128:131]
    v_mfma_f32_16x16x32_bf16 a[132:135], a[240:243], v[52:55], a[132:135]
    buffer_store_dwordx4 a[212:215], v221, s[20:23], s55 offen offset:1024 sc1
    v_mfma_f32_16x16x32_bf16 a[136:139], a[240:243], v[84:87], a[136:139]
    v_mfma_f32_16x16x32_bf16 a[140:143], a[240:243], v[116:119], a[140:143]
    s_waitcnt lgkmcnt(0)
    v_mfma_f32_16x16x32_bf16 v[0:3], a[144:147], v[128:131], v[24:27]
    v_exp_f32 v8, v8
    v_mfma_f32_16x16x32_bf16 v[32:35], a[144:147], v[144:147], v[56:59]
    buffer_store_dwordx4 a[228:231], v221, s[20:23], s56 offen offset:1024 sc1
    v_mfma_f32_16x16x32_bf16 v[64:67], a[144:147], v[160:163], v[88:91]
    v_exp_f32 v9, v9
    v_mfma_f32_16x16x32_bf16 v[96:99], a[144:147], v[176:179], v[120:123]
    ds_read_b64_tr_b16 a[176:177], v196 offset:0
    v_cvt_pk_bf16_f32 v20, v8, v9
    v_mfma_f32_16x16x32_bf16 v[4:7], a[160:163], v[128:131], v[24:27]
    v_exp_f32 v10, v10
    v_mfma_f32_16x16x32_bf16 v[36:39], a[160:163], v[144:147], v[56:59]
    ds_read_b64_tr_b16 a[178:179], v196 offset:4096
    ds_read_b64_tr_b16 a[180:181], v197 offset:0
    v_mfma_f32_16x16x32_bf16 v[68:71], a[160:163], v[160:163], v[88:91]
    v_exp_f32 v11, v11
    v_mfma_f32_16x16x32_bf16 v[100:103], a[160:163], v[176:179], v[120:123]
    ds_read_b64_tr_b16 a[182:183], v197 offset:4096
    v_cvt_pk_bf16_f32 v21, v10, v11
    v_mfma_f32_16x16x32_bf16 v[0:3], a[148:151], v[132:135], v[0:3]
    v_exp_f32 v12, v12
    v_mfma_f32_16x16x32_bf16 v[32:35], a[148:151], v[148:151], v[32:35]
    ds_read_b64_tr_b16 a[184:185], v198 offset:0
    ds_read_b64_tr_b16 a[186:187], v198 offset:4096
    v_mfma_f32_16x16x32_bf16 v[64:67], a[148:151], v[164:167], v[64:67]
    v_exp_f32 v13, v13
    v_mfma_f32_16x16x32_bf16 v[96:99], a[148:151], v[180:183], v[96:99]
    ds_read_b64_tr_b16 a[188:189], v199 offset:0
    v_cvt_pk_bf16_f32 v22, v12, v13
    v_mfma_f32_16x16x32_bf16 v[4:7], a[164:167], v[132:135], v[4:7]
    v_exp_f32 v14, v14
    v_mfma_f32_16x16x32_bf16 v[36:39], a[164:167], v[148:151], v[36:39]
    buffer_store_dwordx4 v[228:231], v221, s[20:23], s57 offen offset:1024 sc1
    v_mfma_f32_16x16x32_bf16 v[68:71], a[164:167], v[164:167], v[68:71]
    v_exp_f32 v15, v15
    v_mfma_f32_16x16x32_bf16 v[100:103], a[164:167], v[180:183], v[100:103]
    ds_read_b64_tr_b16 a[190:191], v199 offset:4096
    v_cvt_pk_bf16_f32 v23, v14, v15
    v_mfma_f32_16x16x32_bf16 v[0:3], a[152:155], v[136:139], v[0:3]
    v_exp_f32 v40, v40
    v_mfma_f32_16x16x32_bf16 v[32:35], a[152:155], v[152:155], v[32:35]
    ds_read_b64_tr_b16 a[192:193], v200 offset:0
    ds_read_b64_tr_b16 a[194:195], v200 offset:4096
    v_mfma_f32_16x16x32_bf16 v[64:67], a[152:155], v[168:171], v[64:67]
    v_exp_f32 v41, v41
    v_mfma_f32_16x16x32_bf16 v[96:99], a[152:155], v[184:187], v[96:99]
    ds_read_b64_tr_b16 a[196:197], v201 offset:0
    v_cvt_pk_bf16_f32 v52, v40, v41
    v_mfma_f32_16x16x32_bf16 v[4:7], a[168:171], v[136:139], v[4:7]
    v_exp_f32 v42, v42
    v_mfma_f32_16x16x32_bf16 v[36:39], a[168:171], v[152:155], v[36:39]
    ds_read_b64_tr_b16 a[198:199], v201 offset:4096
    ds_read_b64_tr_b16 a[200:201], v202 offset:0
    v_mfma_f32_16x16x32_bf16 v[68:71], a[168:171], v[168:171], v[68:71]
    v_exp_f32 v43, v43
    v_mfma_f32_16x16x32_bf16 v[100:103], a[168:171], v[184:187], v[100:103]
    ds_read_b64_tr_b16 a[202:203], v202 offset:4096
    v_cvt_pk_bf16_f32 v53, v42, v43
    v_mfma_f32_16x16x32_bf16 v[0:3], a[156:159], v[140:143], v[0:3]
    v_exp_f32 v44, v44
    v_mfma_f32_16x16x32_bf16 v[32:35], a[156:159], v[156:159], v[32:35]
    buffer_store_dwordx4 v[244:247], v221, s[20:23], s58 offen offset:1024 sc1
    v_mfma_f32_16x16x32_bf16 v[64:67], a[156:159], v[172:175], v[64:67]
    v_exp_f32 v45, v45
    v_mfma_f32_16x16x32_bf16 v[96:99], a[156:159], v[188:191], v[96:99]
    ds_read_b64_tr_b16 a[204:205], v203 offset:0
    v_cvt_pk_bf16_f32 v54, v44, v45
    v_mfma_f32_16x16x32_bf16 v[4:7], a[172:175], v[140:143], v[4:7]
    v_exp_f32 v46, v46
    v_mfma_f32_16x16x32_bf16 v[36:39], a[172:175], v[156:159], v[36:39]
    ds_read_b64_tr_b16 a[206:207], v203 offset:4096
    v_mfma_f32_16x16x32_bf16 v[68:71], a[172:175], v[172:175], v[68:71]
    v_exp_f32 v47, v47
    v_mfma_f32_16x16x32_bf16 v[100:103], a[172:175], v[188:191], v[100:103]
    s_waitcnt lgkmcnt(0)
    v_cvt_pk_bf16_f32 v55, v46, v47
    v_mfma_f32_16x16x32_bf16 a[0:3], a[176:179], v[16:19], a[0:3]
    v_exp_f32 v72, v72
    v_mfma_f32_16x16x32_bf16 a[32:35], a[176:179], v[48:51], a[32:35]
    buffer_store_dwordx4 a[216:219], v221, s[20:23], s55 offen offset:2048 sc1
    v_mfma_f32_16x16x32_bf16 a[64:67], a[176:179], v[80:83], a[64:67]
    v_exp_f32 v73, v73
    v_mfma_f32_16x16x32_bf16 a[96:99], a[176:179], v[112:115], a[96:99]
    ds_read_b128 a[144:147], v192 offset:8192
    v_cvt_pk_bf16_f32 v84, v72, v73
    v_mfma_f32_16x16x32_bf16 a[4:7], a[180:183], v[16:19], a[4:7]
    v_exp_f32 v74, v74
    v_mfma_f32_16x16x32_bf16 a[36:39], a[180:183], v[48:51], a[36:39]
    ds_read_b128 a[160:163], v192 offset:12288
    v_mfma_f32_16x16x32_bf16 a[68:71], a[180:183], v[80:83], a[68:71]
    v_exp_f32 v75, v75
    v_mfma_f32_16x16x32_bf16 a[100:103], a[180:183], v[112:115], a[100:103]
    ds_read_b128 a[148:151], v193 offset:8192
    v_cvt_pk_bf16_f32 v85, v74, v75
    v_mfma_f32_16x16x32_bf16 a[8:11], a[184:187], v[16:19], a[8:11]
    v_exp_f32 v76, v76
    v_mfma_f32_16x16x32_bf16 a[40:43], a[184:187], v[48:51], a[40:43]
    buffer_store_dwordx4 a[232:235], v221, s[20:23], s56 offen offset:2048 sc1
    v_mfma_f32_16x16x32_bf16 a[72:75], a[184:187], v[80:83], a[72:75]
    v_exp_f32 v77, v77
    v_mfma_f32_16x16x32_bf16 a[104:107], a[184:187], v[112:115], a[104:107]
    ds_read_b128 a[164:167], v193 offset:12288
    v_cvt_pk_bf16_f32 v86, v76, v77
    v_mfma_f32_16x16x32_bf16 a[12:15], a[188:191], v[16:19], a[12:15]
    v_exp_f32 v78, v78
    v_mfma_f32_16x16x32_bf16 a[44:47], a[188:191], v[48:51], a[44:47]
    ds_read_b128 a[152:155], v194 offset:8192
    v_mfma_f32_16x16x32_bf16 a[76:79], a[188:191], v[80:83], a[76:79]
    v_exp_f32 v79, v79
    v_mfma_f32_16x16x32_bf16 a[108:111], a[188:191], v[112:115], a[108:111]
    ds_read_b128 a[168:171], v194 offset:12288
    v_cvt_pk_bf16_f32 v87, v78, v79
    v_mfma_f32_16x16x32_bf16 a[16:19], a[192:195], v[16:19], a[16:19]
    v_exp_f32 v104, v104
    v_mfma_f32_16x16x32_bf16 a[48:51], a[192:195], v[48:51], a[48:51]
    buffer_store_dwordx4 v[232:235], v221, s[20:23], s57 offen offset:2048 sc1
    v_mfma_f32_16x16x32_bf16 a[80:83], a[192:195], v[80:83], a[80:83]
    v_exp_f32 v105, v105
    v_mfma_f32_16x16x32_bf16 a[112:115], a[192:195], v[112:115], a[112:115]
    ds_read_b128 a[156:159], v195 offset:8192
    v_cvt_pk_bf16_f32 v116, v104, v105
    v_mfma_f32_16x16x32_bf16 a[20:23], a[196:199], v[16:19], a[20:23]
    v_exp_f32 v106, v106
    v_mfma_f32_16x16x32_bf16 a[52:55], a[196:199], v[48:51], a[52:55]
    ds_read_b128 a[172:175], v195 offset:12288
    v_mfma_f32_16x16x32_bf16 a[84:87], a[196:199], v[80:83], a[84:87]
    v_exp_f32 v107, v107
    v_mfma_f32_16x16x32_bf16 a[116:119], a[196:199], v[112:115], a[116:119]
    v_cvt_pk_bf16_f32 v117, v106, v107
    v_mfma_f32_16x16x32_bf16 a[24:27], a[200:203], v[16:19], a[24:27]
    v_exp_f32 v108, v108
    v_mfma_f32_16x16x32_bf16 a[56:59], a[200:203], v[48:51], a[56:59]
    buffer_store_dwordx4 v[248:251], v221, s[20:23], s58 offen offset:2048 sc1
    v_mfma_f32_16x16x32_bf16 a[88:91], a[200:203], v[80:83], a[88:91]
    v_exp_f32 v109, v109
    v_mfma_f32_16x16x32_bf16 a[120:123], a[200:203], v[112:115], a[120:123]
    v_cvt_pk_bf16_f32 v118, v108, v109
    v_mfma_f32_16x16x32_bf16 a[28:31], a[204:207], v[16:19], a[28:31]
    v_exp_f32 v110, v110
    v_mfma_f32_16x16x32_bf16 a[60:63], a[204:207], v[48:51], a[60:63]
    v_mfma_f32_16x16x32_bf16 a[92:95], a[204:207], v[80:83], a[92:95]
    v_exp_f32 v111, v111
    v_mfma_f32_16x16x32_bf16 a[124:127], a[204:207], v[112:115], a[124:127]
    v_cvt_pk_bf16_f32 v119, v110, v111
    v_mfma_f32_16x16x32_bf16 a[128:131], a[240:243], v[16:19], a[128:131]
    v_mfma_f32_16x16x32_bf16 a[132:135], a[240:243], v[48:51], a[132:135]
    buffer_store_dwordx4 a[220:223], v221, s[20:23], s55 offen offset:3072 sc1
    v_mfma_f32_16x16x32_bf16 a[136:139], a[240:243], v[80:83], a[136:139]
    v_mfma_f32_16x16x32_bf16 a[140:143], a[240:243], v[112:115], a[140:143]
    s_waitcnt lgkmcnt(0)
    v_mfma_f32_16x16x32_bf16 v[8:11], a[144:147], v[128:131], v[24:27]
    v_exp_f32 v0, v0
    v_mfma_f32_16x16x32_bf16 v[40:43], a[144:147], v[144:147], v[56:59]
    buffer_store_dwordx4 a[236:239], v221, s[20:23], s56 offen offset:3072 sc1
    v_mfma_f32_16x16x32_bf16 v[72:75], a[144:147], v[160:163], v[88:91]
    v_exp_f32 v1, v1
    v_mfma_f32_16x16x32_bf16 v[104:107], a[144:147], v[176:179], v[120:123]
    ds_read_b64_tr_b16 a[176:177], v196 offset:8192
    v_cvt_pk_bf16_f32 v16, v0, v1
    v_mfma_f32_16x16x32_bf16 v[12:15], a[160:163], v[128:131], v[24:27]
    v_exp_f32 v2, v2
    v_mfma_f32_16x16x32_bf16 v[44:47], a[160:163], v[144:147], v[56:59]
    ds_read_b64_tr_b16 a[178:179], v196 offset:12288
    ds_read_b64_tr_b16 a[180:181], v197 offset:8192
    v_mfma_f32_16x16x32_bf16 v[76:79], a[160:163], v[160:163], v[88:91]
    v_exp_f32 v3, v3
    v_mfma_f32_16x16x32_bf16 v[108:111], a[160:163], v[176:179], v[120:123]
    ds_read_b64_tr_b16 a[182:183], v197 offset:12288
    v_cvt_pk_bf16_f32 v17, v2, v3
    v_mfma_f32_16x16x32_bf16 v[8:11], a[148:151], v[132:135], v[8:11]
    v_exp_f32 v4, v4
    v_mfma_f32_16x16x32_bf16 v[40:43], a[148:151], v[148:151], v[40:43]
    ds_read_b64_tr_b16 a[184:185], v198 offset:8192
    ds_read_b64_tr_b16 a[186:187], v198 offset:12288
    v_mfma_f32_16x16x32_bf16 v[72:75], a[148:151], v[164:167], v[72:75]
    v_exp_f32 v5, v5
    v_mfma_f32_16x16x32_bf16 v[104:107], a[148:151], v[180:183], v[104:107]
    ds_read_b64_tr_b16 a[188:189], v199 offset:8192
    v_cvt_pk_bf16_f32 v18, v4, v5
    v_mfma_f32_16x16x32_bf16 v[12:15], a[164:167], v[132:135], v[12:15]
    v_exp_f32 v6, v6
    v_mfma_f32_16x16x32_bf16 v[44:47], a[164:167], v[148:151], v[44:47]
    buffer_store_dwordx4 v[236:239], v221, s[20:23], s57 offen offset:3072 sc1
    v_mfma_f32_16x16x32_bf16 v[76:79], a[164:167], v[164:167], v[76:79]
    v_exp_f32 v7, v7
    v_mfma_f32_16x16x32_bf16 v[108:111], a[164:167], v[180:183], v[108:111]
    ds_read_b64_tr_b16 a[190:191], v199 offset:12288
    v_cvt_pk_bf16_f32 v19, v6, v7
    v_mfma_f32_16x16x32_bf16 v[8:11], a[152:155], v[136:139], v[8:11]
    v_exp_f32 v32, v32
    v_mfma_f32_16x16x32_bf16 v[40:43], a[152:155], v[152:155], v[40:43]
    ds_read_b64_tr_b16 a[192:193], v200 offset:8192
    ds_read_b64_tr_b16 a[194:195], v200 offset:12288
    v_mfma_f32_16x16x32_bf16 v[72:75], a[152:155], v[168:171], v[72:75]
    v_exp_f32 v33, v33
    v_mfma_f32_16x16x32_bf16 v[104:107], a[152:155], v[184:187], v[104:107]
    ds_read_b64_tr_b16 a[196:197], v201 offset:8192
    v_cvt_pk_bf16_f32 v48, v32, v33
    v_mfma_f32_16x16x32_bf16 v[12:15], a[168:171], v[136:139], v[12:15]
    v_exp_f32 v34, v34
    v_mfma_f32_16x16x32_bf16 v[44:47], a[168:171], v[152:155], v[44:47]
    ds_read_b64_tr_b16 a[198:199], v201 offset:12288
    ds_read_b64_tr_b16 a[200:201], v202 offset:8192
    v_mfma_f32_16x16x32_bf16 v[76:79], a[168:171], v[168:171], v[76:79]
    v_exp_f32 v35, v35
    v_mfma_f32_16x16x32_bf16 v[108:111], a[168:171], v[184:187], v[108:111]
    ds_read_b64_tr_b16 a[202:203], v202 offset:12288
    v_cvt_pk_bf16_f32 v49, v34, v35
    v_mfma_f32_16x16x32_bf16 v[8:11], a[156:159], v[140:143], v[8:11]
    v_exp_f32 v36, v36
    v_mfma_f32_16x16x32_bf16 v[40:43], a[156:159], v[156:159], v[40:43]
    buffer_store_dwordx4 v[252:255], v221, s[20:23], s58 offen offset:3072 sc1
    v_mfma_f32_16x16x32_bf16 v[72:75], a[156:159], v[172:175], v[72:75]
    v_exp_f32 v37, v37
    v_mfma_f32_16x16x32_bf16 v[104:107], a[156:159], v[188:191], v[104:107]
    ds_read_b64_tr_b16 a[204:205], v203 offset:8192
    v_cvt_pk_bf16_f32 v50, v36, v37
    v_mfma_f32_16x16x32_bf16 v[12:15], a[172:175], v[140:143], v[12:15]
    v_exp_f32 v38, v38
    v_mfma_f32_16x16x32_bf16 v[44:47], a[172:175], v[156:159], v[44:47]
    ds_read_b64_tr_b16 a[206:207], v203 offset:12288
    v_mfma_f32_16x16x32_bf16 v[76:79], a[172:175], v[172:175], v[76:79]
    v_exp_f32 v39, v39
    v_mfma_f32_16x16x32_bf16 v[108:111], a[172:175], v[188:191], v[108:111]
    s_waitcnt vmcnt(24) lgkmcnt(0)
    v_cvt_pk_bf16_f32 v51, v38, v39
    s_barrier
    v_mfma_f32_16x16x32_bf16 a[0:3], a[176:179], v[20:23], a[0:3]
    s_xor_b32 s52, s30, 0
    v_exp_f32 v64, v64
    v_mfma_f32_16x16x32_bf16 a[32:35], a[176:179], v[52:55], a[32:35]
    s_lshl_b32 s52, s52, 15
    v_mfma_f32_16x16x32_bf16 a[64:67], a[176:179], v[84:87], a[64:67]
    s_add_u32 m0, s53, 0
    v_exp_f32 v65, v65
    v_mfma_f32_16x16x32_bf16 a[96:99], a[176:179], v[116:119], a[96:99]
    buffer_load_dwordx4 v205, s[16:19], s52 offen lds
    v_cvt_pk_bf16_f32 v80, v64, v65
    v_mfma_f32_16x16x32_bf16 a[4:7], a[180:183], v[20:23], a[4:7]
    v_exp_f32 v66, v66
    v_mfma_f32_16x16x32_bf16 a[36:39], a[180:183], v[52:55], a[36:39]
    buffer_load_dwordx4 v206, s[16:19], s52 offen offset:1024 lds
    v_mfma_f32_16x16x32_bf16 a[68:71], a[180:183], v[84:87], a[68:71]
    s_xor_b32 s52, s30, 1
    v_exp_f32 v67, v67
    v_mfma_f32_16x16x32_bf16 a[100:103], a[180:183], v[116:119], a[100:103]
    s_lshl_b32 s52, s52, 15
    v_cvt_pk_bf16_f32 v81, v66, v67
    v_mfma_f32_16x16x32_bf16 a[8:11], a[184:187], v[20:23], a[8:11]
    s_add_u32 m0, s53, 8192
    v_exp_f32 v68, v68
    v_mfma_f32_16x16x32_bf16 a[40:43], a[184:187], v[52:55], a[40:43]
    buffer_load_dwordx4 v205, s[16:19], s52 offen lds
    v_mfma_f32_16x16x32_bf16 a[72:75], a[184:187], v[84:87], a[72:75]
    v_exp_f32 v69, v69
    v_mfma_f32_16x16x32_bf16 a[104:107], a[184:187], v[116:119], a[104:107]
    v_cvt_pk_bf16_f32 v82, v68, v69
    v_mfma_f32_16x16x32_bf16 a[12:15], a[188:191], v[20:23], a[12:15]
    v_exp_f32 v70, v70
    v_mfma_f32_16x16x32_bf16 a[44:47], a[188:191], v[52:55], a[44:47]
    buffer_load_dwordx4 v206, s[16:19], s52 offen offset:1024 lds
    v_mfma_f32_16x16x32_bf16 a[76:79], a[188:191], v[84:87], a[76:79]
    s_xor_b32 s52, s30, 2
    v_exp_f32 v71, v71
    v_mfma_f32_16x16x32_bf16 a[108:111], a[188:191], v[116:119], a[108:111]
    s_lshl_b32 s52, s52, 15
    v_cvt_pk_bf16_f32 v83, v70, v71
    v_mfma_f32_16x16x32_bf16 a[16:19], a[192:195], v[20:23], a[16:19]
    s_add_u32 m0, s53, 16384
    v_exp_f32 v96, v96
    v_mfma_f32_16x16x32_bf16 a[48:51], a[192:195], v[52:55], a[48:51]
    buffer_load_dwordx4 v205, s[16:19], s52 offen lds
    v_mfma_f32_16x16x32_bf16 a[80:83], a[192:195], v[84:87], a[80:83]
    v_exp_f32 v97, v97
    v_mfma_f32_16x16x32_bf16 a[112:115], a[192:195], v[116:119], a[112:115]
    buffer_load_dwordx4 v206, s[16:19], s52 offen offset:1024 lds
    v_cvt_pk_bf16_f32 v112, v96, v97
    v_mfma_f32_16x16x32_bf16 a[20:23], a[196:199], v[20:23], a[20:23]
    v_exp_f32 v98, v98
    v_mfma_f32_16x16x32_bf16 a[52:55], a[196:199], v[52:55], a[52:55]
    v_add_u32 v196, 16384, v196
    v_add_u32 v197, 16384, v197
    v_mfma_f32_16x16x32_bf16 a[84:87], a[196:199], v[84:87], a[84:87]
    v_exp_f32 v99, v99
    v_mfma_f32_16x16x32_bf16 a[116:119], a[196:199], v[116:119], a[116:119]
    v_cvt_pk_bf16_f32 v113, v98, v99
    v_add_u32 v198, 16384, v198
    v_mfma_f32_16x16x32_bf16 a[24:27], a[200:203], v[20:23], a[24:27]
    v_exp_f32 v100, v100
    v_mfma_f32_16x16x32_bf16 a[56:59], a[200:203], v[52:55], a[56:59]
    v_add_u32 v199, 16384, v199
    v_add_u32 v200, 16384, v200
    v_mfma_f32_16x16x32_bf16 a[88:91], a[200:203], v[84:87], a[88:91]
    v_exp_f32 v101, v101
    v_mfma_f32_16x16x32_bf16 a[120:123], a[200:203], v[116:119], a[120:123]
    v_cvt_pk_bf16_f32 v114, v100, v101
    v_add_u32 v201, 16384, v201
    v_mfma_f32_16x16x32_bf16 a[28:31], a[204:207], v[20:23], a[28:31]
    v_exp_f32 v102, v102
    v_mfma_f32_16x16x32_bf16 a[60:63], a[204:207], v[52:55], a[60:63]
    v_add_u32 v202, 16384, v202
    v_add_u32 v203, 16384, v203
    v_mfma_f32_16x16x32_bf16 a[92:95], a[204:207], v[84:87], a[92:95]
    v_exp_f32 v103, v103
    v_mfma_f32_16x16x32_bf16 a[124:127], a[204:207], v[116:119], a[124:127]
    v_cvt_pk_bf16_f32 v115, v102, v103
    v_mfma_f32_16x16x32_bf16 a[128:131], a[240:243], v[20:23], a[128:131]
    v_mfma_f32_16x16x32_bf16 a[132:135], a[240:243], v[52:55], a[132:135]
    v_mfma_f32_16x16x32_bf16 a[136:139], a[240:243], v[84:87], a[136:139]
    v_mfma_f32_16x16x32_bf16 a[140:143], a[240:243], v[116:119], a[140:143]
    ds_read_b64_tr_b16 a[176:177], v196 offset:0
    ds_read_b64_tr_b16 a[178:179], v196 offset:4096
    ds_read_b64_tr_b16 a[180:181], v197 offset:0
    ds_read_b64_tr_b16 a[182:183], v197 offset:4096
    ds_read_b64_tr_b16 a[184:185], v198 offset:0
    ds_read_b64_tr_b16 a[186:187], v198 offset:4096
    ds_read_b64_tr_b16 a[188:189], v199 offset:0
    ds_read_b64_tr_b16 a[190:191], v199 offset:4096
    ds_read_b64_tr_b16 a[192:193], v200 offset:0
    ds_read_b64_tr_b16 a[194:195], v200 offset:4096
    ds_read_b64_tr_b16 a[196:197], v201 offset:0
    ds_read_b64_tr_b16 a[198:199], v201 offset:4096
    ds_read_b64_tr_b16 a[200:201], v202 offset:0
    ds_read_b64_tr_b16 a[202:203], v202 offset:4096
    ds_read_b64_tr_b16 a[204:205], v203 offset:0
    ds_read_b64_tr_b16 a[206:207], v203 offset:4096
    v_exp_f32 v8, v8
    v_exp_f32 v9, v9
    v_exp_f32 v10, v10
    v_exp_f32 v11, v11
    v_cvt_pk_bf16_f32 v20, v8, v9
    v_exp_f32 v12, v12
    v_exp_f32 v13, v13
    v_cvt_pk_bf16_f32 v21, v10, v11
    v_exp_f32 v14, v14
    s_waitcnt lgkmcnt(0)
    v_mfma_f32_16x16x32_bf16 a[0:3], a[176:179], v[16:19], a[0:3]
    ds_read_b64_tr_b16 a[144:145], v196 offset:8192
    ds_read_b64_tr_b16 a[146:147], v196 offset:12288
    v_mfma_f32_16x16x32_bf16 a[32:35], a[176:179], v[48:51], a[32:35]
    ds_read_b64_tr_b16 a[148:149], v197 offset:8192
    ds_read_b64_tr_b16 a[150:151], v197 offset:12288
    v_mfma_f32_16x16x32_bf16 a[64:67], a[176:179], v[80:83], a[64:67]
    ds_read_b64_tr_b16 a[152:153], v198 offset:8192
    ds_read_b64_tr_b16 a[154:155], v198 offset:12288
    v_mfma_f32_16x16x32_bf16 a[96:99], a[176:179], v[112:115], a[96:99]
    ds_read_b64_tr_b16 a[156:157], v199 offset:8192
    ds_read_b64_tr_b16 a[158:159], v199 offset:12288
    v_mfma_f32_16x16x32_bf16 a[4:7], a[180:183], v[16:19], a[4:7]
    ds_read_b64_tr_b16 a[160:161], v200 offset:8192
    ds_read_b64_tr_b16 a[162:163], v200 offset:12288
    v_mfma_f32_16x16x32_bf16 a[36:39], a[180:183], v[48:51], a[36:39]
    ds_read_b64_tr_b16 a[164:165], v201 offset:8192
    ds_read_b64_tr_b16 a[166:167], v201 offset:12288
    v_mfma_f32_16x16x32_bf16 a[68:71], a[180:183], v[80:83], a[68:71]
    s_xor_b32 s52, s30, 3
    ds_read_b64_tr_b16 a[168:169], v202 offset:8192
    ds_read_b64_tr_b16 a[170:171], v202 offset:12288
    v_mfma_f32_16x16x32_bf16 a[100:103], a[180:183], v[112:115], a[100:103]
    s_lshl_b32 s52, s52, 15
    ds_read_b64_tr_b16 a[172:173], v203 offset:8192
    ds_read_b64_tr_b16 a[174:175], v203 offset:12288
    v_mfma_f32_16x16x32_bf16 a[8:11], a[184:187], v[16:19], a[8:11]
    s_add_u32 m0, s53, 24576
    v_exp_f32 v15, v15
    v_mfma_f32_16x16x32_bf16 a[40:43], a[184:187], v[48:51], a[40:43]
    buffer_load_dwordx4 v205, s[16:19], s52 offen lds
    v_mfma_f32_16x16x32_bf16 a[72:75], a[184:187], v[80:83], a[72:75]
    v_cvt_pk_bf16_f32 v22, v12, v13
    v_mfma_f32_16x16x32_bf16 a[104:107], a[184:187], v[112:115], a[104:107]
    v_exp_f32 v40, v40
    v_mfma_f32_16x16x32_bf16 a[12:15], a[188:191], v[16:19], a[12:15]
    buffer_load_dwordx4 v206, s[16:19], s52 offen offset:1024 lds
    v_mfma_f32_16x16x32_bf16 a[44:47], a[188:191], v[48:51], a[44:47]
    s_xor_b32 s52, s30, 4
    v_exp_f32 v41, v41
    v_mfma_f32_16x16x32_bf16 a[76:79], a[188:191], v[80:83], a[76:79]
    s_lshl_b32 s52, s52, 15
    v_cvt_pk_bf16_f32 v23, v14, v15
    v_mfma_f32_16x16x32_bf16 a[108:111], a[188:191], v[112:115], a[108:111]
    s_add_u32 m0, s53, 32768
    v_exp_f32 v42, v42
    v_mfma_f32_16x16x32_bf16 a[16:19], a[192:195], v[16:19], a[16:19]
    buffer_load_dwordx4 v205, s[16:19], s52 offen lds
    v_mfma_f32_16x16x32_bf16 a[48:51], a[192:195], v[48:51], a[48:51]
    v_exp_f32 v43, v43
    v_mfma_f32_16x16x32_bf16 a[80:83], a[192:195], v[80:83], a[80:83]
    v_cvt_pk_bf16_f32 v52, v40, v41
    v_mfma_f32_16x16x32_bf16 a[112:115], a[192:195], v[112:115], a[112:115]
    buffer_load_dwordx4 v206, s[16:19], s52 offen offset:1024 lds
    v_mfma_f32_16x16x32_bf16 a[20:23], a[196:199], v[16:19], a[20:23]
    v_exp_f32 v44, v44
    v_mfma_f32_16x16x32_bf16 a[52:55], a[196:199], v[48:51], a[52:55]
    v_exp_f32 v45, v45
    v_mfma_f32_16x16x32_bf16 a[84:87], a[196:199], v[80:83], a[84:87]
    v_cvt_pk_bf16_f32 v53, v42, v43
    v_mfma_f32_16x16x32_bf16 a[116:119], a[196:199], v[112:115], a[116:119]
    v_exp_f32 v46, v46
    v_mfma_f32_16x16x32_bf16 a[24:27], a[200:203], v[16:19], a[24:27]
    v_exp_f32 v47, v47
    v_mfma_f32_16x16x32_bf16 a[56:59], a[200:203], v[48:51], a[56:59]
    v_cvt_pk_bf16_f32 v54, v44, v45
    v_mfma_f32_16x16x32_bf16 a[88:91], a[200:203], v[80:83], a[88:91]
    v_exp_f32 v72, v72
    v_mfma_f32_16x16x32_bf16 a[120:123], a[200:203], v[112:115], a[120:123]
    v_exp_f32 v73, v73
    v_mfma_f32_16x16x32_bf16 a[28:31], a[204:207], v[16:19], a[28:31]
    v_cvt_pk_bf16_f32 v55, v46, v47
    v_mfma_f32_16x16x32_bf16 a[60:63], a[204:207], v[48:51], a[60:63]
    v_exp_f32 v74, v74
    v_mfma_f32_16x16x32_bf16 a[92:95], a[204:207], v[80:83], a[92:95]
    v_exp_f32 v75, v75
    v_mfma_f32_16x16x32_bf16 a[124:127], a[204:207], v[112:115], a[124:127]
    v_cvt_pk_bf16_f32 v84, v72, v73
    v_mfma_f32_16x16x32_bf16 a[128:131], a[240:243], v[16:19], a[128:131]
    v_exp_f32 v76, v76
    v_mfma_f32_16x16x32_bf16 a[132:135], a[240:243], v[48:51], a[132:135]
    v_exp_f32 v77, v77
    v_mfma_f32_16x16x32_bf16 a[136:139], a[240:243], v[80:83], a[136:139]
    v_cvt_pk_bf16_f32 v85, v74, v75
    v_mfma_f32_16x16x32_bf16 a[140:143], a[240:243], v[112:115], a[140:143]
    v_exp_f32 v78, v78
    v_exp_f32 v79, v79
    v_cvt_pk_bf16_f32 v86, v76, v77
    v_exp_f32 v104, v104
    v_exp_f32 v105, v105
    v_cvt_pk_bf16_f32 v87, v78, v79
    v_exp_f32 v106, v106
    v_exp_f32 v107, v107
    v_cvt_pk_bf16_f32 v116, v104, v105
    v_exp_f32 v108, v108
    v_exp_f32 v109, v109
    v_cvt_pk_bf16_f32 v117, v106, v107
    v_exp_f32 v110, v110
    v_exp_f32 v111, v111
    v_cvt_pk_bf16_f32 v118, v108, v109
    v_cvt_pk_bf16_f32 v119, v110, v111
    s_waitcnt lgkmcnt(0)
    v_mfma_f32_16x16x32_bf16 a[128:131], a[240:243], v[20:23], a[128:131]
    v_subrev_u32 v196, 49152, v196
    v_subrev_u32 v197, 49152, v197
    v_mfma_f32_16x16x32_bf16 a[132:135], a[240:243], v[52:55], a[132:135]
    v_subrev_u32 v198, 49152, v198
    v_subrev_u32 v199, 49152, v199
    v_mfma_f32_16x16x32_bf16 a[136:139], a[240:243], v[84:87], a[136:139]
    v_subrev_u32 v200, 49152, v200
    v_subrev_u32 v201, 49152, v201
    v_mfma_f32_16x16x32_bf16 a[140:143], a[240:243], v[116:119], a[140:143]
    s_mov_b32 s59, 0x53800000
    v_subrev_u32 v202, 49152, v202
    v_subrev_u32 v203, 49152, v203
    v_mfma_f32_16x16x32_bf16 a[0:3], a[144:147], v[20:23], a[0:3]
    v_mfma_f32_16x16x32_bf16 a[4:7], a[148:151], v[20:23], a[4:7]
    v_mfma_f32_16x16x32_bf16 a[8:11], a[152:155], v[20:23], a[8:11]
    v_mfma_f32_16x16x32_bf16 a[12:15], a[156:159], v[20:23], a[12:15]
    v_mfma_f32_16x16x32_bf16 a[16:19], a[160:163], v[20:23], a[16:19]
    v_mfma_f32_16x16x32_bf16 a[20:23], a[164:167], v[20:23], a[20:23]
    v_accvgpr_read_b32 v210, a128
    v_accvgpr_read_b32 v212, a132
    v_mfma_f32_16x16x32_bf16 a[24:27], a[168:171], v[20:23], a[24:27]
    v_accvgpr_read_b32 v214, a136
    v_accvgpr_read_b32 v216, a140
    v_mfma_f32_16x16x32_bf16 a[28:31], a[172:175], v[20:23], a[28:31]
    v_cmp_nge_f32 s[32:33], s59, v210
    v_cmp_nge_f32 s[34:35], s59, v212
    v_mfma_f32_16x16x32_bf16 a[32:35], a[144:147], v[52:55], a[32:35]
    v_cmp_nge_f32 s[36:37], s59, v214
    v_cmp_nge_f32 vcc, s59, v216
    v_mfma_f32_16x16x32_bf16 a[36:39], a[148:151], v[52:55], a[36:39]
    v_rcp_f32 v210, v210
    v_mfma_f32_16x16x32_bf16 a[40:43], a[152:155], v[52:55], a[40:43]
    v_rcp_f32 v212, v212
    v_mfma_f32_16x16x32_bf16 a[44:47], a[156:159], v[52:55], a[44:47]
    v_rcp_f32 v214, v214
    v_mfma_f32_16x16x32_bf16 a[48:51], a[160:163], v[52:55], a[48:51]
    s_or_b64 s[32:33], s[32:33], s[34:35]
    v_rcp_f32 v216, v216
    v_mfma_f32_16x16x32_bf16 a[52:55], a[164:167], v[52:55], a[52:55]
    s_or_b64 s[36:37], s[36:37], vcc
    v_mov_b32 v211, v210
    v_mov_b32 v213, v212
    v_mfma_f32_16x16x32_bf16 a[56:59], a[168:171], v[52:55], a[56:59]
    s_or_b64 s[32:33], s[32:33], s[36:37]
    v_mov_b32 v215, v214
    v_mov_b32 v217, v216
    s_cbranch_scc1 K1_SLOW
    v_mfma_f32_16x16x32_bf16 a[60:63], a[172:175], v[52:55], a[60:63]
    v_mfma_f32_16x16x32_bf16 a[64:67], a[144:147], v[84:87], a[64:67]
    v_mfma_f32_16x16x32_bf16 a[68:71], a[148:151], v[84:87], a[68:71]
    v_mfma_f32_16x16x32_bf16 a[72:75], a[152:155], v[84:87], a[72:75]
    v_mfma_f32_16x16x32_bf16 a[76:79], a[156:159], v[84:87], a[76:79]
    v_mfma_f32_16x16x32_bf16 a[80:83], a[160:163], v[84:87], a[80:83]
    v_mfma_f32_16x16x32_bf16 a[84:87], a[164:167], v[84:87], a[84:87]
    v_mfma_f32_16x16x32_bf16 a[88:91], a[168:171], v[84:87], a[88:91]
    v_mfma_f32_16x16x32_bf16 a[92:95], a[172:175], v[84:87], a[92:95]
    v_mfma_f32_16x16x32_bf16 a[96:99], a[144:147], v[116:119], a[96:99]
    v_mfma_f32_16x16x32_bf16 a[100:103], a[148:151], v[116:119], a[100:103]
    v_mfma_f32_16x16x32_bf16 a[104:107], a[152:155], v[116:119], a[104:107]
    v_mfma_f32_16x16x32_bf16 a[108:111], a[156:159], v[116:119], a[108:111]
    v_mfma_f32_16x16x32_bf16 a[112:115], a[160:163], v[116:119], a[112:115]
    v_mfma_f32_16x16x32_bf16 a[116:119], a[164:167], v[116:119], a[116:119]
    v_mfma_f32_16x16x32_bf16 a[120:123], a[168:171], v[116:119], a[120:123]
    v_mfma_f32_16x16x32_bf16 a[124:127], a[172:175], v[116:119], a[124:127]
K1_SLOW_RET2:
    s_load_dwordx2 s[36:37], s[0:1], 80
    s_lshl_b32 s59, s30, 10
    s_sub_u32 s4, s20, s59
    s_subb_u32 s5, s21, 0
    s_add_u32 s6, s22, s59
    s_lshr_b32 s3, s30, 1
    s_add_u32 s28, s3, s60
    s_mov_b32 s31, 0
    v_readfirstlane_b32 s54, v219
    v_lshrrev_b32 v204, 18, v218
    v_min_u32 v204, 12, v204
    s_add_u32 s45, s55, 4096
    s_add_u32 s48, s56, 4096
    s_add_u32 s49, s57, 4096
    s_add_u32 s101, s58, 4096
    s_waitcnt vmcnt(6) lgkmcnt(0)
    s_barrier
    ds_read_b64_tr_b16 a[144:145], v196 offset:0
    ds_read_b64_tr_b16 a[146:147], v196 offset:4096
    ds_read_b64_tr_b16 a[148:149], v197 offset:0
    ds_read_b64_tr_b16 a[150:151], v197 offset:4096
    ds_read_b64_tr_b16 a[152:153], v198 offset:0
    ds_read_b64_tr_b16 a[154:155], v198 offset:4096
    ds_read_b64_tr_b16 a[156:157], v199 offset:0
    ds_read_b64_tr_b16 a[158:159], v199 offset:4096
    ds_read_b64_tr_b16 a[160:161], v200 offset:0
    ds_read_b64_tr_b16 a[162:163], v200 offset:4096
    ds_read_b64_tr_b16 a[164:165], v201 offset:0
    ds_read_b64_tr_b16 a[166:167], v201 offset:4096
    ds_read_b64_tr_b16 a[168:169], v202 offset:0
    ds_read_b64_tr_b16 a[170:171], v202 offset:4096
    ds_read_b64_tr_b16 a[172:173], v203 offset:0
    ds_read_b64_tr_b16 a[174:175], v203 offset:4096
    v_accvgpr_read_b32 v128, a0
    v_accvgpr_read_b32 v129, a1
    v_accvgpr_read_b32 v130, a2
    v_accvgpr_read_b32 v131, a3
    v_accvgpr_read_b32 v132, a4
    v_accvgpr_read_b32 v133, a5
    v_accvgpr_read_b32 v134, a6
    v_accvgpr_read_b32 v135, a7
    v_pk_mul_f32 v[128:129], v[128:129], v[210:211]
    v_pk_mul_f32 v[130:131], v[130:131], v[210:211]
    v_pk_mul_f32 v[132:133], v[132:133], v[210:211]
    v_pk_mul_f32 v[134:135], v[134:135], v[210:211]
    v_cvt_pk_bf16_f32 v128, v128, v129
    v_cvt_pk_bf16_f32 v129, v130, v131
    v_cvt_pk_bf16_f32 v130, v132, v133
    v_cvt_pk_bf16_f32 v131, v134, v135
    v_accvgpr_read_b32 v132, a32
    v_accvgpr_read_b32 v133, a33
    v_accvgpr_read_b32 v134, a34
    v_accvgpr_read_b32 v135, a35
    v_accvgpr_read_b32 v136, a36
    v_accvgpr_read_b32 v137, a37
    v_accvgpr_read_b32 v138, a38
    v_accvgpr_read_b32 v139, a39
    v_pk_mul_f32 v[132:133], v[132:133], v[212:213]
    v_pk_mul_f32 v[134:135], v[134:135], v[212:213]
    v_pk_mul_f32 v[136:137], v[136:137], v[212:213]
    v_pk_mul_f32 v[138:139], v[138:139], v[212:213]
    v_cvt_pk_bf16_f32 v132, v132, v133
    v_cvt_pk_bf16_f32 v133, v134, v135
    v_cvt_pk_bf16_f32 v134, v136, v137
    v_cvt_pk_bf16_f32 v135, v138, v139
    v_accvgpr_read_b32 v136, a64
    v_accvgpr_read_b32 v137, a65
    v_accvgpr_read_b32 v138, a66
    v_accvgpr_read_b32 v139, a67
    v_accvgpr_read_b32 v140, a68
    v_accvgpr_read_b32 v141, a69
    v_accvgpr_read_b32 v142, a70
    v_accvgpr_read_b32 v143, a71
    v_pk_mul_f32 v[136:137], v[136:137], v[214:215]
    v_pk_mul_f32 v[138:139], v[138:139], v[214:215]
    v_pk_mul_f32 v[140:141], v[140:141], v[214:215]
    v_pk_mul_f32 v[142:143], v[142:143], v[214:215]
    v_cvt_pk_bf16_f32 v136, v136, v137
    v_cvt_pk_bf16_f32 v137, v138, v139
    v_cvt_pk_bf16_f32 v138, v140, v141
    v_cvt_pk_bf16_f32 v139, v142, v143
    v_accvgpr_read_b32 v140, a96
    v_accvgpr_read_b32 v141, a97
    v_accvgpr_read_b32 v142, a98
    v_accvgpr_read_b32 v143, a99
    v_accvgpr_read_b32 v144, a100
    v_accvgpr_read_b32 v145, a101
    v_accvgpr_read_b32 v146, a102
    v_accvgpr_read_b32 v147, a103
    v_pk_mul_f32 v[140:141], v[140:141], v[216:217]
    v_pk_mul_f32 v[142:143], v[142:143], v[216:217]
    v_pk_mul_f32 v[144:145], v[144:145], v[216:217]
    v_pk_mul_f32 v[146:147], v[146:147], v[216:217]
    v_cvt_pk_bf16_f32 v140, v140, v141
    v_cvt_pk_bf16_f32 v141, v142, v143
    v_cvt_pk_bf16_f32 v142, v144, v145
    v_cvt_pk_bf16_f32 v143, v146, v147
    s_and_b32 s35, s2, 3
    s_lshl_b32 s59, s35, 15
    s_sub_u32 s8, s20, s59
    s_subb_u32 s9, s21, 0
    s_add_u32 s10, s22, s59
    s_lshl_b32 s3, s44, 3
    s_add_u32 s3, s3, s42
    s_lshl_b32 s3, s3, 5
    s_add_u32 s3, s3, s30
    s_lshl_b32 s29, s3, 8
    s_add_u32 s29, s29, 32768
    s_lshr_b32 s3, s100, 3
    s_add_u32 s29, s29, s3
    s_lshl_b32 s3, s44, 10
    s_lshl_b32 s59, s30, 5
    s_add_u32 s3, s3, s59
    s_lshl_b32 s59, s35, 6
    s_add_u32 s3, s3, s59
    s_sub_u32 s26, 491520, s3
    s_mul_i32 s59, s42, 491520
    s_add_u32 s3, s3, s59
    s_add_u32 s24, s36, s3
    s_addc_u32 s25, s37, 0
    s_waitcnt lgkmcnt(0)
    buffer_store_dword v219, v218, s[12:15], s28 offen offset:0 sc1
    v_mfma_f32_16x16x32_bf16 v[0:3], a[144:147], a[208:211], 0
    s_xor_b32 s52, s30, 5
    v_accvgpr_read_b32 v144, a8
    v_accvgpr_read_b32 v145, a9
    v_mfma_f32_16x16x32_bf16 v[8:11], a[144:147], a[224:227], 0
    s_lshl_b32 s52, s52, 15
    v_accvgpr_read_b32 v146, a10
    v_accvgpr_read_b32 v147, a11
    v_mfma_f32_16x16x32_bf16 v[16:19], a[144:147], v[224:227], 0
    s_add_u32 m0, s53, 40960
    v_accvgpr_read_b32 v148, a12
    v_accvgpr_read_b32 v149, a13
    v_mfma_f32_16x16x32_bf16 v[24:27], a[144:147], v[240:243], 0
    s_waitcnt lgkmcnt(6)
    buffer_load_dwordx4 v205, s[16:19], s52 offen lds
    v_mfma_f32_16x16x32_bf16 v[4:7], a[148:151], a[208:211], 0
    ds_read_b64_tr_b16 a[144:145], v196 offset:8192
    v_accvgpr_read_b32 v150, a14
    v_mfma_f32_16x16x32_bf16 v[12:15], a[148:151], a[224:227], 0
    ds_read_b64_tr_b16 a[146:147], v196 offset:12288
    v_accvgpr_read_b32 v151, a15
    v_mfma_f32_16x16x32_bf16 v[20:23], a[148:151], v[224:227], 0
    v_mul_f32 v144, v144, v210
    v_mul_f32 v145, v145, v210
    v_mfma_f32_16x16x32_bf16 v[28:31], a[148:151], v[240:243], 0
    s_waitcnt lgkmcnt(6)
    v_mul_f32 v146, v146, v210
    v_mul_f32 v147, v147, v210
    v_mfma_f32_16x16x32_bf16 v[32:35], a[152:155], a[208:211], 0
    ds_read_b64_tr_b16 a[148:149], v197 offset:8192
    v_mul_f32 v148, v148, v210
    v_mfma_f32_16x16x32_bf16 v[40:43], a[152:155], a[224:227], 0
    ds_read_b64_tr_b16 a[150:151], v197 offset:12288
    v_mul_f32 v149, v149, v210
    v_mfma_f32_16x16x32_bf16 v[48:51], a[152:155], v[224:227], 0
    v_mul_f32 v150, v150, v210
    v_mul_f32 v151, v151, v210
    v_mfma_f32_16x16x32_bf16 v[56:59], a[152:155], v[240:243], 0
    s_waitcnt lgkmcnt(6)
    v_cvt_pk_bf16_f32 v144, v144, v145
    v_cvt_pk_bf16_f32 v145, v146, v147
    v_mfma_f32_16x16x32_bf16 v[36:39], a[156:159], a[208:211], 0
    ds_read_b64_tr_b16 a[152:153], v198 offset:8192
    v_cvt_pk_bf16_f32 v146, v148, v149
    v_mfma_f32_16x16x32_bf16 v[44:47], a[156:159], a[224:227], 0
    ds_read_b64_tr_b16 a[154:155], v198 offset:12288
    v_cvt_pk_bf16_f32 v147, v150, v151
    v_mfma_f32_16x16x32_bf16 v[52:55], a[156:159], v[224:227], 0
    buffer_load_dwordx4 v206, s[16:19], s52 offen offset:1024 lds
    v_mfma_f32_16x16x32_bf16 v[60:63], a[156:159], v[240:243], 0
    s_waitcnt lgkmcnt(6)
    v_accvgpr_read_b32 v148, a40
    v_accvgpr_read_b32 v149, a41
    v_mfma_f32_16x16x32_bf16 v[64:67], a[160:163], a[208:211], 0
    ds_read_b64_tr_b16 a[156:157], v199 offset:8192
    v_accvgpr_read_b32 v150, a42
    v_mfma_f32_16x16x32_bf16 v[72:75], a[160:163], a[224:227], 0
    ds_read_b64_tr_b16 a[158:159], v199 offset:12288
    v_accvgpr_read_b32 v151, a43
    v_mfma_f32_16x16x32_bf16 v[80:83], a[160:163], v[224:227], 0
    v_accvgpr_read_b32 v152, a44
    v_accvgpr_read_b32 v153, a45
    v_mfma_f32_16x16x32_bf16 v[88:91], a[160:163], v[240:243], 0
    s_waitcnt lgkmcnt(6)
    v_accvgpr_read_b32 v154, a46
    v_accvgpr_read_b32 v155, a47
    v_mfma_f32_16x16x32_bf16 v[68:71], a[164:167], a[208:211], 0
    ds_read_b64_tr_b16 a[160:161], v200 offset:8192
    v_mul_f32 v148, v148, v212
    v_mfma_f32_16x16x32_bf16 v[76:79], a[164:167], a[224:227], 0
    ds_read_b64_tr_b16 a[162:163], v200 offset:12288
    v_mul_f32 v149, v149, v212
    v_mfma_f32_16x16x32_bf16 v[84:87], a[164:167], v[224:227], 0
    v_mul_f32 v150, v150, v212
    v_mul_f32 v151, v151, v212
    v_mfma_f32_16x16x32_bf16 v[92:95], a[164:167], v[240:243], 0
    s_waitcnt lgkmcnt(6)
    buffer_store_dwordx4 v[128:131], v221, s[20:23], s45 offen offset:0 sc1
    v_mfma_f32_16x16x32_bf16 v[96:99], a[168:171], a[208:211], 0
    ds_read_b64_tr_b16 a[164:165], v201 offset:8192
    v_mul_f32 v152, v152, v212
    v_mfma_f32_16x16x32_bf16 v[104:107], a[168:171], a[224:227], 0
    ds_read_b64_tr_b16 a[166:167], v201 offset:12288
    v_mul_f32 v153, v153, v212
    v_mfma_f32_16x16x32_bf16 v[112:115], a[168:171], v[224:227], 0
    v_mul_f32 v154, v154, v212
    v_mul_f32 v155, v155, v212
    v_mfma_f32_16x16x32_bf16 v[120:123], a[168:171], v[240:243], 0
    s_waitcnt lgkmcnt(6)
    v_cvt_pk_bf16_f32 v148, v148, v149
    v_cvt_pk_bf16_f32 v149, v150, v151
    v_mfma_f32_16x16x32_bf16 v[100:103], a[172:175], a[208:211], 0
    ds_read_b64_tr_b16 a[168:169], v202 offset:8192
    v_cvt_pk_bf16_f32 v150, v152, v153
    v_mfma_f32_16x16x32_bf16 v[108:111], a[172:175], a[224:227], 0
    ds_read_b64_tr_b16 a[170:171], v202 offset:12288
    v_cvt_pk_bf16_f32 v151, v154, v155
    v_mfma_f32_16x16x32_bf16 v[116:119], a[172:175], v[224:227], 0
    v_accvgpr_read_b32 v152, a72
    v_accvgpr_read_b32 v153, a73
    v_mfma_f32_16x16x32_bf16 v[124:127], a[172:175], v[240:243], 0
    s_waitcnt lgkmcnt(6)
    v_accvgpr_read_b32 v154, a74
    v_accvgpr_read_b32 v155, a75
    ds_read_b64_tr_b16 a[172:173], v203 offset:8192
    ds_read_b64_tr_b16 a[174:175], v203 offset:12288
    s_waitcnt vmcnt(6)
    s_barrier
    v_mfma_f32_16x16x32_bf16 v[0:3], a[144:147], a[212:215], v[0:3]
    s_xor_b32 s52, s30, 6
    v_accvgpr_read_b32 v156, a76
    v_accvgpr_read_b32 v157, a77
    v_mfma_f32_16x16x32_bf16 v[8:11], a[144:147], a[228:231], v[8:11]
    s_lshl_b32 s52, s52, 15
    v_accvgpr_read_b32 v158, a78
    v_accvgpr_read_b32 v159, a79
    v_mfma_f32_16x16x32_bf16 v[16:19], a[144:147], v[228:231], v[16:19]
    s_add_u32 m0, s53, 49152
    v_mul_f32 v152, v152, v214
    v_mul_f32 v153, v153, v214
    v_mfma_f32_16x16x32_bf16 v[24:27], a[144:147], v[244:247], v[24:27]
    s_waitcnt lgkmcnt(6)
    buffer_load_dwordx4 v205, s[16:19], s52 offen lds
    v_mfma_f32_16x16x32_bf16 v[4:7], a[148:151], a[212:215], v[4:7]
    ds_read_b64_tr_b16 a[144:145], v196 offset:16384
    v_mul_f32 v154, v154, v214
    v_mfma_f32_16x16x32_bf16 v[12:15], a[148:151], a[228:231], v[12:15]
    ds_read_b64_tr_b16 a[146:147], v196 offset:20480
    v_mul_f32 v155, v155, v214
    v_mfma_f32_16x16x32_bf16 v[20:23], a[148:151], v[228:231], v[20:23]
    v_mul_f32 v156, v156, v214
    v_mul_f32 v157, v157, v214
    v_mfma_f32_16x16x32_bf16 v[28:31], a[148:151], v[244:247], v[28:31]
    s_waitcnt lgkmcnt(6)
    v_mul_f32 v158, v158, v214
    v_mul_f32 v159, v159, v214
    v_mfma_f32_16x16x32_bf16 v[32:35], a[152:155], a[212:215], v[32:35]
    ds_read_b64_tr_b16 a[148:149], v197 offset:16384
    v_cvt_pk_bf16_f32 v152, v152, v153
    v_mfma_f32_16x16x32_bf16 v[40:43], a[152:155], a[228:231], v[40:43]
    ds_read_b64_tr_b16 a[150:151], v197 offset:20480
    v_cvt_pk_bf16_f32 v153, v154, v155
    v_mfma_f32_16x16x32_bf16 v[48:51], a[152:155], v[228:231], v[48:51]
    v_cvt_pk_bf16_f32 v154, v156, v157
    v_cvt_pk_bf16_f32 v155, v158, v159
    v_mfma_f32_16x16x32_bf16 v[56:59], a[152:155], v[244:247], v[56:59]
    s_waitcnt lgkmcnt(6)
    v_accvgpr_read_b32 v156, a104
    v_accvgpr_read_b32 v157, a105
    v_mfma_f32_16x16x32_bf16 v[36:39], a[156:159], a[212:215], v[36:39]
    ds_read_b64_tr_b16 a[152:153], v198 offset:16384
    v_accvgpr_read_b32 v158, a106
    v_mfma_f32_16x16x32_bf16 v[44:47], a[156:159], a[228:231], v[44:47]
    ds_read_b64_tr_b16 a[154:155], v198 offset:20480
    v_accvgpr_read_b32 v159, a107
    v_mfma_f32_16x16x32_bf16 v[52:55], a[156:159], v[228:231], v[52:55]
    buffer_load_dwordx4 v206, s[16:19], s52 offen offset:1024 lds
    v_mfma_f32_16x16x32_bf16 v[60:63], a[156:159], v[244:247], v[60:63]
    s_waitcnt lgkmcnt(6)
    v_accvgpr_read_b32 v160, a108
    v_accvgpr_read_b32 v161, a109
    v_mfma_f32_16x16x32_bf16 v[64:67], a[160:163], a[212:215], v[64:67]
    ds_read_b64_tr_b16 a[156:157], v199 offset:16384
    v_accvgpr_read_b32 v162, a110
    v_mfma_f32_16x16x32_bf16 v[72:75], a[160:163], a[228:231], v[72:75]
    ds_read_b64_tr_b16 a[158:159], v199 offset:20480
    v_accvgpr_read_b32 v163, a111
    v_mfma_f32_16x16x32_bf16 v[80:83], a[160:163], v[228:231], v[80:83]
    v_mul_f32 v156, v156, v216
    v_mul_f32 v157, v157, v216
    v_mfma_f32_16x16x32_bf16 v[88:91], a[160:163], v[244:247], v[88:91]
    s_waitcnt lgkmcnt(6)
    v_mul_f32 v158, v158, v216
    v_mul_f32 v159, v159, v216
    v_mfma_f32_16x16x32_bf16 v[68:71], a[164:167], a[212:215], v[68:71]
    ds_read_b64_tr_b16 a[160:161], v200 offset:16384
    v_mul_f32 v160, v160, v216
    v_mfma_f32_16x16x32_bf16 v[76:79], a[164:167], a[228:231], v[76:79]
    ds_read_b64_tr_b16 a[162:163], v200 offset:20480
    v_mul_f32 v161, v161, v216
    v_mfma_f32_16x16x32_bf16 v[84:87], a[164:167], v[228:231], v[84:87]
    v_mul_f32 v162, v162, v216
    v_mul_f32 v163, v163, v216
    v_mfma_f32_16x16x32_bf16 v[92:95], a[164:167], v[244:247], v[92:95]
    s_waitcnt lgkmcnt(6)
    buffer_store_dwordx4 v[132:135], v221, s[20:23], s48 offen offset:0 sc1
    v_mfma_f32_16x16x32_bf16 v[96:99], a[168:171], a[212:215], v[96:99]
    ds_read_b64_tr_b16 a[164:165], v201 offset:16384
    v_cvt_pk_bf16_f32 v156, v156, v157
    v_mfma_f32_16x16x32_bf16 v[104:107], a[168:171], a[228:231], v[104:107]
    ds_read_b64_tr_b16 a[166:167], v201 offset:20480
    v_cvt_pk_bf16_f32 v157, v158, v159
    v_mfma_f32_16x16x32_bf16 v[112:115], a[168:171], v[228:231], v[112:115]
    v_cvt_pk_bf16_f32 v158, v160, v161
    v_cvt_pk_bf16_f32 v159, v162, v163
    v_mfma_f32_16x16x32_bf16 v[120:123], a[168:171], v[244:247], v[120:123]
    s_waitcnt lgkmcnt(6)
    v_accvgpr_read_b32 v160, a16
    v_accvgpr_read_b32 v161, a17
    v_mfma_f32_16x16x32_bf16 v[100:103], a[172:175], a[212:215], v[100:103]
    ds_read_b64_tr_b16 a[168:169], v202 offset:16384
    v_accvgpr_read_b32 v162, a18
    v_mfma_f32_16x16x32_bf16 v[108:111], a[172:175], a[228:231], v[108:111]
    ds_read_b64_tr_b16 a[170:171], v202 offset:20480
    v_accvgpr_read_b32 v163, a19
    v_mfma_f32_16x16x32_bf16 v[116:119], a[172:175], v[228:231], v[116:119]
    v_accvgpr_read_b32 v164, a20
    v_accvgpr_read_b32 v165, a21
    v_mfma_f32_16x16x32_bf16 v[124:127], a[172:175], v[244:247], v[124:127]
    s_waitcnt lgkmcnt(6)
    v_accvgpr_read_b32 v166, a22
    v_accvgpr_read_b32 v167, a23
    ds_read_b64_tr_b16 a[172:173], v203 offset:16384
    ds_read_b64_tr_b16 a[174:175], v203 offset:20480
    v_mfma_f32_16x16x32_bf16 v[0:3], a[144:147], a[216:219], v[0:3]
    v_mul_f32 v160, v160, v210
    v_mul_f32 v161, v161, v210
    v_mfma_f32_16x16x32_bf16 v[8:11], a[144:147], a[232:235], v[8:11]
    v_mul_f32 v162, v162, v210
    v_mul_f32 v163, v163, v210
    v_mfma_f32_16x16x32_bf16 v[16:19], a[144:147], v[232:235], v[16:19]
    v_mul_f32 v164, v164, v210
    v_mul_f32 v165, v165, v210
    v_mfma_f32_16x16x32_bf16 v[24:27], a[144:147], v[248:251], v[24:27]
    s_waitcnt lgkmcnt(6)
    buffer_load_dword v208, v204, s[12:15], s60 offen offset:0 sc1
    v_mfma_f32_16x16x32_bf16 v[4:7], a[148:151], a[216:219], v[4:7]
    ds_read_b64_tr_b16 a[144:145], v196 offset:24576
    v_mul_f32 v166, v166, v210
    v_mfma_f32_16x16x32_bf16 v[12:15], a[148:151], a[232:235], v[12:15]
    ds_read_b64_tr_b16 a[146:147], v196 offset:28672
    v_mul_f32 v167, v167, v210
    v_mfma_f32_16x16x32_bf16 v[20:23], a[148:151], v[232:235], v[20:23]
    s_xor_b32 s52, s30, 7
    v_cvt_pk_bf16_f32 v160, v160, v161
    v_cvt_pk_bf16_f32 v161, v162, v163
    v_mfma_f32_16x16x32_bf16 v[28:31], a[148:151], v[248:251], v[28:31]
    s_waitcnt lgkmcnt(6)
    v_cvt_pk_bf16_f32 v162, v164, v165
    v_cvt_pk_bf16_f32 v163, v166, v167
    v_mfma_f32_16x16x32_bf16 v[32:35], a[152:155], a[216:219], v[32:35]
    s_lshl_b32 s52, s52, 15
    ds_read_b64_tr_b16 a[148:149], v197 offset:24576
    v_accvgpr_read_b32 v164, a48
    v_mfma_f32_16x16x32_bf16 v[40:43], a[152:155], a[232:235], v[40:43]
    s_add_u32 m0, s53, 57344
    ds_read_b64_tr_b16 a[150:151], v197 offset:28672
    v_accvgpr_read_b32 v165, a49
    v_mfma_f32_16x16x32_bf16 v[48:51], a[152:155], v[232:235], v[48:51]
    buffer_load_dwordx4 v205, s[16:19], s52 offen lds
    v_mfma_f32_16x16x32_bf16 v[56:59], a[152:155], v[248:251], v[56:59]
    s_waitcnt lgkmcnt(6)
    v_accvgpr_read_b32 v166, a50
    v_accvgpr_read_b32 v167, a51
    v_mfma_f32_16x16x32_bf16 v[36:39], a[156:159], a[216:219], v[36:39]
    ds_read_b64_tr_b16 a[152:153], v198 offset:24576
    v_accvgpr_read_b32 v168, a52
    v_mfma_f32_16x16x32_bf16 v[44:47], a[156:159], a[232:235], v[44:47]
    ds_read_b64_tr_b16 a[154:155], v198 offset:28672
    v_accvgpr_read_b32 v169, a53
    v_mfma_f32_16x16x32_bf16 v[52:55], a[156:159], v[232:235], v[52:55]
    v_accvgpr_read_b32 v170, a54
    v_accvgpr_read_b32 v171, a55
    v_mfma_f32_16x16x32_bf16 v[60:63], a[156:159], v[248:251], v[60:63]
    s_waitcnt lgkmcnt(6)
    v_mul_f32 v164, v164, v212
    v_mul_f32 v165, v165, v212
    v_mfma_f32_16x16x32_bf16 v[64:67], a[160:163], a[216:219], v[64:67]
    ds_read_b64_tr_b16 a[156:157], v199 offset:24576
    v_mul_f32 v166, v166, v212
    v_mfma_f32_16x16x32_bf16 v[72:75], a[160:163], a[232:235], v[72:75]
    ds_read_b64_tr_b16 a[158:159], v199 offset:28672
    v_mul_f32 v167, v167, v212
    v_mfma_f32_16x16x32_bf16 v[80:83], a[160:163], v[232:235], v[80:83]
    buffer_load_dwordx4 v206, s[16:19], s52 offen offset:1024 lds
    v_mfma_f32_16x16x32_bf16 v[88:91], a[160:163], v[248:251], v[88:91]
    s_waitcnt lgkmcnt(6)
    v_mul_f32 v168, v168, v212
    v_mul_f32 v169, v169, v212
    v_mfma_f32_16x16x32_bf16 v[68:71], a[164:167], a[216:219], v[68:71]
    ds_read_b64_tr_b16 a[160:161], v200 offset:24576
    v_mul_f32 v170, v170, v212
    v_mfma_f32_16x16x32_bf16 v[76:79], a[164:167], a[232:235], v[76:79]
    ds_read_b64_tr_b16 a[162:163], v200 offset:28672
    v_mul_f32 v171, v171, v212
    v_mfma_f32_16x16x32_bf16 v[84:87], a[164:167], v[232:235], v[84:87]
    v_cvt_pk_bf16_f32 v164, v164, v165
    v_cvt_pk_bf16_f32 v165, v166, v167
    v_mfma_f32_16x16x32_bf16 v[92:95], a[164:167], v[248:251], v[92:95]
    s_waitcnt lgkmcnt(6)
    v_cvt_pk_bf16_f32 v166, v168, v169
    v_cvt_pk_bf16_f32 v167, v170, v171
    v_mfma_f32_16x16x32_bf16 v[96:99], a[168:171], a[216:219], v[96:99]
    ds_read_b64_tr_b16 a[164:165], v201 offset:24576
    v_accvgpr_read_b32 v168, a80
    v_mfma_f32_16x16x32_bf16 v[104:107], a[168:171], a[232:235], v[104:107]
    ds_read_b64_tr_b16 a[166:167], v201 offset:28672
    v_accvgpr_read_b32 v169, a81
    v_mfma_f32_16x16x32_bf16 v[112:115], a[168:171], v[232:235], v[112:115]
    buffer_store_dwordx4 v[136:139], v221, s[20:23], s49 offen offset:0 sc1
    v_mfma_f32_16x16x32_bf16 v[120:123], a[168:171], v[248:251], v[120:123]
    s_waitcnt lgkmcnt(6)
    v_accvgpr_read_b32 v170, a82
    v_accvgpr_read_b32 v171, a83
    v_mfma_f32_16x16x32_bf16 v[100:103], a[172:175], a[216:219], v[100:103]
    ds_read_b64_tr_b16 a[168:169], v202 offset:24576
    v_accvgpr_read_b32 v172, a84
    v_mfma_f32_16x16x32_bf16 v[108:111], a[172:175], a[232:235], v[108:111]
    ds_read_b64_tr_b16 a[170:171], v202 offset:28672
    v_accvgpr_read_b32 v173, a85
    v_mfma_f32_16x16x32_bf16 v[116:119], a[172:175], v[232:235], v[116:119]
    v_accvgpr_read_b32 v174, a86
    v_accvgpr_read_b32 v175, a87
    v_mfma_f32_16x16x32_bf16 v[124:127], a[172:175], v[248:251], v[124:127]
    s_waitcnt lgkmcnt(6)
    v_mul_f32 v168, v168, v214
    v_mul_f32 v169, v169, v214
    ds_read_b64_tr_b16 a[172:173], v203 offset:24576
    ds_read_b64_tr_b16 a[174:175], v203 offset:28672
    s_waitcnt vmcnt(8)
    s_barrier
    v_mfma_f32_16x16x32_bf16 v[0:3], a[144:147], a[220:223], v[0:3]
    s_xor_b32 s52, s30, 8
    v_mul_f32 v170, v170, v214
    v_mul_f32 v171, v171, v214
    v_mfma_f32_16x16x32_bf16 v[8:11], a[144:147], a[236:239], v[8:11]
    s_lshl_b32 s52, s52, 15
    v_mul_f32 v172, v172, v214
    v_mul_f32 v173, v173, v214
    v_mfma_f32_16x16x32_bf16 v[16:19], a[144:147], v[236:239], v[16:19]
    s_add_u32 m0, s53, 0
    v_mul_f32 v174, v174, v214
    v_mul_f32 v175, v175, v214
    v_mfma_f32_16x16x32_bf16 v[24:27], a[144:147], v[252:255], v[24:27]
    s_waitcnt lgkmcnt(6)
    buffer_load_dwordx4 v205, s[16:19], s52 offen lds
    v_mfma_f32_16x16x32_bf16 v[4:7], a[148:151], a[220:223], v[4:7]
    ds_read_b64_tr_b16 a[144:145], v196 offset:32768
    v_cvt_pk_bf16_f32 v168, v168, v169
    v_mfma_f32_16x16x32_bf16 v[12:15], a[148:151], a[236:239], v[12:15]
    ds_read_b64_tr_b16 a[146:147], v196 offset:36864
    v_cvt_pk_bf16_f32 v169, v170, v171
    v_mfma_f32_16x16x32_bf16 v[20:23], a[148:151], v[236:239], v[20:23]
    v_cvt_pk_bf16_f32 v170, v172, v173
    v_cvt_pk_bf16_f32 v171, v174, v175
    v_mfma_f32_16x16x32_bf16 v[28:31], a[148:151], v[252:255], v[28:31]
    s_waitcnt lgkmcnt(6)
    v_accvgpr_read_b32 v172, a112
    v_accvgpr_read_b32 v173, a113
    v_mfma_f32_16x16x32_bf16 v[32:35], a[152:155], a[220:223], v[32:35]
    ds_read_b64_tr_b16 a[148:149], v197 offset:32768
    v_accvgpr_read_b32 v174, a114
    v_mfma_f32_16x16x32_bf16 v[40:43], a[152:155], a[236:239], v[40:43]
    ds_read_b64_tr_b16 a[150:151], v197 offset:36864
    v_accvgpr_read_b32 v175, a115
    v_mfma_f32_16x16x32_bf16 v[48:51], a[152:155], v[236:239], v[48:51]
    v_accvgpr_read_b32 v176, a116
    v_accvgpr_read_b32 v177, a117
    v_mfma_f32_16x16x32_bf16 v[56:59], a[152:155], v[252:255], v[56:59]
    s_waitcnt lgkmcnt(6)
    v_accvgpr_read_b32 v178, a118
    v_accvgpr_read_b32 v179, a119
    v_mfma_f32_16x16x32_bf16 v[36:39], a[156:159], a[220:223], v[36:39]
    ds_read_b64_tr_b16 a[152:153], v198 offset:32768
    v_mul_f32 v172, v172, v216
    v_mfma_f32_16x16x32_bf16 v[44:47], a[156:159], a[236:239], v[44:47]
    ds_read_b64_tr_b16 a[154:155], v198 offset:36864
    v_mul_f32 v173, v173, v216
    v_mfma_f32_16x16x32_bf16 v[52:55], a[156:159], v[236:239], v[52:55]
    buffer_load_dwordx4 v206, s[16:19], s52 offen offset:1024 lds
    v_mfma_f32_16x16x32_bf16 v[60:63], a[156:159], v[252:255], v[60:63]
    s_waitcnt lgkmcnt(6)
    v_mul_f32 v174, v174, v216
    v_mul_f32 v175, v175, v216
    v_mfma_f32_16x16x32_bf16 v[64:67], a[160:163], a[220:223], v[64:67]
    ds_read_b64_tr_b16 a[156:157], v199 offset:32768
    v_mul_f32 v176, v176, v216
    v_mfma_f32_16x16x32_bf16 v[72:75], a[160:163], a[236:239], v[72:75]
    ds_read_b64_tr_b16 a[158:159], v199 offset:36864
    v_mul_f32 v177, v177, v216
    v_mfma_f32_16x16x32_bf16 v[80:83], a[160:163], v[236:239], v[80:83]
    v_mul_f32 v178, v178, v216
    v_mul_f32 v179, v179, v216
    v_mfma_f32_16x16x32_bf16 v[88:91], a[160:163], v[252:255], v[88:91]
    s_waitcnt lgkmcnt(6)
    v_cvt_pk_bf16_f32 v172, v172, v173
    v_cvt_pk_bf16_f32 v173, v174, v175
    v_mfma_f32_16x16x32_bf16 v[68:71], a[164:167], a[220:223], v[68:71]
    ds_read_b64_tr_b16 a[160:161], v200 offset:32768
    v_cvt_pk_bf16_f32 v174, v176, v177
    v_mfma_f32_16x16x32_bf16 v[76:79], a[164:167], a[236:239], v[76:79]
    ds_read_b64_tr_b16 a[162:163], v200 offset:36864
    v_cvt_pk_bf16_f32 v175, v178, v179
    v_mfma_f32_16x16x32_bf16 v[84:87], a[164:167], v[236:239], v[84:87]
    v_accvgpr_read_b32 v176, a24
    v_accvgpr_read_b32 v177, a25
    v_mfma_f32_16x16x32_bf16 v[92:95], a[164:167], v[252:255], v[92:95]
    s_waitcnt lgkmcnt(6)
    buffer_store_dwordx4 v[140:143], v221, s[20:23], s101 offen offset:0 sc1
    v_mfma_f32_16x16x32_bf16 v[96:99], a[168:171], a[220:223], v[96:99]
    ds_read_b64_tr_b16 a[164:165], v201 offset:32768
    v_accvgpr_read_b32 v178, a26
    v_mfma_f32_16x16x32_bf16 v[104:107], a[168:171], a[236:239], v[104:107]
    ds_read_b64_tr_b16 a[166:167], v201 offset:36864
    v_accvgpr_read_b32 v179, a27
    v_mfma_f32_16x16x32_bf16 v[112:115], a[168:171], v[236:239], v[112:115]
    v_accvgpr_read_b32 v180, a28
    v_accvgpr_read_b32 v181, a29
    v_mfma_f32_16x16x32_bf16 v[120:123], a[168:171], v[252:255], v[120:123]
    s_waitcnt lgkmcnt(6)
    v_accvgpr_read_b32 v182, a30
    v_accvgpr_read_b32 v183, a31
    v_mfma_f32_16x16x32_bf16 v[100:103], a[172:175], a[220:223], v[100:103]
    ds_read_b64_tr_b16 a[168:169], v202 offset:32768
    v_mul_f32 v176, v176, v210
    v_mfma_f32_16x16x32_bf16 v[108:111], a[172:175], a[236:239], v[108:111]
    ds_read_b64_tr_b16 a[170:171], v202 offset:36864
    v_mul_f32 v177, v177, v210
    v_mfma_f32_16x16x32_bf16 v[116:119], a[172:175], v[236:239], v[116:119]
    v_mul_f32 v178, v178, v210
    v_mul_f32 v179, v179, v210
    v_mfma_f32_16x16x32_bf16 v[124:127], a[172:175], v[252:255], v[124:127]
    s_waitcnt lgkmcnt(6)
    v_mul_f32 v180, v180, v210
    v_mul_f32 v181, v181, v210
    ds_read_b64_tr_b16 a[172:173], v203 offset:32768
    ds_read_b64_tr_b16 a[174:175], v203 offset:36864
    s_waitcnt vmcnt(6)
    v_cmp_ne_u32 vcc, s54, v208
    s_cmp_eq_u32 vcc_lo, 0
    s_cbranch_scc0 K1_SPIN1
K1_CHK1_OK:
    v_mfma_f32_16x16x32_bf16 v[0:3], a[144:147], v[128:131], v[0:3]
    s_xor_b32 s52, s30, 16
    v_mul_f32 v182, v182, v210
    v_mul_f32 v183, v183, v210
    v_mfma_f32_16x16x32_bf16 v[8:11], a[144:147], v[132:135], v[8:11]
    s_lshl_b32 s52, s52, 15
    v_cvt_pk_bf16_f32 v176, v176, v177
    v_cvt_pk_bf16_f32 v177, v178, v179
    v_mfma_f32_16x16x32_bf16 v[16:19], a[144:147], v[136:139], v[16:19]
    s_add_u32 m0, s53, 8192
    v_cvt_pk_bf16_f32 v178, v180, v181
    v_cvt_pk_bf16_f32 v179, v182, v183
    v_mfma_f32_16x16x32_bf16 v[24:27], a[144:147], v[140:143], v[24:27]
    s_waitcnt lgkmcnt(6)
    buffer_load_dwordx4 v205, s[16:19], s52 offen lds
    v_mfma_f32_16x16x32_bf16 v[4:7], a[148:151], v[128:131], v[4:7]
    ds_read_b64_tr_b16 a[144:145], v196 offset:40960
    v_accvgpr_read_b32 v180, a56
    v_mfma_f32_16x16x32_bf16 v[12:15], a[148:151], v[132:135], v[12:15]
    ds_read_b64_tr_b16 a[146:147], v196 offset:45056
    v_accvgpr_read_b32 v181, a57
    v_mfma_f32_16x16x32_bf16 v[20:23], a[148:151], v[136:139], v[20:23]
    v_accvgpr_read_b32 v182, a58
    v_accvgpr_read_b32 v183, a59
    v_mfma_f32_16x16x32_bf16 v[28:31], a[148:151], v[140:143], v[28:31]
    s_waitcnt lgkmcnt(6)
    buffer_load_dwordx4 v206, s[16:19], s52 offen offset:1024 lds
    v_mfma_f32_16x16x32_bf16 v[32:35], a[152:155], v[128:131], v[32:35]
    ds_read_b64_tr_b16 a[148:149], v197 offset:40960
    v_accvgpr_read_b32 v184, a60
    v_mfma_f32_16x16x32_bf16 v[40:43], a[152:155], v[132:135], v[40:43]
    s_xor_b32 s46, s30, 8
    ds_read_b64_tr_b16 a[150:151], v197 offset:45056
    v_accvgpr_read_b32 v185, a61
    v_mfma_f32_16x16x32_bf16 v[48:51], a[152:155], v[136:139], v[48:51]
    s_lshl_b32 s46, s46, 10
    v_accvgpr_read_b32 v186, a62
    v_accvgpr_read_b32 v187, a63
    v_mfma_f32_16x16x32_bf16 v[56:59], a[152:155], v[140:143], v[56:59]
    s_waitcnt lgkmcnt(6)
    buffer_load_dwordx4 a[0:3], v221, s[4:7], s46 offen sc1
    v_mfma_f32_16x16x32_bf16 v[36:39], a[156:159], v[128:131], v[36:39]
    ds_read_b64_tr_b16 a[152:153], v198 offset:40960
    v_mul_f32 v180, v180, v212
    v_mfma_f32_16x16x32_bf16 v[44:47], a[156:159], v[132:135], v[44:47]
    ds_read_b64_tr_b16 a[154:155], v198 offset:45056
    v_mul_f32 v181, v181, v212
    v_mfma_f32_16x16x32_bf16 v[52:55], a[156:159], v[136:139], v[52:55]
    s_add_u32 s46, s46, 131072
    v_mul_f32 v182, v182, v212
    v_mul_f32 v183, v183, v212
    v_mfma_f32_16x16x32_bf16 v[60:63], a[156:159], v[140:143], v[60:63]
    s_waitcnt lgkmcnt(6)
    buffer_load_dwordx4 a[32:35], v221, s[4:7], s46 offen sc1
    v_mfma_f32_16x16x32_bf16 v[64:67], a[160:163], v[128:131], v[64:67]
    ds_read_b64_tr_b16 a[156:157], v199 offset:40960
    v_mul_f32 v184, v184, v212
    v_mfma_f32_16x16x32_bf16 v[72:75], a[160:163], v[132:135], v[72:75]
    ds_read_b64_tr_b16 a[158:159], v199 offset:45056
    v_mul_f32 v185, v185, v212
    v_mfma_f32_16x16x32_bf16 v[80:83], a[160:163], v[136:139], v[80:83]
    s_add_u32 s46, s46, 131072
    v_mul_f32 v186, v186, v212
    v_mul_f32 v187, v187, v212
    v_mfma_f32_16x16x32_bf16 v[88:91], a[160:163], v[140:143], v[88:91]
    s_waitcnt lgkmcnt(6)
    buffer_load_dwordx4 a[64:67], v221, s[4:7], s46 offen sc1
    v_mfma_f32_16x16x32_bf16 v[68:71], a[164:167], v[128:131], v[68:71]
    ds_read_b64_tr_b16 a[160:161], v200 offset:40960
    v_cvt_pk_bf16_f32 v180, v180, v181
    v_mfma_f32_16x16x32_bf16 v[76:79], a[164:167], v[132:135], v[76:79]
    ds_read_b64_tr_b16 a[162:163], v200 offset:45056
    v_cvt_pk_bf16_f32 v181, v182, v183
    v_mfma_f32_16x16x32_bf16 v[84:87], a[164:167], v[136:139], v[84:87]
    s_add_u32 s46, s46, 131072
    v_cvt_pk_bf16_f32 v182, v184, v185
    v_cvt_pk_bf16_f32 v183, v186, v187
    v_mfma_f32_16x16x32_bf16 v[92:95], a[164:167], v[140:143], v[92:95]
    s_waitcnt lgkmcnt(6)
    buffer_load_dwordx4 a[96:99], v221, s[4:7], s46 offen sc1
    v_mfma_f32_16x16x32_bf16 v[96:99], a[168:171], v[128:131], v[96:99]
    ds_read_b64_tr_b16 a[164:165], v201 offset:40960
    v_accvgpr_read_b32 v184, a88
    v_mfma_f32_16x16x32_bf16 v[104:107], a[168:171], v[132:135], v[104:107]
    ds_read_b64_tr_b16 a[166:167], v201 offset:45056
    v_accvgpr_read_b32 v185, a89
    v_mfma_f32_16x16x32_bf16 v[112:115], a[168:171], v[136:139], v[112:115]
    v_accvgpr_read_b32 v186, a90
    v_accvgpr_read_b32 v187, a91
    v_mfma_f32_16x16x32_bf16 v[120:123], a[168:171], v[140:143], v[120:123]
    s_waitcnt lgkmcnt(6)
    buffer_store_dwordx4 v[144:147], v221, s[20:23], s45 offen offset:1024 sc1
    v_mfma_f32_16x16x32_bf16 v[100:103], a[172:175], v[128:131], v[100:103]
    ds_read_b64_tr_b16 a[168:169], v202 offset:40960
    v_accvgpr_read_b32 v188, a92
    v_mfma_f32_16x16x32_bf16 v[108:111], a[172:175], v[132:135], v[108:111]
    ds_read_b64_tr_b16 a[170:171], v202 offset:45056
    v_accvgpr_read_b32 v189, a93
    v_mfma_f32_16x16x32_bf16 v[116:119], a[172:175], v[136:139], v[116:119]
    v_accvgpr_read_b32 v190, a94
    v_accvgpr_read_b32 v191, a95
    v_mfma_f32_16x16x32_bf16 v[124:127], a[172:175], v[140:143], v[124:127]
    s_waitcnt lgkmcnt(6)
    v_mul_f32 v184, v184, v214
    v_mul_f32 v185, v185, v214
    ds_read_b64_tr_b16 a[172:173], v203 offset:40960
    ds_read_b64_tr_b16 a[174:175], v203 offset:45056
    s_waitcnt vmcnt(11)
    s_barrier
    v_mfma_f32_16x16x32_bf16 v[0:3], a[144:147], v[144:147], v[0:3]
    s_xor_b32 s52, s30, 24
    v_mul_f32 v186, v186, v214
    v_mul_f32 v187, v187, v214
    v_mfma_f32_16x16x32_bf16 v[8:11], a[144:147], v[148:151], v[8:11]
    s_lshl_b32 s52, s52, 15
    v_mul_f32 v188, v188, v214
    v_mul_f32 v189, v189, v214
    v_mfma_f32_16x16x32_bf16 v[16:19], a[144:147], v[152:155], v[16:19]
    s_add_u32 m0, s53, 16384
    v_mul_f32 v190, v190, v214
    v_mul_f32 v191, v191, v214
    v_mfma_f32_16x16x32_bf16 v[24:27], a[144:147], v[156:159], v[24:27]
    s_waitcnt lgkmcnt(6)
    buffer_load_dwordx4 v205, s[16:19], s52 offen lds
    v_mfma_f32_16x16x32_bf16 v[4:7], a[148:151], v[144:147], v[4:7]
    ds_read_b64_tr_b16 a[144:145], v196 offset:49152
    v_cvt_pk_bf16_f32 v184, v184, v185
    v_mfma_f32_16x16x32_bf16 v[12:15], a[148:151], v[148:151], v[12:15]
    ds_read_b64_tr_b16 a[146:147], v196 offset:53248
    v_cvt_pk_bf16_f32 v185, v186, v187
    v_mfma_f32_16x16x32_bf16 v[20:23], a[148:151], v[152:155], v[20:23]
    v_cvt_pk_bf16_f32 v186, v188, v189
    v_cvt_pk_bf16_f32 v187, v190, v191
    v_mfma_f32_16x16x32_bf16 v[28:31], a[148:151], v[156:159], v[28:31]
    s_waitcnt lgkmcnt(6)
    buffer_load_dwordx4 v206, s[16:19], s52 offen offset:1024 lds
    v_mfma_f32_16x16x32_bf16 v[32:35], a[152:155], v[144:147], v[32:35]
    ds_read_b64_tr_b16 a[148:149], v197 offset:49152
    v_accvgpr_read_b32 v188, a120
    v_mfma_f32_16x16x32_bf16 v[40:43], a[152:155], v[148:151], v[40:43]
    s_xor_b32 s46, s30, 16
    ds_read_b64_tr_b16 a[150:151], v197 offset:53248
    v_accvgpr_read_b32 v189, a121
    v_mfma_f32_16x16x32_bf16 v[48:51], a[152:155], v[152:155], v[48:51]
    s_lshl_b32 s46, s46, 10
    v_accvgpr_read_b32 v190, a122
    v_accvgpr_read_b32 v191, a123
    v_mfma_f32_16x16x32_bf16 v[56:59], a[152:155], v[156:159], v[56:59]
    s_waitcnt lgkmcnt(6)
    buffer_load_dwordx4 a[4:7], v221, s[4:7], s46 offen sc1
    v_mfma_f32_16x16x32_bf16 v[36:39], a[156:159], v[144:147], v[36:39]
    ds_read_b64_tr_b16 a[152:153], v198 offset:49152
    v_accvgpr_read_b32 v192, a124
    v_mfma_f32_16x16x32_bf16 v[44:47], a[156:159], v[148:151], v[44:47]
    ds_read_b64_tr_b16 a[154:155], v198 offset:53248
    v_accvgpr_read_b32 v193, a125
    v_mfma_f32_16x16x32_bf16 v[52:55], a[156:159], v[152:155], v[52:55]
    s_add_u32 s46, s46, 131072
    v_accvgpr_read_b32 v194, a126
    v_accvgpr_read_b32 v195, a127
    v_mfma_f32_16x16x32_bf16 v[60:63], a[156:159], v[156:159], v[60:63]
    s_waitcnt lgkmcnt(6)
    buffer_load_dwordx4 a[36:39], v221, s[4:7], s46 offen sc1
    v_mfma_f32_16x16x32_bf16 v[64:67], a[160:163], v[144:147], v[64:67]
    ds_read_b64_tr_b16 a[156:157], v199 offset:49152
    v_mul_f32 v188, v188, v216
    v_mfma_f32_16x16x32_bf16 v[72:75], a[160:163], v[148:151], v[72:75]
    ds_read_b64_tr_b16 a[158:159], v199 offset:53248
    v_mul_f32 v189, v189, v216
    v_mfma_f32_16x16x32_bf16 v[80:83], a[160:163], v[152:155], v[80:83]
    s_add_u32 s46, s46, 131072
    v_mul_f32 v190, v190, v216
    v_mul_f32 v191, v191, v216
    v_mfma_f32_16x16x32_bf16 v[88:91], a[160:163], v[156:159], v[88:91]
    s_waitcnt lgkmcnt(6)
    buffer_load_dwordx4 a[68:71], v221, s[4:7], s46 offen sc1
    v_mfma_f32_16x16x32_bf16 v[68:71], a[164:167], v[144:147], v[68:71]
    ds_read_b64_tr_b16 a[160:161], v200 offset:49152
    v_mul_f32 v192, v192, v216
    v_mfma_f32_16x16x32_bf16 v[76:79], a[164:167], v[148:151], v[76:79]
    ds_read_b64_tr_b16 a[162:163], v200 offset:53248
    v_mul_f32 v193, v193, v216
    v_mfma_f32_16x16x32_bf16 v[84:87], a[164:167], v[152:155], v[84:87]
    s_add_u32 s46, s46, 131072
    v_mul_f32 v194, v194, v216
    v_mul_f32 v195, v195, v216
    v_mfma_f32_16x16x32_bf16 v[92:95], a[164:167], v[156:159], v[92:95]
    s_waitcnt lgkmcnt(6)
    buffer_load_dwordx4 a[100:103], v221, s[4:7], s46 offen sc1
    v_mfma_f32_16x16x32_bf16 v[96:99], a[168:171], v[144:147], v[96:99]
    ds_read_b64_tr_b16 a[164:165], v201 offset:49152
    v_cvt_pk_bf16_f32 v188, v188, v189
    v_mfma_f32_16x16x32_bf16 v[104:107], a[168:171], v[148:151], v[104:107]
    ds_read_b64_tr_b16 a[166:167], v201 offset:53248
    v_cvt_pk_bf16_f32 v189, v190, v191
    v_mfma_f32_16x16x32_bf16 v[112:115], a[168:171], v[152:155], v[112:115]
    v_cvt_pk_bf16_f32 v190, v192, v193
    v_cvt_pk_bf16_f32 v191, v194, v195
    v_mfma_f32_16x16x32_bf16 v[120:123], a[168:171], v[156:159], v[120:123]
    s_waitcnt lgkmcnt(6)
    buffer_store_dwordx4 v[148:151], v221, s[20:23], s48 offen offset:1024 sc1
    v_mfma_f32_16x16x32_bf16 v[100:103], a[172:175], v[144:147], v[100:103]
    ds_read_b64_tr_b16 a[168:169], v202 offset:49152
    v_mfma_f32_16x16x32_bf16 v[108:111], a[172:175], v[148:151], v[108:111]
    ds_read_b64_tr_b16 a[170:171], v202 offset:53248
    v_mfma_f32_16x16x32_bf16 v[116:119], a[172:175], v[152:155], v[116:119]
    v_mfma_f32_16x16x32_bf16 v[124:127], a[172:175], v[156:159], v[124:127]
    s_waitcnt lgkmcnt(6)
    ds_read_b64_tr_b16 a[172:173], v203 offset:49152
    ds_read_b64_tr_b16 a[174:175], v203 offset:53248
    v_mfma_f32_16x16x32_bf16 v[0:3], a[144:147], v[160:163], v[0:3]
    s_xor_b32 s52, s30, 9
    v_mfma_f32_16x16x32_bf16 v[8:11], a[144:147], v[164:167], v[8:11]
    s_lshl_b32 s52, s52, 15
    v_mfma_f32_16x16x32_bf16 v[16:19], a[144:147], v[168:171], v[16:19]
    s_add_u32 m0, s53, 24576
    v_mfma_f32_16x16x32_bf16 v[24:27], a[144:147], v[172:175], v[24:27]
    s_waitcnt lgkmcnt(6)
    buffer_load_dwordx4 v205, s[16:19], s52 offen lds
    v_mfma_f32_16x16x32_bf16 v[4:7], a[148:151], v[160:163], v[4:7]
    ds_read_b64_tr_b16 a[144:145], v196 offset:57344
    v_mfma_f32_16x16x32_bf16 v[12:15], a[148:151], v[164:167], v[12:15]
    ds_read_b64_tr_b16 a[146:147], v196 offset:61440
    v_mfma_f32_16x16x32_bf16 v[20:23], a[148:151], v[168:171], v[20:23]
    v_mfma_f32_16x16x32_bf16 v[28:31], a[148:151], v[172:175], v[28:31]
    s_waitcnt lgkmcnt(6)
    buffer_load_dwordx4 v206, s[16:19], s52 offen offset:1024 lds
    v_mfma_f32_16x16x32_bf16 v[32:35], a[152:155], v[160:163], v[32:35]
    ds_read_b64_tr_b16 a[148:149], v197 offset:57344
    v_mfma_f32_16x16x32_bf16 v[40:43], a[152:155], v[164:167], v[40:43]
    s_xor_b32 s46, s30, 24
    ds_read_b64_tr_b16 a[150:151], v197 offset:61440
    v_mfma_f32_16x16x32_bf16 v[48:51], a[152:155], v[168:171], v[48:51]
    s_lshl_b32 s46, s46, 10
    v_mfma_f32_16x16x32_bf16 v[56:59], a[152:155], v[172:175], v[56:59]
    s_waitcnt lgkmcnt(6)
    buffer_load_dwordx4 a[8:11], v221, s[4:7], s46 offen sc1
    v_mfma_f32_16x16x32_bf16 v[36:39], a[156:159], v[160:163], v[36:39]
    ds_read_b64_tr_b16 a[152:153], v198 offset:57344
    v_mfma_f32_16x16x32_bf16 v[44:47], a[156:159], v[164:167], v[44:47]
    ds_read_b64_tr_b16 a[154:155], v198 offset:61440
    v_mfma_f32_16x16x32_bf16 v[52:55], a[156:159], v[168:171], v[52:55]
    s_add_u32 s46, s46, 131072
    v_mfma_f32_16x16x32_bf16 v[60:63], a[156:159], v[172:175], v[60:63]
    s_waitcnt lgkmcnt(6)
    buffer_load_dwordx4 a[40:43], v221, s[4:7], s46 offen sc1
    v_mfma_f32_16x16x32_bf16 v[64:67], a[160:163], v[160:163], v[64:67]
    ds_read_b64_tr_b16 a[156:157], v199 offset:57344
    v_mfma_f32_16x16x32_bf16 v[72:75], a[160:163], v[164:167], v[72:75]
    ds_read_b64_tr_b16 a[158:159], v199 offset:61440
    v_mfma_f32_16x16x32_bf16 v[80:83], a[160:163], v[168:171], v[80:83]
    s_add_u32 s46, s46, 131072
    v_mfma_f32_16x16x32_bf16 v[88:91], a[160:163], v[172:175], v[88:91]
    s_waitcnt lgkmcnt(6)
    buffer_load_dwordx4 a[72:75], v221, s[4:7], s46 offen sc1
    v_mfma_f32_16x16x32_bf16 v[68:71], a[164:167], v[160:163], v[68:71]
    ds_read_b64_tr_b16 a[160:161], v200 offset:57344
    v_mfma_f32_16x16x32_bf16 v[76:79], a[164:167], v[164:167], v[76:79]
    ds_read_b64_tr_b16 a[162:163], v200 offset:61440
    v_mfma_f32_16x16x32_bf16 v[84:87], a[164:167], v[168:171], v[84:87]
    s_add_u32 s46, s46, 131072
    v_mfma_f32_16x16x32_bf16 v[92:95], a[164:167], v[172:175], v[92:95]
    s_waitcnt lgkmcnt(6)
    buffer_load_dwordx4 a[104:107], v221, s[4:7], s46 offen sc1
    v_mfma_f32_16x16x32_bf16 v[96:99], a[168:171], v[160:163], v[96:99]
    ds_read_b64_tr_b16 a[164:165], v201 offset:57344
    v_mfma_f32_16x16x32_bf16 v[104:107], a[168:171], v[164:167], v[104:107]
    ds_read_b64_tr_b16 a[166:167], v201 offset:61440
    v_mfma_f32_16x16x32_bf16 v[112:115], a[168:171], v[168:171], v[112:115]
    v_mfma_f32_16x16x32_bf16 v[120:123], a[168:171], v[172:175], v[120:123]
    s_waitcnt lgkmcnt(6)
    buffer_store_dwordx4 v[152:155], v221, s[20:23], s49 offen offset:1024 sc1
    v_mfma_f32_16x16x32_bf16 v[100:103], a[172:175], v[160:163], v[100:103]
    ds_read_b64_tr_b16 a[168:169], v202 offset:57344
    v_mfma_f32_16x16x32_bf16 v[108:111], a[172:175], v[164:167], v[108:111]
    ds_read_b64_tr_b16 a[170:171], v202 offset:61440
    v_mfma_f32_16x16x32_bf16 v[116:119], a[172:175], v[168:171], v[116:119]
    v_mfma_f32_16x16x32_bf16 v[124:127], a[172:175], v[172:175], v[124:127]
    s_waitcnt lgkmcnt(6)
    ds_read_b64_tr_b16 a[172:173], v203 offset:57344
    ds_read_b64_tr_b16 a[174:175], v203 offset:61440
    s_waitcnt vmcnt(19)
    s_barrier
    v_mfma_f32_16x16x32_bf16 v[0:3], a[144:147], v[176:179], v[0:3]
    s_xor_b32 s52, s30, 17
    v_mfma_f32_16x16x32_bf16 v[8:11], a[144:147], v[180:183], v[8:11]
    s_lshl_b32 s52, s52, 15
    v_mfma_f32_16x16x32_bf16 v[16:19], a[144:147], v[184:187], v[16:19]
    s_add_u32 m0, s53, 32768
    v_mfma_f32_16x16x32_bf16 v[24:27], a[144:147], v[188:191], v[24:27]
    s_waitcnt lgkmcnt(6)
    buffer_load_dwordx4 v205, s[16:19], s52 offen lds
    v_mfma_f32_16x16x32_bf16 v[4:7], a[148:151], v[176:179], v[4:7]
    ds_read_b64_tr_b16 a[144:145], v196 offset:0
    v_mfma_f32_16x16x32_bf16 v[12:15], a[148:151], v[180:183], v[12:15]
    ds_read_b64_tr_b16 a[146:147], v196 offset:4096
    v_mfma_f32_16x16x32_bf16 v[20:23], a[148:151], v[184:187], v[20:23]
    v_mfma_f32_16x16x32_bf16 v[28:31], a[148:151], v[188:191], v[28:31]
    s_waitcnt lgkmcnt(6)
    buffer_load_dwordx4 v206, s[16:19], s52 offen offset:1024 lds
    v_mfma_f32_16x16x32_bf16 v[32:35], a[152:155], v[176:179], v[32:35]
    ds_read_b64_tr_b16 a[148:149], v197 offset:0
    v_mfma_f32_16x16x32_bf16 v[40:43], a[152:155], v[180:183], v[40:43]
    s_xor_b32 s46, s30, 9
    ds_read_b64_tr_b16 a[150:151], v197 offset:4096
    v_mfma_f32_16x16x32_bf16 v[48:51], a[152:155], v[184:187], v[48:51]
    s_lshl_b32 s46, s46, 10
    v_mfma_f32_16x16x32_bf16 v[56:59], a[152:155], v[188:191], v[56:59]
    s_waitcnt lgkmcnt(6)
    buffer_load_dwordx4 a[12:15], v221, s[4:7], s46 offen sc1
    v_mfma_f32_16x16x32_bf16 v[36:39], a[156:159], v[176:179], v[36:39]
    ds_read_b64_tr_b16 a[152:153], v198 offset:0
    v_mfma_f32_16x16x32_bf16 v[44:47], a[156:159], v[180:183], v[44:47]
    ds_read_b64_tr_b16 a[154:155], v198 offset:4096
    v_mfma_f32_16x16x32_bf16 v[52:55], a[156:159], v[184:187], v[52:55]
    s_add_u32 s46, s46, 131072
    v_mfma_f32_16x16x32_bf16 v[60:63], a[156:159], v[188:191], v[60:63]
    s_waitcnt lgkmcnt(6)
    buffer_load_dwordx4 a[44:47], v221, s[4:7], s46 offen sc1
    v_mfma_f32_16x16x32_bf16 v[64:67], a[160:163], v[176:179], v[64:67]
    ds_read_b64_tr_b16 a[156:157], v199 offset:0
    v_mfma_f32_16x16x32_bf16 v[72:75], a[160:163], v[180:183], v[72:75]
    ds_read_b64_tr_b16 a[158:159], v199 offset:4096
    v_mfma_f32_16x16x32_bf16 v[80:83], a[160:163], v[184:187], v[80:83]
    s_add_u32 s46, s46, 131072
    v_mfma_f32_16x16x32_bf16 v[88:91], a[160:163], v[188:191], v[88:91]
    s_waitcnt lgkmcnt(6)
    buffer_load_dwordx4 a[76:79], v221, s[4:7], s46 offen sc1
    v_mfma_f32_16x16x32_bf16 v[68:71], a[164:167], v[176:179], v[68:71]
    ds_read_b64_tr_b16 a[160:161], v200 offset:0
    v_mfma_f32_16x16x32_bf16 v[76:79], a[164:167], v[180:183], v[76:79]
    ds_read_b64_tr_b16 a[162:163], v200 offset:4096
    v_mfma_f32_16x16x32_bf16 v[84:87], a[164:167], v[184:187], v[84:87]
    s_add_u32 s46, s46, 131072
    v_mfma_f32_16x16x32_bf16 v[92:95], a[164:167], v[188:191], v[92:95]
    s_waitcnt lgkmcnt(6)
    buffer_load_dwordx4 a[108:111], v221, s[4:7], s46 offen sc1
    v_mfma_f32_16x16x32_bf16 v[96:99], a[168:171], v[176:179], v[96:99]
    ds_read_b64_tr_b16 a[164:165], v201 offset:0
    v_mfma_f32_16x16x32_bf16 v[104:107], a[168:171], v[180:183], v[104:107]
    ds_read_b64_tr_b16 a[166:167], v201 offset:4096
    v_mfma_f32_16x16x32_bf16 v[112:115], a[168:171], v[184:187], v[112:115]
    v_mfma_f32_16x16x32_bf16 v[120:123], a[168:171], v[188:191], v[120:123]
    s_waitcnt lgkmcnt(6)
    buffer_store_dwordx4 v[156:159], v221, s[20:23], s101 offen offset:1024 sc1
    v_mfma_f32_16x16x32_bf16 v[100:103], a[172:175], v[176:179], v[100:103]
    ds_read_b64_tr_b16 a[168:169], v202 offset:0
    v_mfma_f32_16x16x32_bf16 v[108:111], a[172:175], v[180:183], v[108:111]
    ds_read_b64_tr_b16 a[170:171], v202 offset:4096
    v_mfma_f32_16x16x32_bf16 v[116:119], a[172:175], v[184:187], v[116:119]
    v_mfma_f32_16x16x32_bf16 v[124:127], a[172:175], v[188:191], v[124:127]
    s_waitcnt lgkmcnt(6)
    ds_read_b64_tr_b16 a[172:173], v203 offset:0
    ds_read_b64_tr_b16 a[174:175], v203 offset:4096
    s_waitcnt vmcnt(22)
    v_mfma_f32_16x16x32_bf16 v[0:3], a[144:147], a[0:3], v[0:3]
    s_xor_b32 s52, s30, 25
    v_mfma_f32_16x16x32_bf16 v[8:11], a[144:147], a[32:35], v[8:11]
    s_lshl_b32 s52, s52, 15
    v_mfma_f32_16x16x32_bf16 v[16:19], a[144:147], a[64:67], v[16:19]
    s_add_u32 m0, s53, 40960
    v_mfma_f32_16x16x32_bf16 v[24:27], a[144:147], a[96:99], v[24:27]
    s_waitcnt lgkmcnt(6)
    buffer_load_dwordx4 v205, s[16:19], s52 offen lds
    v_mfma_f32_16x16x32_bf16 v[4:7], a[148:151], a[0:3], v[4:7]
    ds_read_b64_tr_b16 a[144:145], v196 offset:8192
    v_mfma_f32_16x16x32_bf16 v[12:15], a[148:151], a[32:35], v[12:15]
    ds_read_b64_tr_b16 a[146:147], v196 offset:12288
    v_mfma_f32_16x16x32_bf16 v[20:23], a[148:151], a[64:67], v[20:23]
    v_mfma_f32_16x16x32_bf16 v[28:31], a[148:151], a[96:99], v[28:31]
    s_waitcnt lgkmcnt(6)
    buffer_load_dwordx4 v206, s[16:19], s52 offen offset:1024 lds
    v_mfma_f32_16x16x32_bf16 v[32:35], a[152:155], a[0:3], v[32:35]
    ds_read_b64_tr_b16 a[148:149], v197 offset:8192
    v_mfma_f32_16x16x32_bf16 v[40:43], a[152:155], a[32:35], v[40:43]
    s_xor_b32 s46, s30, 17
    ds_read_b64_tr_b16 a[150:151], v197 offset:12288
    v_mfma_f32_16x16x32_bf16 v[48:51], a[152:155], a[64:67], v[48:51]
    s_lshl_b32 s46, s46, 10
    v_mfma_f32_16x16x32_bf16 v[56:59], a[152:155], a[96:99], v[56:59]
    s_waitcnt lgkmcnt(6)
    buffer_load_dwordx4 a[16:19], v221, s[4:7], s46 offen sc1
    v_mfma_f32_16x16x32_bf16 v[36:39], a[156:159], a[0:3], v[36:39]
    ds_read_b64_tr_b16 a[152:153], v198 offset:8192
    v_mfma_f32_16x16x32_bf16 v[44:47], a[156:159], a[32:35], v[44:47]
    ds_read_b64_tr_b16 a[154:155], v198 offset:12288
    v_mfma_f32_16x16x32_bf16 v[52:55], a[156:159], a[64:67], v[52:55]
    s_add_u32 s46, s46, 131072
    v_mfma_f32_16x16x32_bf16 v[60:63], a[156:159], a[96:99], v[60:63]
    s_waitcnt lgkmcnt(6)
    buffer_load_dwordx4 a[48:51], v221, s[4:7], s46 offen sc1
    v_mfma_f32_16x16x32_bf16 v[64:67], a[160:163], a[0:3], v[64:67]
    ds_read_b64_tr_b16 a[156:157], v199 offset:8192
    v_mfma_f32_16x16x32_bf16 v[72:75], a[160:163], a[32:35], v[72:75]
    ds_read_b64_tr_b16 a[158:159], v199 offset:12288
    v_mfma_f32_16x16x32_bf16 v[80:83], a[160:163], a[64:67], v[80:83]
    s_add_u32 s46, s46, 131072
    v_mfma_f32_16x16x32_bf16 v[88:91], a[160:163], a[96:99], v[88:91]
    s_waitcnt lgkmcnt(6)
    buffer_load_dwordx4 a[80:83], v221, s[4:7], s46 offen sc1
    v_mfma_f32_16x16x32_bf16 v[68:71], a[164:167], a[0:3], v[68:71]
    ds_read_b64_tr_b16 a[160:161], v200 offset:8192
    v_mfma_f32_16x16x32_bf16 v[76:79], a[164:167], a[32:35], v[76:79]
    ds_read_b64_tr_b16 a[162:163], v200 offset:12288
    v_mfma_f32_16x16x32_bf16 v[84:87], a[164:167], a[64:67], v[84:87]
    s_add_u32 s46, s46, 131072
    v_mfma_f32_16x16x32_bf16 v[92:95], a[164:167], a[96:99], v[92:95]
    s_waitcnt lgkmcnt(6)
    buffer_load_dwordx4 a[112:115], v221, s[4:7], s46 offen sc1
    v_mfma_f32_16x16x32_bf16 v[96:99], a[168:171], a[0:3], v[96:99]
    ds_read_b64_tr_b16 a[164:165], v201 offset:8192
    v_mfma_f32_16x16x32_bf16 v[104:107], a[168:171], a[32:35], v[104:107]
    ds_read_b64_tr_b16 a[166:167], v201 offset:12288
    v_mfma_f32_16x16x32_bf16 v[112:115], a[168:171], a[64:67], v[112:115]
    v_mfma_f32_16x16x32_bf16 v[120:123], a[168:171], a[96:99], v[120:123]
    s_waitcnt lgkmcnt(6)
    buffer_store_dwordx4 v[160:163], v221, s[20:23], s45 offen offset:2048 sc1
    v_mfma_f32_16x16x32_bf16 v[100:103], a[172:175], a[0:3], v[100:103]
    ds_read_b64_tr_b16 a[168:169], v202 offset:8192
    v_mfma_f32_16x16x32_bf16 v[108:111], a[172:175], a[32:35], v[108:111]
    ds_read_b64_tr_b16 a[170:171], v202 offset:12288
    v_mfma_f32_16x16x32_bf16 v[116:119], a[172:175], a[64:67], v[116:119]
    v_mfma_f32_16x16x32_bf16 v[124:127], a[172:175], a[96:99], v[124:127]
    s_waitcnt lgkmcnt(6)
    ds_read_b64_tr_b16 a[172:173], v203 offset:8192
    ds_read_b64_tr_b16 a[174:175], v203 offset:12288
    s_waitcnt vmcnt(19)
    s_barrier
    v_mfma_f32_16x16x32_bf16 v[0:3], a[144:147], a[4:7], v[0:3]
    s_xor_b32 s52, s30, 10
    v_mfma_f32_16x16x32_bf16 v[8:11], a[144:147], a[36:39], v[8:11]
    s_lshl_b32 s52, s52, 15
    v_mfma_f32_16x16x32_bf16 v[16:19], a[144:147], a[68:71], v[16:19]
    s_add_u32 m0, s53, 49152
    v_mfma_f32_16x16x32_bf16 v[24:27], a[144:147], a[100:103], v[24:27]
    s_waitcnt lgkmcnt(6)
    buffer_load_dwordx4 v205, s[16:19], s52 offen lds
    v_mfma_f32_16x16x32_bf16 v[4:7], a[148:151], a[4:7], v[4:7]
    ds_read_b64_tr_b16 a[144:145], v196 offset:16384
    v_mfma_f32_16x16x32_bf16 v[12:15], a[148:151], a[36:39], v[12:15]
    ds_read_b64_tr_b16 a[146:147], v196 offset:20480
    v_mfma_f32_16x16x32_bf16 v[20:23], a[148:151], a[68:71], v[20:23]
    v_mfma_f32_16x16x32_bf16 v[28:31], a[148:151], a[100:103], v[28:31]
    s_waitcnt lgkmcnt(6)
    buffer_load_dwordx4 v206, s[16:19], s52 offen offset:1024 lds
    v_mfma_f32_16x16x32_bf16 v[32:35], a[152:155], a[4:7], v[32:35]
    ds_read_b64_tr_b16 a[148:149], v197 offset:16384
    v_mfma_f32_16x16x32_bf16 v[40:43], a[152:155], a[36:39], v[40:43]
    s_xor_b32 s46, s30, 25
    ds_read_b64_tr_b16 a[150:151], v197 offset:20480
    v_mfma_f32_16x16x32_bf16 v[48:51], a[152:155], a[68:71], v[48:51]
    s_lshl_b32 s46, s46, 10
    v_mfma_f32_16x16x32_bf16 v[56:59], a[152:155], a[100:103], v[56:59]
    s_waitcnt lgkmcnt(6)
    buffer_load_dwordx4 a[20:23], v221, s[4:7], s46 offen sc1
    v_mfma_f32_16x16x32_bf16 v[36:39], a[156:159], a[4:7], v[36:39]
    ds_read_b64_tr_b16 a[152:153], v198 offset:16384
    v_mfma_f32_16x16x32_bf16 v[44:47], a[156:159], a[36:39], v[44:47]
    ds_read_b64_tr_b16 a[154:155], v198 offset:20480
    v_mfma_f32_16x16x32_bf16 v[52:55], a[156:159], a[68:71], v[52:55]
    s_add_u32 s46, s46, 131072
    v_mfma_f32_16x16x32_bf16 v[60:63], a[156:159], a[100:103], v[60:63]
    s_waitcnt lgkmcnt(6)
    buffer_load_dwordx4 a[52:55], v221, s[4:7], s46 offen sc1
    v_mfma_f32_16x16x32_bf16 v[64:67], a[160:163], a[4:7], v[64:67]
    ds_read_b64_tr_b16 a[156:157], v199 offset:16384
    v_mfma_f32_16x16x32_bf16 v[72:75], a[160:163], a[36:39], v[72:75]
    ds_read_b64_tr_b16 a[158:159], v199 offset:20480
    v_mfma_f32_16x16x32_bf16 v[80:83], a[160:163], a[68:71], v[80:83]
    s_add_u32 s46, s46, 131072
    v_mfma_f32_16x16x32_bf16 v[88:91], a[160:163], a[100:103], v[88:91]
    s_waitcnt lgkmcnt(6)
    buffer_load_dwordx4 a[84:87], v221, s[4:7], s46 offen sc1
    v_mfma_f32_16x16x32_bf16 v[68:71], a[164:167], a[4:7], v[68:71]
    ds_read_b64_tr_b16 a[160:161], v200 offset:16384
    v_mfma_f32_16x16x32_bf16 v[76:79], a[164:167], a[36:39], v[76:79]
    ds_read_b64_tr_b16 a[162:163], v200 offset:20480
    v_mfma_f32_16x16x32_bf16 v[84:87], a[164:167], a[68:71], v[84:87]
    s_add_u32 s46, s46, 131072
    v_mfma_f32_16x16x32_bf16 v[92:95], a[164:167], a[100:103], v[92:95]
    s_waitcnt lgkmcnt(6)
    buffer_load_dwordx4 a[116:119], v221, s[4:7], s46 offen sc1
    v_mfma_f32_16x16x32_bf16 v[96:99], a[168:171], a[4:7], v[96:99]
    ds_read_b64_tr_b16 a[164:165], v201 offset:16384
    v_mfma_f32_16x16x32_bf16 v[104:107], a[168:171], a[36:39], v[104:107]
    ds_read_b64_tr_b16 a[166:167], v201 offset:20480
    v_mfma_f32_16x16x32_bf16 v[112:115], a[168:171], a[68:71], v[112:115]
    v_mfma_f32_16x16x32_bf16 v[120:123], a[168:171], a[100:103], v[120:123]
    s_waitcnt lgkmcnt(6)
    buffer_store_dwordx4 v[164:167], v221, s[20:23], s48 offen offset:2048 sc1
    v_mfma_f32_16x16x32_bf16 v[100:103], a[172:175], a[4:7], v[100:103]
    ds_read_b64_tr_b16 a[168:169], v202 offset:16384
    v_mfma_f32_16x16x32_bf16 v[108:111], a[172:175], a[36:39], v[108:111]
    ds_read_b64_tr_b16 a[170:171], v202 offset:20480
    v_mfma_f32_16x16x32_bf16 v[116:119], a[172:175], a[68:71], v[116:119]
    v_mfma_f32_16x16x32_bf16 v[124:127], a[172:175], a[100:103], v[124:127]
    s_waitcnt lgkmcnt(6)
    ds_read_b64_tr_b16 a[172:173], v203 offset:16384
    ds_read_b64_tr_b16 a[174:175], v203 offset:20480
    s_waitcnt vmcnt(22)
    v_mfma_f32_16x16x32_bf16 v[0:3], a[144:147], a[8:11], v[0:3]
    s_xor_b32 s52, s30, 18
    v_mfma_f32_16x16x32_bf16 v[8:11], a[144:147], a[40:43], v[8:11]
    s_lshl_b32 s52, s52, 15
    v_mfma_f32_16x16x32_bf16 v[16:19], a[144:147], a[72:75], v[16:19]
    s_add_u32 m0, s53, 57344
    v_mfma_f32_16x16x32_bf16 v[24:27], a[144:147], a[104:107], v[24:27]
    s_waitcnt lgkmcnt(6)
    buffer_load_dwordx4 v205, s[16:19], s52 offen lds
    v_mfma_f32_16x16x32_bf16 v[4:7], a[148:151], a[8:11], v[4:7]
    ds_read_b64_tr_b16 a[144:145], v196 offset:24576
    v_mfma_f32_16x16x32_bf16 v[12:15], a[148:151], a[40:43], v[12:15]
    ds_read_b64_tr_b16 a[146:147], v196 offset:28672
    v_mfma_f32_16x16x32_bf16 v[20:23], a[148:151], a[72:75], v[20:23]
    v_mfma_f32_16x16x32_bf16 v[28:31], a[148:151], a[104:107], v[28:31]
    s_waitcnt lgkmcnt(6)
    buffer_load_dwordx4 v206, s[16:19], s52 offen offset:1024 lds
    v_mfma_f32_16x16x32_bf16 v[32:35], a[152:155], a[8:11], v[32:35]
    ds_read_b64_tr_b16 a[148:149], v197 offset:24576
    v_mfma_f32_16x16x32_bf16 v[40:43], a[152:155], a[40:43], v[40:43]
    s_xor_b32 s46, s30, 10
    ds_read_b64_tr_b16 a[150:151], v197 offset:28672
    v_mfma_f32_16x16x32_bf16 v[48:51], a[152:155], a[72:75], v[48:51]
    s_lshl_b32 s46, s46, 10
    v_mfma_f32_16x16x32_bf16 v[56:59], a[152:155], a[104:107], v[56:59]
    s_waitcnt lgkmcnt(6)
    buffer_load_dwordx4 a[24:27], v221, s[4:7], s46 offen sc1
    v_mfma_f32_16x16x32_bf16 v[36:39], a[156:159], a[8:11], v[36:39]
    ds_read_b64_tr_b16 a[152:153], v198 offset:24576
    v_mfma_f32_16x16x32_bf16 v[44:47], a[156:159], a[40:43], v[44:47]
    ds_read_b64_tr_b16 a[154:155], v198 offset:28672
    v_mfma_f32_16x16x32_bf16 v[52:55], a[156:159], a[72:75], v[52:55]
    s_add_u32 s46, s46, 131072
    v_mfma_f32_16x16x32_bf16 v[60:63], a[156:159], a[104:107], v[60:63]
    s_waitcnt lgkmcnt(6)
    buffer_load_dwordx4 a[56:59], v221, s[4:7], s46 offen sc1
    v_mfma_f32_16x16x32_bf16 v[64:67], a[160:163], a[8:11], v[64:67]
    ds_read_b64_tr_b16 a[156:157], v199 offset:24576
    v_mfma_f32_16x16x32_bf16 v[72:75], a[160:163], a[40:43], v[72:75]
    ds_read_b64_tr_b16 a[158:159], v199 offset:28672
    v_mfma_f32_16x16x32_bf16 v[80:83], a[160:163], a[72:75], v[80:83]
    s_add_u32 s46, s46, 131072
    v_mfma_f32_16x16x32_bf16 v[88:91], a[160:163], a[104:107], v[88:91]
    s_waitcnt lgkmcnt(6)
    buffer_load_dwordx4 a[88:91], v221, s[4:7], s46 offen sc1
    v_mfma_f32_16x16x32_bf16 v[68:71], a[164:167], a[8:11], v[68:71]
    ds_read_b64_tr_b16 a[160:161], v200 offset:24576
    v_mfma_f32_16x16x32_bf16 v[76:79], a[164:167], a[40:43], v[76:79]
    ds_read_b64_tr_b16 a[162:163], v200 offset:28672
    v_mfma_f32_16x16x32_bf16 v[84:87], a[164:167], a[72:75], v[84:87]
    s_add_u32 s46, s46, 131072
    v_mfma_f32_16x16x32_bf16 v[92:95], a[164:167], a[104:107], v[92:95]
    s_waitcnt lgkmcnt(6)
    buffer_load_dwordx4 a[120:123], v221, s[4:7], s46 offen sc1
    v_mfma_f32_16x16x32_bf16 v[96:99], a[168:171], a[8:11], v[96:99]
    ds_read_b64_tr_b16 a[164:165], v201 offset:24576
    v_mfma_f32_16x16x32_bf16 v[104:107], a[168:171], a[40:43], v[104:107]
    ds_read_b64_tr_b16 a[166:167], v201 offset:28672
    v_mfma_f32_16x16x32_bf16 v[112:115], a[168:171], a[72:75], v[112:115]
    v_mfma_f32_16x16x32_bf16 v[120:123], a[168:171], a[104:107], v[120:123]
    s_waitcnt lgkmcnt(6)
    buffer_store_dwordx4 v[168:171], v221, s[20:23], s49 offen offset:2048 sc1
    v_mfma_f32_16x16x32_bf16 v[100:103], a[172:175], a[8:11], v[100:103]
    ds_read_b64_tr_b16 a[168:169], v202 offset:24576
    v_mfma_f32_16x16x32_bf16 v[108:111], a[172:175], a[40:43], v[108:111]
    ds_read_b64_tr_b16 a[170:171], v202 offset:28672
    v_mfma_f32_16x16x32_bf16 v[116:119], a[172:175], a[72:75], v[116:119]
    v_mfma_f32_16x16x32_bf16 v[124:127], a[172:175], a[104:107], v[124:127]
    s_waitcnt lgkmcnt(6)
    ds_read_b64_tr_b16 a[172:173], v203 offset:24576
    ds_read_b64_tr_b16 a[174:175], v203 offset:28672
    s_waitcnt vmcnt(19)
    s_barrier
    buffer_store_dword v219, v218, s[12:15], s28 offen offset:16 sc1
    v_mfma_f32_16x16x32_bf16 v[0:3], a[144:147], a[12:15], v[0:3]
    s_xor_b32 s52, s30, 26
    v_mfma_f32_16x16x32_bf16 v[8:11], a[144:147], a[44:47], v[8:11]
    s_lshl_b32 s52, s52, 15
    v_mfma_f32_16x16x32_bf16 v[16:19], a[144:147], a[76:79], v[16:19]
    s_add_u32 m0, s53, 0
    v_mfma_f32_16x16x32_bf16 v[24:27], a[144:147], a[108:111], v[24:27]
    s_waitcnt lgkmcnt(6)
    buffer_load_dwordx4 v205, s[16:19], s52 offen lds
    v_mfma_f32_16x16x32_bf16 v[4:7], a[148:151], a[12:15], v[4:7]
    ds_read_b64_tr_b16 a[144:145], v196 offset:32768
    v_mfma_f32_16x16x32_bf16 v[12:15], a[148:151], a[44:47], v[12:15]
    ds_read_b64_tr_b16 a[146:147], v196 offset:36864
    v_mfma_f32_16x16x32_bf16 v[20:23], a[148:151], a[76:79], v[20:23]
    v_mfma_f32_16x16x32_bf16 v[28:31], a[148:151], a[108:111], v[28:31]
    s_waitcnt lgkmcnt(6)
    buffer_load_dwordx4 v206, s[16:19], s52 offen offset:1024 lds
    v_mfma_f32_16x16x32_bf16 v[32:35], a[152:155], a[12:15], v[32:35]
    ds_read_b64_tr_b16 a[148:149], v197 offset:32768
    v_mfma_f32_16x16x32_bf16 v[40:43], a[152:155], a[44:47], v[40:43]
    s_xor_b32 s46, s30, 18
    ds_read_b64_tr_b16 a[150:151], v197 offset:36864
    v_mfma_f32_16x16x32_bf16 v[48:51], a[152:155], a[76:79], v[48:51]
    s_lshl_b32 s46, s46, 10
    v_mfma_f32_16x16x32_bf16 v[56:59], a[152:155], a[108:111], v[56:59]
    s_waitcnt lgkmcnt(6)
    buffer_load_dwordx4 a[28:31], v221, s[4:7], s46 offen sc1
    v_mfma_f32_16x16x32_bf16 v[36:39], a[156:159], a[12:15], v[36:39]
    ds_read_b64_tr_b16 a[152:153], v198 offset:32768
    v_mfma_f32_16x16x32_bf16 v[44:47], a[156:159], a[44:47], v[44:47]
    ds_read_b64_tr_b16 a[154:155], v198 offset:36864
    v_mfma_f32_16x16x32_bf16 v[52:55], a[156:159], a[76:79], v[52:55]
    s_add_u32 s46, s46, 131072
    v_mfma_f32_16x16x32_bf16 v[60:63], a[156:159], a[108:111], v[60:63]
    s_waitcnt lgkmcnt(6)
    buffer_load_dwordx4 a[60:63], v221, s[4:7], s46 offen sc1
    v_mfma_f32_16x16x32_bf16 v[64:67], a[160:163], a[12:15], v[64:67]
    ds_read_b64_tr_b16 a[156:157], v199 offset:32768
    v_mfma_f32_16x16x32_bf16 v[72:75], a[160:163], a[44:47], v[72:75]
    ds_read_b64_tr_b16 a[158:159], v199 offset:36864
    v_mfma_f32_16x16x32_bf16 v[80:83], a[160:163], a[76:79], v[80:83]
    s_add_u32 s46, s46, 131072
    v_mfma_f32_16x16x32_bf16 v[88:91], a[160:163], a[108:111], v[88:91]
    s_waitcnt lgkmcnt(6)
    buffer_load_dwordx4 a[92:95], v221, s[4:7], s46 offen sc1
    v_mfma_f32_16x16x32_bf16 v[68:71], a[164:167], a[12:15], v[68:71]
    ds_read_b64_tr_b16 a[160:161], v200 offset:32768
    v_mfma_f32_16x16x32_bf16 v[76:79], a[164:167], a[44:47], v[76:79]
    ds_read_b64_tr_b16 a[162:163], v200 offset:36864
    v_mfma_f32_16x16x32_bf16 v[84:87], a[164:167], a[76:79], v[84:87]
    s_add_u32 s46, s46, 131072
    v_mfma_f32_16x16x32_bf16 v[92:95], a[164:167], a[108:111], v[92:95]
    s_waitcnt lgkmcnt(6)
    buffer_load_dwordx4 a[124:127], v221, s[4:7], s46 offen sc1
    v_mfma_f32_16x16x32_bf16 v[96:99], a[168:171], a[12:15], v[96:99]
    ds_read_b64_tr_b16 a[164:165], v201 offset:32768
    v_mfma_f32_16x16x32_bf16 v[104:107], a[168:171], a[44:47], v[104:107]
    ds_read_b64_tr_b16 a[166:167], v201 offset:36864
    v_mfma_f32_16x16x32_bf16 v[112:115], a[168:171], a[76:79], v[112:115]
    v_mfma_f32_16x16x32_bf16 v[120:123], a[168:171], a[108:111], v[120:123]
    s_waitcnt lgkmcnt(6)
    buffer_store_dwordx4 v[172:175], v221, s[20:23], s101 offen offset:2048 sc1
    v_mfma_f32_16x16x32_bf16 v[100:103], a[172:175], a[12:15], v[100:103]
    ds_read_b64_tr_b16 a[168:169], v202 offset:32768
    v_mfma_f32_16x16x32_bf16 v[108:111], a[172:175], a[44:47], v[108:111]
    ds_read_b64_tr_b16 a[170:171], v202 offset:36864
    v_mfma_f32_16x16x32_bf16 v[116:119], a[172:175], a[76:79], v[116:119]
    v_mfma_f32_16x16x32_bf16 v[124:127], a[172:175], a[108:111], v[124:127]
    s_waitcnt lgkmcnt(6)
    ds_read_b64_tr_b16 a[172:173], v203 offset:32768
    ds_read_b64_tr_b16 a[174:175], v203 offset:36864
    s_waitcnt vmcnt(23)
    v_mfma_f32_16x16x32_bf16 v[0:3], a[144:147], a[16:19], v[0:3]
    s_xor_b32 s52, s30, 11
    v_mfma_f32_16x16x32_bf16 v[8:11], a[144:147], a[48:51], v[8:11]
    s_lshl_b32 s52, s52, 15
    v_mfma_f32_16x16x32_bf16 v[16:19], a[144:147], a[80:83], v[16:19]
    s_add_u32 m0, s53, 8192
    v_mfma_f32_16x16x32_bf16 v[24:27], a[144:147], a[112:115], v[24:27]
    s_waitcnt lgkmcnt(6)
    buffer_load_dwordx4 v205, s[16:19], s52 offen lds
    v_mfma_f32_16x16x32_bf16 v[4:7], a[148:151], a[16:19], v[4:7]
    ds_read_b64_tr_b16 a[144:145], v196 offset:40960
    v_mfma_f32_16x16x32_bf16 v[12:15], a[148:151], a[48:51], v[12:15]
    ds_read_b64_tr_b16 a[146:147], v196 offset:45056
    v_mfma_f32_16x16x32_bf16 v[20:23], a[148:151], a[80:83], v[20:23]
    v_mfma_f32_16x16x32_bf16 v[28:31], a[148:151], a[112:115], v[28:31]
    s_waitcnt lgkmcnt(6)
    buffer_load_dwordx4 v206, s[16:19], s52 offen offset:1024 lds
    v_mfma_f32_16x16x32_bf16 v[32:35], a[152:155], a[16:19], v[32:35]
    ds_read_b64_tr_b16 a[148:149], v197 offset:40960
    v_mfma_f32_16x16x32_bf16 v[40:43], a[152:155], a[48:51], v[40:43]
    s_xor_b32 s46, s30, 26
    ds_read_b64_tr_b16 a[150:151], v197 offset:45056
    v_mfma_f32_16x16x32_bf16 v[48:51], a[152:155], a[80:83], v[48:51]
    s_lshl_b32 s46, s46, 10
    v_mfma_f32_16x16x32_bf16 v[56:59], a[152:155], a[112:115], v[56:59]
    s_waitcnt lgkmcnt(6)
    buffer_load_dwordx4 a[0:3], v221, s[4:7], s46 offen sc1
    v_mfma_f32_16x16x32_bf16 v[36:39], a[156:159], a[16:19], v[36:39]
    ds_read_b64_tr_b16 a[152:153], v198 offset:40960
    v_mfma_f32_16x16x32_bf16 v[44:47], a[156:159], a[48:51], v[44:47]
    ds_read_b64_tr_b16 a[154:155], v198 offset:45056
    v_mfma_f32_16x16x32_bf16 v[52:55], a[156:159], a[80:83], v[52:55]
    s_add_u32 s46, s46, 131072
    v_mfma_f32_16x16x32_bf16 v[60:63], a[156:159], a[112:115], v[60:63]
    s_waitcnt lgkmcnt(6)
    buffer_load_dwordx4 a[32:35], v221, s[4:7], s46 offen sc1
    v_mfma_f32_16x16x32_bf16 v[64:67], a[160:163], a[16:19], v[64:67]
    ds_read_b64_tr_b16 a[156:157], v199 offset:40960
    v_mfma_f32_16x16x32_bf16 v[72:75], a[160:163], a[48:51], v[72:75]
    ds_read_b64_tr_b16 a[158:159], v199 offset:45056
    v_mfma_f32_16x16x32_bf16 v[80:83], a[160:163], a[80:83], v[80:83]
    s_add_u32 s46, s46, 131072
    v_mfma_f32_16x16x32_bf16 v[88:91], a[160:163], a[112:115], v[88:91]
    s_waitcnt lgkmcnt(6)
    buffer_load_dwordx4 a[64:67], v221, s[4:7], s46 offen sc1
    v_mfma_f32_16x16x32_bf16 v[68:71], a[164:167], a[16:19], v[68:71]
    ds_read_b64_tr_b16 a[160:161], v200 offset:40960
    v_mfma_f32_16x16x32_bf16 v[76:79], a[164:167], a[48:51], v[76:79]
    ds_read_b64_tr_b16 a[162:163], v200 offset:45056
    v_mfma_f32_16x16x32_bf16 v[84:87], a[164:167], a[80:83], v[84:87]
    s_add_u32 s46, s46, 131072
    v_mfma_f32_16x16x32_bf16 v[92:95], a[164:167], a[112:115], v[92:95]
    s_waitcnt lgkmcnt(6)
    buffer_load_dwordx4 a[96:99], v221, s[4:7], s46 offen sc1
    v_mfma_f32_16x16x32_bf16 v[96:99], a[168:171], a[16:19], v[96:99]
    ds_read_b64_tr_b16 a[164:165], v201 offset:40960
    v_mfma_f32_16x16x32_bf16 v[104:107], a[168:171], a[48:51], v[104:107]
    ds_read_b64_tr_b16 a[166:167], v201 offset:45056
    v_mfma_f32_16x16x32_bf16 v[112:115], a[168:171], a[80:83], v[112:115]
    v_mfma_f32_16x16x32_bf16 v[120:123], a[168:171], a[112:115], v[120:123]
    s_waitcnt lgkmcnt(6)
    buffer_store_dwordx4 v[176:179], v221, s[20:23], s45 offen offset:3072 sc1
    v_mfma_f32_16x16x32_bf16 v[100:103], a[172:175], a[16:19], v[100:103]
    ds_read_b64_tr_b16 a[168:169], v202 offset:40960
    v_mfma_f32_16x16x32_bf16 v[108:111], a[172:175], a[48:51], v[108:111]
    ds_read_b64_tr_b16 a[170:171], v202 offset:45056
    v_mfma_f32_16x16x32_bf16 v[116:119], a[172:175], a[80:83], v[116:119]
    v_mfma_f32_16x16x32_bf16 v[124:127], a[172:175], a[112:115], v[124:127]
    s_waitcnt lgkmcnt(6)
    ds_read_b64_tr_b16 a[172:173], v203 offset:40960
    ds_read_b64_tr_b16 a[174:175], v203 offset:45056
    s_waitcnt vmcnt(20)
    s_barrier
    v_mfma_f32_16x16x32_bf16 v[0:3], a[144:147], a[20:23], v[0:3]
    s_xor_b32 s52, s30, 19
    v_mfma_f32_16x16x32_bf16 v[8:11], a[144:147], a[52:55], v[8:11]
    s_lshl_b32 s52, s52, 15
    v_mfma_f32_16x16x32_bf16 v[16:19], a[144:147], a[84:87], v[16:19]
    s_add_u32 m0, s53, 16384
    v_mfma_f32_16x16x32_bf16 v[24:27], a[144:147], a[116:119], v[24:27]
    s_waitcnt lgkmcnt(6)
    buffer_load_dwordx4 v205, s[16:19], s52 offen lds
    v_mfma_f32_16x16x32_bf16 v[4:7], a[148:151], a[20:23], v[4:7]
    ds_read_b64_tr_b16 a[144:145], v196 offset:49152
    v_mfma_f32_16x16x32_bf16 v[12:15], a[148:151], a[52:55], v[12:15]
    ds_read_b64_tr_b16 a[146:147], v196 offset:53248
    v_mfma_f32_16x16x32_bf16 v[20:23], a[148:151], a[84:87], v[20:23]
    v_mfma_f32_16x16x32_bf16 v[28:31], a[148:151], a[116:119], v[28:31]
    s_waitcnt lgkmcnt(6)
    buffer_load_dwordx4 v206, s[16:19], s52 offen offset:1024 lds
    v_mfma_f32_16x16x32_bf16 v[32:35], a[152:155], a[20:23], v[32:35]
    ds_read_b64_tr_b16 a[148:149], v197 offset:49152
    v_mfma_f32_16x16x32_bf16 v[40:43], a[152:155], a[52:55], v[40:43]
    s_xor_b32 s46, s30, 11
    ds_read_b64_tr_b16 a[150:151], v197 offset:53248
    v_mfma_f32_16x16x32_bf16 v[48:51], a[152:155], a[84:87], v[48:51]
    s_lshl_b32 s46, s46, 10
    v_mfma_f32_16x16x32_bf16 v[56:59], a[152:155], a[116:119], v[56:59]
    s_waitcnt lgkmcnt(6)
    buffer_load_dwordx4 a[4:7], v221, s[4:7], s46 offen sc1
    v_mfma_f32_16x16x32_bf16 v[36:39], a[156:159], a[20:23], v[36:39]
    ds_read_b64_tr_b16 a[152:153], v198 offset:49152
    v_mfma_f32_16x16x32_bf16 v[44:47], a[156:159], a[52:55], v[44:47]
    ds_read_b64_tr_b16 a[154:155], v198 offset:53248
    v_mfma_f32_16x16x32_bf16 v[52:55], a[156:159], a[84:87], v[52:55]
    s_add_u32 s46, s46, 131072
    v_mfma_f32_16x16x32_bf16 v[60:63], a[156:159], a[116:119], v[60:63]
    s_waitcnt lgkmcnt(6)
    buffer_load_dwordx4 a[36:39], v221, s[4:7], s46 offen sc1
    v_mfma_f32_16x16x32_bf16 v[64:67], a[160:163], a[20:23], v[64:67]
    ds_read_b64_tr_b16 a[156:157], v199 offset:49152
    v_mfma_f32_16x16x32_bf16 v[72:75], a[160:163], a[52:55], v[72:75]
    ds_read_b64_tr_b16 a[158:159], v199 offset:53248
    v_mfma_f32_16x16x32_bf16 v[80:83], a[160:163], a[84:87], v[80:83]
    s_add_u32 s46, s46, 131072
    v_mfma_f32_16x16x32_bf16 v[88:91], a[160:163], a[116:119], v[88:91]
    s_waitcnt lgkmcnt(6)
    buffer_load_dwordx4 a[68:71], v221, s[4:7], s46 offen sc1
    v_mfma_f32_16x16x32_bf16 v[68:71], a[164:167], a[20:23], v[68:71]
    ds_read_b64_tr_b16 a[160:161], v200 offset:49152
    v_mfma_f32_16x16x32_bf16 v[76:79], a[164:167], a[52:55], v[76:79]
    ds_read_b64_tr_b16 a[162:163], v200 offset:53248
    v_mfma_f32_16x16x32_bf16 v[84:87], a[164:167], a[84:87], v[84:87]
    s_add_u32 s46, s46, 131072
    v_mfma_f32_16x16x32_bf16 v[92:95], a[164:167], a[116:119], v[92:95]
    s_waitcnt lgkmcnt(6)
    buffer_load_dwordx4 a[100:103], v221, s[4:7], s46 offen sc1
    v_mfma_f32_16x16x32_bf16 v[96:99], a[168:171], a[20:23], v[96:99]
    ds_read_b64_tr_b16 a[164:165], v201 offset:49152
    v_mfma_f32_16x16x32_bf16 v[104:107], a[168:171], a[52:55], v[104:107]
    ds_read_b64_tr_b16 a[166:167], v201 offset:53248
    v_mfma_f32_16x16x32_bf16 v[112:115], a[168:171], a[84:87], v[112:115]
    v_mfma_f32_16x16x32_bf16 v[120:123], a[168:171], a[116:119], v[120:123]
    s_waitcnt lgkmcnt(6)
    buffer_store_dwordx4 v[180:183], v221, s[20:23], s48 offen offset:3072 sc1
    v_mfma_f32_16x16x32_bf16 v[100:103], a[172:175], a[20:23], v[100:103]
    ds_read_b64_tr_b16 a[168:169], v202 offset:49152
    v_mfma_f32_16x16x32_bf16 v[108:111], a[172:175], a[52:55], v[108:111]
    ds_read_b64_tr_b16 a[170:171], v202 offset:53248
    v_mfma_f32_16x16x32_bf16 v[116:119], a[172:175], a[84:87], v[116:119]
    v_mfma_f32_16x16x32_bf16 v[124:127], a[172:175], a[116:119], v[124:127]
    s_waitcnt lgkmcnt(6)
    ds_read_b64_tr_b16 a[172:173], v203 offset:49152
    ds_read_b64_tr_b16 a[174:175], v203 offset:53248
    s_waitcnt vmcnt(23)
    v_mfma_f32_16x16x32_bf16 v[0:3], a[144:147], a[24:27], v[0:3]
    v_mfma_f32_16x16x32_bf16 v[8:11], a[144:147], a[56:59], v[8:11]
    v_mfma_f32_16x16x32_bf16 v[16:19], a[144:147], a[88:91], v[16:19]
    v_mfma_f32_16x16x32_bf16 v[24:27], a[144:147], a[120:123], v[24:27]
    s_waitcnt lgkmcnt(6)
    buffer_load_dword v208, v204, s[12:15], s60 offen offset:16 sc1
    v_mfma_f32_16x16x32_bf16 v[4:7], a[148:151], a[24:27], v[4:7]
    s_xor_b32 s52, s30, 27
    s_lshl_b32 s52, s52, 15
    ds_read_b64_tr_b16 a[144:145], v196 offset:57344
    v_mfma_f32_16x16x32_bf16 v[12:15], a[148:151], a[56:59], v[12:15]
    s_add_u32 m0, s53, 24576
    ds_read_b64_tr_b16 a[146:147], v196 offset:61440
    v_mfma_f32_16x16x32_bf16 v[20:23], a[148:151], a[88:91], v[20:23]
    buffer_load_dwordx4 v205, s[16:19], s52 offen lds
    v_mfma_f32_16x16x32_bf16 v[28:31], a[148:151], a[120:123], v[28:31]
    s_waitcnt lgkmcnt(6)
    v_mfma_f32_16x16x32_bf16 v[32:35], a[152:155], a[24:27], v[32:35]
    ds_read_b64_tr_b16 a[148:149], v197 offset:57344
    v_mfma_f32_16x16x32_bf16 v[40:43], a[152:155], a[56:59], v[40:43]
    ds_read_b64_tr_b16 a[150:151], v197 offset:61440
    v_mfma_f32_16x16x32_bf16 v[48:51], a[152:155], a[88:91], v[48:51]
    buffer_load_dwordx4 v206, s[16:19], s52 offen offset:1024 lds
    v_mfma_f32_16x16x32_bf16 v[56:59], a[152:155], a[120:123], v[56:59]
    s_waitcnt lgkmcnt(6)
    v_mfma_f32_16x16x32_bf16 v[36:39], a[156:159], a[24:27], v[36:39]
    s_xor_b32 s46, s30, 19
    ds_read_b64_tr_b16 a[152:153], v198 offset:57344
    v_mfma_f32_16x16x32_bf16 v[44:47], a[156:159], a[56:59], v[44:47]
    s_lshl_b32 s46, s46, 10
    ds_read_b64_tr_b16 a[154:155], v198 offset:61440
    v_mfma_f32_16x16x32_bf16 v[52:55], a[156:159], a[88:91], v[52:55]
    buffer_load_dwordx4 a[8:11], v221, s[4:7], s46 offen sc1
    v_mfma_f32_16x16x32_bf16 v[60:63], a[156:159], a[120:123], v[60:63]
    s_waitcnt lgkmcnt(6)
    v_mfma_f32_16x16x32_bf16 v[64:67], a[160:163], a[24:27], v[64:67]
    ds_read_b64_tr_b16 a[156:157], v199 offset:57344
    v_mfma_f32_16x16x32_bf16 v[72:75], a[160:163], a[56:59], v[72:75]
    s_add_u32 s46, s46, 131072
    ds_read_b64_tr_b16 a[158:159], v199 offset:61440
    v_mfma_f32_16x16x32_bf16 v[80:83], a[160:163], a[88:91], v[80:83]
    buffer_load_dwordx4 a[40:43], v221, s[4:7], s46 offen sc1
    v_mfma_f32_16x16x32_bf16 v[88:91], a[160:163], a[120:123], v[88:91]
    s_waitcnt lgkmcnt(6)
    v_mfma_f32_16x16x32_bf16 v[68:71], a[164:167], a[24:27], v[68:71]
    ds_read_b64_tr_b16 a[160:161], v200 offset:57344
    v_mfma_f32_16x16x32_bf16 v[76:79], a[164:167], a[56:59], v[76:79]
    s_add_u32 s46, s46, 131072
    ds_read_b64_tr_b16 a[162:163], v200 offset:61440
    v_mfma_f32_16x16x32_bf16 v[84:87], a[164:167], a[88:91], v[84:87]
    buffer_load_dwordx4 a[72:75], v221, s[4:7], s46 offen sc1
    v_mfma_f32_16x16x32_bf16 v[92:95], a[164:167], a[120:123], v[92:95]
    s_waitcnt lgkmcnt(6)
    v_mfma_f32_16x16x32_bf16 v[96:99], a[168:171], a[24:27], v[96:99]
    ds_read_b64_tr_b16 a[164:165], v201 offset:57344
    v_mfma_f32_16x16x32_bf16 v[104:107], a[168:171], a[56:59], v[104:107]
    s_add_u32 s46, s46, 131072
    ds_read_b64_tr_b16 a[166:167], v201 offset:61440
    v_mfma_f32_16x16x32_bf16 v[112:115], a[168:171], a[88:91], v[112:115]
    buffer_load_dwordx4 a[104:107], v221, s[4:7], s46 offen sc1
    v_mfma_f32_16x16x32_bf16 v[120:123], a[168:171], a[120:123], v[120:123]
    s_waitcnt lgkmcnt(6)
    v_mfma_f32_16x16x32_bf16 v[100:103], a[172:175], a[24:27], v[100:103]
    ds_read_b64_tr_b16 a[168:169], v202 offset:57344
    v_mfma_f32_16x16x32_bf16 v[108:111], a[172:175], a[56:59], v[108:111]
    ds_read_b64_tr_b16 a[170:171], v202 offset:61440
    v_mfma_f32_16x16x32_bf16 v[116:119], a[172:175], a[88:91], v[116:119]
    buffer_store_dwordx4 v[184:187], v221, s[20:23], s49 offen offset:3072 sc1
    v_mfma_f32_16x16x32_bf16 v[124:127], a[172:175], a[120:123], v[124:127]
    s_waitcnt lgkmcnt(6)
    ds_read_b64_tr_b16 a[172:173], v203 offset:57344
    ds_read_b64_tr_b16 a[174:175], v203 offset:61440
    s_waitcnt vmcnt(20)
    s_barrier
    v_mfma_f32_16x16x32_bf16 v[0:3], a[144:147], a[28:31], v[0:3]
    s_xor_b32 s52, s30, 12
    v_mfma_f32_16x16x32_bf16 v[8:11], a[144:147], a[60:63], v[8:11]
    s_lshl_b32 s52, s52, 15
    v_mfma_f32_16x16x32_bf16 v[16:19], a[144:147], a[92:95], v[16:19]
    s_add_u32 m0, s53, 32768
    v_mfma_f32_16x16x32_bf16 v[24:27], a[144:147], a[124:127], v[24:27]
    s_waitcnt lgkmcnt(6)
    buffer_load_dwordx4 v205, s[16:19], s52 offen lds
    v_mfma_f32_16x16x32_bf16 v[4:7], a[148:151], a[28:31], v[4:7]
    ds_read_b64_tr_b16 a[144:145], v196 offset:0
    v_mfma_f32_16x16x32_bf16 v[12:15], a[148:151], a[60:63], v[12:15]
    ds_read_b64_tr_b16 a[146:147], v196 offset:4096
    v_mfma_f32_16x16x32_bf16 v[20:23], a[148:151], a[92:95], v[20:23]
    v_mfma_f32_16x16x32_bf16 v[28:31], a[148:151], a[124:127], v[28:31]
    s_waitcnt lgkmcnt(6)
    buffer_load_dwordx4 v206, s[16:19], s52 offen offset:1024 lds
    v_mfma_f32_16x16x32_bf16 v[32:35], a[152:155], a[28:31], v[32:35]
    ds_read_b64_tr_b16 a[148:149], v197 offset:0
    v_mfma_f32_16x16x32_bf16 v[40:43], a[152:155], a[60:63], v[40:43]
    s_xor_b32 s46, s30, 27
    ds_read_b64_tr_b16 a[150:151], v197 offset:4096
    v_mfma_f32_16x16x32_bf16 v[48:51], a[152:155], a[92:95], v[48:51]
    s_lshl_b32 s46, s46, 10
    v_mfma_f32_16x16x32_bf16 v[56:59], a[152:155], a[124:127], v[56:59]
    s_waitcnt lgkmcnt(6)
    buffer_load_dwordx4 a[12:15], v221, s[4:7], s46 offen sc1
    v_mfma_f32_16x16x32_bf16 v[36:39], a[156:159], a[28:31], v[36:39]
    ds_read_b64_tr_b16 a[152:153], v198 offset:0
    v_mfma_f32_16x16x32_bf16 v[44:47], a[156:159], a[60:63], v[44:47]
    ds_read_b64_tr_b16 a[154:155], v198 offset:4096
    v_mfma_f32_16x16x32_bf16 v[52:55], a[156:159], a[92:95], v[52:55]
    s_add_u32 s46, s46, 131072
    v_mfma_f32_16x16x32_bf16 v[60:63], a[156:159], a[124:127], v[60:63]
    s_waitcnt lgkmcnt(6)
    buffer_load_dwordx4 a[44:47], v221, s[4:7], s46 offen sc1
    v_mfma_f32_16x16x32_bf16 v[64:67], a[160:163], a[28:31], v[64:67]
    ds_read_b64_tr_b16 a[156:157], v199 offset:0
    v_mfma_f32_16x16x32_bf16 v[72:75], a[160:163], a[60:63], v[72:75]
    ds_read_b64_tr_b16 a[158:159], v199 offset:4096
    v_mfma_f32_16x16x32_bf16 v[80:83], a[160:163], a[92:95], v[80:83]
    s_add_u32 s46, s46, 131072
    v_mfma_f32_16x16x32_bf16 v[88:91], a[160:163], a[124:127], v[88:91]
    s_waitcnt lgkmcnt(6)
    buffer_load_dwordx4 a[76:79], v221, s[4:7], s46 offen sc1
    v_mfma_f32_16x16x32_bf16 v[68:71], a[164:167], a[28:31], v[68:71]
    ds_read_b64_tr_b16 a[160:161], v200 offset:0
    v_mfma_f32_16x16x32_bf16 v[76:79], a[164:167], a[60:63], v[76:79]
    ds_read_b64_tr_b16 a[162:163], v200 offset:4096
    v_mfma_f32_16x16x32_bf16 v[84:87], a[164:167], a[92:95], v[84:87]
    s_add_u32 s46, s46, 131072
    v_mfma_f32_16x16x32_bf16 v[92:95], a[164:167], a[124:127], v[92:95]
    s_waitcnt lgkmcnt(6)
    buffer_load_dwordx4 a[108:111], v221, s[4:7], s46 offen sc1
    v_mfma_f32_16x16x32_bf16 v[96:99], a[168:171], a[28:31], v[96:99]
    ds_read_b64_tr_b16 a[164:165], v201 offset:0
    v_mfma_f32_16x16x32_bf16 v[104:107], a[168:171], a[60:63], v[104:107]
    ds_read_b64_tr_b16 a[166:167], v201 offset:4096
    v_mfma_f32_16x16x32_bf16 v[112:115], a[168:171], a[92:95], v[112:115]
    v_mfma_f32_16x16x32_bf16 v[120:123], a[168:171], a[124:127], v[120:123]
    s_waitcnt lgkmcnt(6)
    buffer_store_dwordx4 v[188:191], v221, s[20:23], s101 offen offset:3072 sc1
    v_mfma_f32_16x16x32_bf16 v[100:103], a[172:175], a[28:31], v[100:103]
    ds_read_b64_tr_b16 a[168:169], v202 offset:0
    v_mfma_f32_16x16x32_bf16 v[108:111], a[172:175], a[60:63], v[108:111]
    ds_read_b64_tr_b16 a[170:171], v202 offset:4096
    v_mfma_f32_16x16x32_bf16 v[116:119], a[172:175], a[92:95], v[116:119]
    v_mfma_f32_16x16x32_bf16 v[124:127], a[172:175], a[124:127], v[124:127]
    s_waitcnt lgkmcnt(6)
    ds_read_b64_tr_b16 a[172:173], v203 offset:0
    ds_read_b64_tr_b16 a[174:175], v203 offset:4096
    s_waitcnt vmcnt(14)
    v_cmp_ne_u32 vcc, s54, v208
    s_cmp_eq_u32 vcc_lo, 0
    s_cbranch_scc0 K1_SPIN2
K1_CHK2_OK:
    v_mfma_f32_16x16x32_bf16 v[0:3], a[144:147], a[0:3], v[0:3]
    s_xor_b32 s52, s30, 20
    v_mfma_f32_16x16x32_bf16 v[8:11], a[144:147], a[32:35], v[8:11]
    s_lshl_b32 s52, s52, 15
    v_mfma_f32_16x16x32_bf16 v[16:19], a[144:147], a[64:67], v[16:19]
    s_add_u32 m0, s53, 40960
    v_mfma_f32_16x16x32_bf16 v[24:27], a[144:147], a[96:99], v[24:27]
    s_waitcnt lgkmcnt(6)
    buffer_load_dwordx4 v205, s[16:19], s52 offen lds
    v_mfma_f32_16x16x32_bf16 v[4:7], a[148:151], a[0:3], v[4:7]
    ds_read_b64_tr_b16 a[144:145], v196 offset:8192
    v_mfma_f32_16x16x32_bf16 v[12:15], a[148:151], a[32:35], v[12:15]
    ds_read_b64_tr_b16 a[146:147], v196 offset:12288
    v_mfma_f32_16x16x32_bf16 v[20:23], a[148:151], a[64:67], v[20:23]
    v_mfma_f32_16x16x32_bf16 v[28:31], a[148:151], a[96:99], v[28:31]
    s_waitcnt lgkmcnt(6)
    buffer_load_dwordx4 v206, s[16:19], s52 offen offset:1024 lds
    v_mfma_f32_16x16x32_bf16 v[32:35], a[152:155], a[0:3], v[32:35]
    ds_read_b64_tr_b16 a[148:149], v197 offset:8192
    v_mfma_f32_16x16x32_bf16 v[40:43], a[152:155], a[32:35], v[40:43]
    ds_read_b64_tr_b16 a[150:151], v197 offset:12288
    v_mfma_f32_16x16x32_bf16 v[48:51], a[152:155], a[64:67], v[48:51]
    v_mfma_f32_16x16x32_bf16 v[56:59], a[152:155], a[96:99], v[56:59]
    s_waitcnt lgkmcnt(6)
    v_mfma_f32_16x16x32_bf16 v[36:39], a[156:159], a[0:3], v[36:39]
    s_xor_b32 s46, s30, 12
    ds_read_b64_tr_b16 a[152:153], v198 offset:8192
    v_mfma_f32_16x16x32_bf16 v[44:47], a[156:159], a[32:35], v[44:47]
    s_lshl_b32 s46, s46, 10
    ds_read_b64_tr_b16 a[154:155], v198 offset:12288
    v_mfma_f32_16x16x32_bf16 v[52:55], a[156:159], a[64:67], v[52:55]
    buffer_load_dwordx4 a[16:19], v221, s[4:7], s46 offen sc1
    v_mfma_f32_16x16x32_bf16 v[60:63], a[156:159], a[96:99], v[60:63]
    s_waitcnt lgkmcnt(6)
    v_mfma_f32_16x16x32_bf16 v[64:67], a[160:163], a[0:3], v[64:67]
    ds_read_b64_tr_b16 a[156:157], v199 offset:8192
    v_mfma_f32_16x16x32_bf16 v[72:75], a[160:163], a[32:35], v[72:75]
    s_add_u32 s46, s46, 131072
    ds_read_b64_tr_b16 a[158:159], v199 offset:12288
    v_mfma_f32_16x16x32_bf16 v[80:83], a[160:163], a[64:67], v[80:83]
    buffer_load_dwordx4 a[48:51], v221, s[4:7], s46 offen sc1
    v_mfma_f32_16x16x32_bf16 v[88:91], a[160:163], a[96:99], v[88:91]
    s_waitcnt lgkmcnt(6)
    v_mfma_f32_16x16x32_bf16 v[68:71], a[164:167], a[0:3], v[68:71]
    ds_read_b64_tr_b16 a[160:161], v200 offset:8192
    v_mfma_f32_16x16x32_bf16 v[76:79], a[164:167], a[32:35], v[76:79]
    ds_read_b64_tr_b16 a[162:163], v200 offset:12288
    v_mfma_f32_16x16x32_bf16 v[84:87], a[164:167], a[64:67], v[84:87]
    s_add_u32 s46, s46, 131072
    v_mfma_f32_16x16x32_bf16 v[92:95], a[164:167], a[96:99], v[92:95]
    s_waitcnt lgkmcnt(6)
    buffer_load_dwordx4 a[80:83], v221, s[4:7], s46 offen sc1
    v_mfma_f32_16x16x32_bf16 v[96:99], a[168:171], a[0:3], v[96:99]
    ds_read_b64_tr_b16 a[164:165], v201 offset:8192
    v_mfma_f32_16x16x32_bf16 v[104:107], a[168:171], a[32:35], v[104:107]
    ds_read_b64_tr_b16 a[166:167], v201 offset:12288
    v_mfma_f32_16x16x32_bf16 v[112:115], a[168:171], a[64:67], v[112:115]
    s_add_u32 s46, s46, 131072
    v_mfma_f32_16x16x32_bf16 v[120:123], a[168:171], a[96:99], v[120:123]
    s_waitcnt lgkmcnt(6)
    buffer_load_dwordx4 a[112:115], v221, s[4:7], s46 offen sc1
    v_mfma_f32_16x16x32_bf16 v[100:103], a[172:175], a[0:3], v[100:103]
    ds_read_b64_tr_b16 a[168:169], v202 offset:8192
    v_mfma_f32_16x16x32_bf16 v[108:111], a[172:175], a[32:35], v[108:111]
    ds_read_b64_tr_b16 a[170:171], v202 offset:12288
    v_mfma_f32_16x16x32_bf16 v[116:119], a[172:175], a[64:67], v[116:119]
    v_mfma_f32_16x16x32_bf16 v[124:127], a[172:175], a[96:99], v[124:127]
    s_waitcnt lgkmcnt(6)
    ds_read_b64_tr_b16 a[172:173], v203 offset:8192
    ds_read_b64_tr_b16 a[174:175], v203 offset:12288
    s_waitcnt vmcnt(18)
    s_barrier
    v_mfma_f32_16x16x32_bf16 v[0:3], a[144:147], a[4:7], v[0:3]
    s_xor_b32 s52, s30, 28
    v_mfma_f32_16x16x32_bf16 v[8:11], a[144:147], a[36:39], v[8:11]
    s_lshl_b32 s52, s52, 15
    v_mfma_f32_16x16x32_bf16 v[16:19], a[144:147], a[68:71], v[16:19]
    s_add_u32 m0, s53, 49152
    v_mfma_f32_16x16x32_bf16 v[24:27], a[144:147], a[100:103], v[24:27]
    s_waitcnt lgkmcnt(6)
    buffer_load_dwordx4 v205, s[16:19], s52 offen lds
    v_mfma_f32_16x16x32_bf16 v[4:7], a[148:151], a[4:7], v[4:7]
    ds_read_b64_tr_b16 a[144:145], v196 offset:16384
    v_mfma_f32_16x16x32_bf16 v[12:15], a[148:151], a[36:39], v[12:15]
    ds_read_b64_tr_b16 a[146:147], v196 offset:20480
    v_mfma_f32_16x16x32_bf16 v[20:23], a[148:151], a[68:71], v[20:23]
    v_mfma_f32_16x16x32_bf16 v[28:31], a[148:151], a[100:103], v[28:31]
    s_waitcnt lgkmcnt(6)
    buffer_load_dwordx4 v206, s[16:19], s52 offen offset:1024 lds
    v_mfma_f32_16x16x32_bf16 v[32:35], a[152:155], a[4:7], v[32:35]
    ds_read_b64_tr_b16 a[148:149], v197 offset:16384
    v_mfma_f32_16x16x32_bf16 v[40:43], a[152:155], a[36:39], v[40:43]
    ds_read_b64_tr_b16 a[150:151], v197 offset:20480
    v_mfma_f32_16x16x32_bf16 v[48:51], a[152:155], a[68:71], v[48:51]
    v_mfma_f32_16x16x32_bf16 v[56:59], a[152:155], a[100:103], v[56:59]
    s_waitcnt lgkmcnt(6)
    v_mfma_f32_16x16x32_bf16 v[36:39], a[156:159], a[4:7], v[36:39]
    s_xor_b32 s46, s30, 20
    ds_read_b64_tr_b16 a[152:153], v198 offset:16384
    v_mfma_f32_16x16x32_bf16 v[44:47], a[156:159], a[36:39], v[44:47]
    s_lshl_b32 s46, s46, 10
    ds_read_b64_tr_b16 a[154:155], v198 offset:20480
    v_mfma_f32_16x16x32_bf16 v[52:55], a[156:159], a[68:71], v[52:55]
    buffer_load_dwordx4 a[20:23], v221, s[4:7], s46 offen sc1
    v_mfma_f32_16x16x32_bf16 v[60:63], a[156:159], a[100:103], v[60:63]
    s_waitcnt lgkmcnt(6)
    v_mfma_f32_16x16x32_bf16 v[64:67], a[160:163], a[4:7], v[64:67]
    ds_read_b64_tr_b16 a[156:157], v199 offset:16384
    v_mfma_f32_16x16x32_bf16 v[72:75], a[160:163], a[36:39], v[72:75]
    s_add_u32 s46, s46, 131072
    ds_read_b64_tr_b16 a[158:159], v199 offset:20480
    v_mfma_f32_16x16x32_bf16 v[80:83], a[160:163], a[68:71], v[80:83]
    buffer_load_dwordx4 a[52:55], v221, s[4:7], s46 offen sc1
    v_mfma_f32_16x16x32_bf16 v[88:91], a[160:163], a[100:103], v[88:91]
    s_waitcnt lgkmcnt(6)
    v_mfma_f32_16x16x32_bf16 v[68:71], a[164:167], a[4:7], v[68:71]
    ds_read_b64_tr_b16 a[160:161], v200 offset:16384
    v_mfma_f32_16x16x32_bf16 v[76:79], a[164:167], a[36:39], v[76:79]
    ds_read_b64_tr_b16 a[162:163], v200 offset:20480
    v_mfma_f32_16x16x32_bf16 v[84:87], a[164:167], a[68:71], v[84:87]
    s_add_u32 s46, s46, 131072
    v_mfma_f32_16x16x32_bf16 v[92:95], a[164:167], a[100:103], v[92:95]
    s_waitcnt lgkmcnt(6)
    buffer_load_dwordx4 a[84:87], v221, s[4:7], s46 offen sc1
    v_mfma_f32_16x16x32_bf16 v[96:99], a[168:171], a[4:7], v[96:99]
    ds_read_b64_tr_b16 a[164:165], v201 offset:16384
    v_mfma_f32_16x16x32_bf16 v[104:107], a[168:171], a[36:39], v[104:107]
    ds_read_b64_tr_b16 a[166:167], v201 offset:20480
    v_mfma_f32_16x16x32_bf16 v[112:115], a[168:171], a[68:71], v[112:115]
    s_add_u32 s46, s46, 131072
    v_mfma_f32_16x16x32_bf16 v[120:123], a[168:171], a[100:103], v[120:123]
    s_waitcnt lgkmcnt(6)
    buffer_load_dwordx4 a[116:119], v221, s[4:7], s46 offen sc1
    v_mfma_f32_16x16x32_bf16 v[100:103], a[172:175], a[4:7], v[100:103]
    ds_read_b64_tr_b16 a[168:169], v202 offset:16384
    v_mfma_f32_16x16x32_bf16 v[108:111], a[172:175], a[36:39], v[108:111]
    ds_read_b64_tr_b16 a[170:171], v202 offset:20480
    v_mfma_f32_16x16x32_bf16 v[116:119], a[172:175], a[68:71], v[116:119]
    v_mfma_f32_16x16x32_bf16 v[124:127], a[172:175], a[100:103], v[124:127]
    s_waitcnt lgkmcnt(6)
    ds_read_b64_tr_b16 a[172:173], v203 offset:16384
    ds_read_b64_tr_b16 a[174:175], v203 offset:20480
    s_waitcnt vmcnt(12)
    buffer_store_dword v219, v218, s[12:15], s28 offen offset:32 sc1
    v_mfma_f32_16x16x32_bf16 v[0:3], a[144:147], a[8:11], v[0:3]
    s_xor_b32 s52, s30, 13
    v_mfma_f32_16x16x32_bf16 v[8:11], a[144:147], a[40:43], v[8:11]
    s_lshl_b32 s52, s52, 15
    v_mfma_f32_16x16x32_bf16 v[16:19], a[144:147], a[72:75], v[16:19]
    s_add_u32 m0, s53, 57344
    v_mfma_f32_16x16x32_bf16 v[24:27], a[144:147], a[104:107], v[24:27]
    s_waitcnt lgkmcnt(6)
    buffer_load_dwordx4 v205, s[16:19], s52 offen lds
    v_mfma_f32_16x16x32_bf16 v[4:7], a[148:151], a[8:11], v[4:7]
    ds_read_b64_tr_b16 a[144:145], v196 offset:24576
    v_mfma_f32_16x16x32_bf16 v[12:15], a[148:151], a[40:43], v[12:15]
    ds_read_b64_tr_b16 a[146:147], v196 offset:28672
    v_mfma_f32_16x16x32_bf16 v[20:23], a[148:151], a[72:75], v[20:23]
    v_mfma_f32_16x16x32_bf16 v[28:31], a[148:151], a[104:107], v[28:31]
    s_waitcnt lgkmcnt(6)
    buffer_load_dwordx4 v206, s[16:19], s52 offen offset:1024 lds
    v_mfma_f32_16x16x32_bf16 v[32:35], a[152:155], a[8:11], v[32:35]
    ds_read_b64_tr_b16 a[148:149], v197 offset:24576
    v_mfma_f32_16x16x32_bf16 v[40:43], a[152:155], a[40:43], v[40:43]
    ds_read_b64_tr_b16 a[150:151], v197 offset:28672
    v_mfma_f32_16x16x32_bf16 v[48:51], a[152:155], a[72:75], v[48:51]
    v_mfma_f32_16x16x32_bf16 v[56:59], a[152:155], a[104:107], v[56:59]
    s_waitcnt lgkmcnt(6)
    v_mfma_f32_16x16x32_bf16 v[36:39], a[156:159], a[8:11], v[36:39]
    s_xor_b32 s46, s30, 28
    ds_read_b64_tr_b16 a[152:153], v198 offset:24576
    v_mfma_f32_16x16x32_bf16 v[44:47], a[156:159], a[40:43], v[44:47]
    s_lshl_b32 s46, s46, 10
    ds_read_b64_tr_b16 a[154:155], v198 offset:28672
    v_mfma_f32_16x16x32_bf16 v[52:55], a[156:159], a[72:75], v[52:55]
    buffer_load_dwordx4 a[24:27], v221, s[4:7], s46 offen sc1
    v_mfma_f32_16x16x32_bf16 v[60:63], a[156:159], a[104:107], v[60:63]
    s_waitcnt lgkmcnt(6)
    v_mfma_f32_16x16x32_bf16 v[64:67], a[160:163], a[8:11], v[64:67]
    ds_read_b64_tr_b16 a[156:157], v199 offset:24576
    v_mfma_f32_16x16x32_bf16 v[72:75], a[160:163], a[40:43], v[72:75]
    s_add_u32 s46, s46, 131072
    ds_read_b64_tr_b16 a[158:159], v199 offset:28672
    v_mfma_f32_16x16x32_bf16 v[80:83], a[160:163], a[72:75], v[80:83]
    buffer_load_dwordx4 a[56:59], v221, s[4:7], s46 offen sc1
    v_mfma_f32_16x16x32_bf16 v[88:91], a[160:163], a[104:107], v[88:91]
    s_waitcnt lgkmcnt(6)
    v_mfma_f32_16x16x32_bf16 v[68:71], a[164:167], a[8:11], v[68:71]
    ds_read_b64_tr_b16 a[160:161], v200 offset:24576
    v_mfma_f32_16x16x32_bf16 v[76:79], a[164:167], a[40:43], v[76:79]
    ds_read_b64_tr_b16 a[162:163], v200 offset:28672
    v_mfma_f32_16x16x32_bf16 v[84:87], a[164:167], a[72:75], v[84:87]
    s_add_u32 s46, s46, 131072
    v_mfma_f32_16x16x32_bf16 v[92:95], a[164:167], a[104:107], v[92:95]
    s_waitcnt lgkmcnt(6)
    buffer_load_dwordx4 a[88:91], v221, s[4:7], s46 offen sc1
    v_mfma_f32_16x16x32_bf16 v[96:99], a[168:171], a[8:11], v[96:99]
    ds_read_b64_tr_b16 a[164:165], v201 offset:24576
    v_mfma_f32_16x16x32_bf16 v[104:107], a[168:171], a[40:43], v[104:107]
    ds_read_b64_tr_b16 a[166:167], v201 offset:28672
    v_mfma_f32_16x16x32_bf16 v[112:115], a[168:171], a[72:75], v[112:115]
    s_add_u32 s46, s46, 131072
    v_mfma_f32_16x16x32_bf16 v[120:123], a[168:171], a[104:107], v[120:123]
    s_waitcnt lgkmcnt(6)
    buffer_load_dwordx4 a[120:123], v221, s[4:7], s46 offen sc1
    v_mfma_f32_16x16x32_bf16 v[100:103], a[172:175], a[8:11], v[100:103]
    ds_read_b64_tr_b16 a[168:169], v202 offset:24576
    v_mfma_f32_16x16x32_bf16 v[108:111], a[172:175], a[40:43], v[108:111]
    ds_read_b64_tr_b16 a[170:171], v202 offset:28672
    v_mfma_f32_16x16x32_bf16 v[116:119], a[172:175], a[72:75], v[116:119]
    v_mfma_f32_16x16x32_bf16 v[124:127], a[172:175], a[104:107], v[124:127]
    s_waitcnt lgkmcnt(6)
    ds_read_b64_tr_b16 a[172:173], v203 offset:24576
    ds_read_b64_tr_b16 a[174:175], v203 offset:28672
    s_waitcnt vmcnt(17)
    s_barrier
    v_mfma_f32_16x16x32_bf16 v[0:3], a[144:147], a[12:15], v[0:3]
    s_xor_b32 s52, s30, 21
    v_mfma_f32_16x16x32_bf16 v[8:11], a[144:147], a[44:47], v[8:11]
    s_lshl_b32 s52, s52, 15
    v_mfma_f32_16x16x32_bf16 v[16:19], a[144:147], a[76:79], v[16:19]
    s_add_u32 m0, s53, 0
    v_mfma_f32_16x16x32_bf16 v[24:27], a[144:147], a[108:111], v[24:27]
    s_waitcnt lgkmcnt(6)
    buffer_load_dwordx4 v205, s[16:19], s52 offen lds
    v_mfma_f32_16x16x32_bf16 v[4:7], a[148:151], a[12:15], v[4:7]
    ds_read_b64_tr_b16 a[144:145], v196 offset:32768
    v_mfma_f32_16x16x32_bf16 v[12:15], a[148:151], a[44:47], v[12:15]
    ds_read_b64_tr_b16 a[146:147], v196 offset:36864
    v_mfma_f32_16x16x32_bf16 v[20:23], a[148:151], a[76:79], v[20:23]
    v_mfma_f32_16x16x32_bf16 v[28:31], a[148:151], a[108:111], v[28:31]
    s_waitcnt lgkmcnt(6)
    buffer_load_dwordx4 v206, s[16:19], s52 offen offset:1024 lds
    v_mfma_f32_16x16x32_bf16 v[32:35], a[152:155], a[12:15], v[32:35]
    ds_read_b64_tr_b16 a[148:149], v197 offset:32768
    v_mfma_f32_16x16x32_bf16 v[40:43], a[152:155], a[44:47], v[40:43]
    ds_read_b64_tr_b16 a[150:151], v197 offset:36864
    v_mfma_f32_16x16x32_bf16 v[48:51], a[152:155], a[76:79], v[48:51]
    v_mfma_f32_16x16x32_bf16 v[56:59], a[152:155], a[108:111], v[56:59]
    s_waitcnt lgkmcnt(6)
    v_mfma_f32_16x16x32_bf16 v[36:39], a[156:159], a[12:15], v[36:39]
    s_xor_b32 s46, s30, 13
    ds_read_b64_tr_b16 a[152:153], v198 offset:32768
    v_mfma_f32_16x16x32_bf16 v[44:47], a[156:159], a[44:47], v[44:47]
    s_lshl_b32 s46, s46, 10
    ds_read_b64_tr_b16 a[154:155], v198 offset:36864
    v_mfma_f32_16x16x32_bf16 v[52:55], a[156:159], a[76:79], v[52:55]
    buffer_load_dwordx4 a[28:31], v221, s[4:7], s46 offen sc1
    v_mfma_f32_16x16x32_bf16 v[60:63], a[156:159], a[108:111], v[60:63]
    s_waitcnt lgkmcnt(6)
    v_mfma_f32_16x16x32_bf16 v[64:67], a[160:163], a[12:15], v[64:67]
    ds_read_b64_tr_b16 a[156:157], v199 offset:32768
    v_mfma_f32_16x16x32_bf16 v[72:75], a[160:163], a[44:47], v[72:75]
    s_add_u32 s46, s46, 131072
    ds_read_b64_tr_b16 a[158:159], v199 offset:36864
    v_mfma_f32_16x16x32_bf16 v[80:83], a[160:163], a[76:79], v[80:83]
    buffer_load_dwordx4 a[60:63], v221, s[4:7], s46 offen sc1
    v_mfma_f32_16x16x32_bf16 v[88:91], a[160:163], a[108:111], v[88:91]
    s_waitcnt lgkmcnt(6)
    v_mfma_f32_16x16x32_bf16 v[68:71], a[164:167], a[12:15], v[68:71]
    ds_read_b64_tr_b16 a[160:161], v200 offset:32768
    v_mfma_f32_16x16x32_bf16 v[76:79], a[164:167], a[44:47], v[76:79]
    ds_read_b64_tr_b16 a[162:163], v200 offset:36864
    v_mfma_f32_16x16x32_bf16 v[84:87], a[164:167], a[76:79], v[84:87]
    s_add_u32 s46, s46, 131072
    v_mfma_f32_16x16x32_bf16 v[92:95], a[164:167], a[108:111], v[92:95]
    s_waitcnt lgkmcnt(6)
    buffer_load_dwordx4 a[92:95], v221, s[4:7], s46 offen sc1
    v_mfma_f32_16x16x32_bf16 v[96:99], a[168:171], a[12:15], v[96:99]
    ds_read_b64_tr_b16 a[164:165], v201 offset:32768
    v_mfma_f32_16x16x32_bf16 v[104:107], a[168:171], a[44:47], v[104:107]
    ds_read_b64_tr_b16 a[166:167], v201 offset:36864
    v_mfma_f32_16x16x32_bf16 v[112:115], a[168:171], a[76:79], v[112:115]
    s_add_u32 s46, s46, 131072
    v_mfma_f32_16x16x32_bf16 v[120:123], a[168:171], a[108:111], v[120:123]
    s_waitcnt lgkmcnt(6)
    buffer_load_dwordx4 a[124:127], v221, s[4:7], s46 offen sc1
    v_mfma_f32_16x16x32_bf16 v[100:103], a[172:175], a[12:15], v[100:103]
    ds_read_b64_tr_b16 a[168:169], v202 offset:32768
    v_mfma_f32_16x16x32_bf16 v[108:111], a[172:175], a[44:47], v[108:111]
    ds_read_b64_tr_b16 a[170:171], v202 offset:36864
    v_mfma_f32_16x16x32_bf16 v[116:119], a[172:175], a[76:79], v[116:119]
    v_mfma_f32_16x16x32_bf16 v[124:127], a[172:175], a[108:111], v[124:127]
    s_waitcnt lgkmcnt(6)
    ds_read_b64_tr_b16 a[172:173], v203 offset:32768
    ds_read_b64_tr_b16 a[174:175], v203 offset:36864
    s_waitcnt vmcnt(19)
    v_mfma_f32_16x16x32_bf16 v[0:3], a[144:147], a[16:19], v[0:3]
    v_mfma_f32_16x16x32_bf16 v[8:11], a[144:147], a[48:51], v[8:11]
    v_mfma_f32_16x16x32_bf16 v[16:19], a[144:147], a[80:83], v[16:19]
    v_mfma_f32_16x16x32_bf16 v[24:27], a[144:147], a[112:115], v[24:27]
    s_waitcnt lgkmcnt(6)
    buffer_load_dword v208, v204, s[12:15], s60 offen offset:32 sc1
    v_mfma_f32_16x16x32_bf16 v[4:7], a[148:151], a[16:19], v[4:7]
    s_xor_b32 s52, s30, 29
    ds_read_b64_tr_b16 a[144:145], v196 offset:40960
    v_mfma_f32_16x16x32_bf16 v[12:15], a[148:151], a[48:51], v[12:15]
    s_lshl_b32 s52, s52, 15
    ds_read_b64_tr_b16 a[146:147], v196 offset:45056
    v_mfma_f32_16x16x32_bf16 v[20:23], a[148:151], a[80:83], v[20:23]
    s_add_u32 m0, s53, 8192
    v_mfma_f32_16x16x32_bf16 v[28:31], a[148:151], a[112:115], v[28:31]
    s_waitcnt lgkmcnt(6)
    buffer_load_dwordx4 v205, s[16:19], s52 offen lds
    v_mfma_f32_16x16x32_bf16 v[32:35], a[152:155], a[16:19], v[32:35]
    ds_read_b64_tr_b16 a[148:149], v197 offset:40960
    v_mfma_f32_16x16x32_bf16 v[40:43], a[152:155], a[48:51], v[40:43]
    ds_read_b64_tr_b16 a[150:151], v197 offset:45056
    v_mfma_f32_16x16x32_bf16 v[48:51], a[152:155], a[80:83], v[48:51]
    v_mfma_f32_16x16x32_bf16 v[56:59], a[152:155], a[112:115], v[56:59]
    s_waitcnt lgkmcnt(6)
    buffer_load_dwordx4 v206, s[16:19], s52 offen offset:1024 lds
    v_mfma_f32_16x16x32_bf16 v[36:39], a[156:159], a[16:19], v[36:39]
    ds_read_b64_tr_b16 a[152:153], v198 offset:40960
    v_mfma_f32_16x16x32_bf16 v[44:47], a[156:159], a[48:51], v[44:47]
    s_xor_b32 s46, s30, 21
    ds_read_b64_tr_b16 a[154:155], v198 offset:45056
    v_mfma_f32_16x16x32_bf16 v[52:55], a[156:159], a[80:83], v[52:55]
    s_lshl_b32 s46, s46, 10
    v_mfma_f32_16x16x32_bf16 v[60:63], a[156:159], a[112:115], v[60:63]
    s_waitcnt lgkmcnt(6)
    buffer_load_dwordx4 a[0:3], v221, s[4:7], s46 offen sc1
    v_mfma_f32_16x16x32_bf16 v[64:67], a[160:163], a[16:19], v[64:67]
    ds_read_b64_tr_b16 a[156:157], v199 offset:40960
    v_mfma_f32_16x16x32_bf16 v[72:75], a[160:163], a[48:51], v[72:75]
    ds_read_b64_tr_b16 a[158:159], v199 offset:45056
    v_mfma_f32_16x16x32_bf16 v[80:83], a[160:163], a[80:83], v[80:83]
    s_add_u32 s46, s46, 131072
    v_mfma_f32_16x16x32_bf16 v[88:91], a[160:163], a[112:115], v[88:91]
    s_waitcnt lgkmcnt(6)
    buffer_load_dwordx4 a[32:35], v221, s[4:7], s46 offen sc1
    v_mfma_f32_16x16x32_bf16 v[68:71], a[164:167], a[16:19], v[68:71]
    ds_read_b64_tr_b16 a[160:161], v200 offset:40960
    v_mfma_f32_16x16x32_bf16 v[76:79], a[164:167], a[48:51], v[76:79]
    ds_read_b64_tr_b16 a[162:163], v200 offset:45056
    v_mfma_f32_16x16x32_bf16 v[84:87], a[164:167], a[80:83], v[84:87]
    s_add_u32 s46, s46, 131072
    v_mfma_f32_16x16x32_bf16 v[92:95], a[164:167], a[112:115], v[92:95]
    s_waitcnt lgkmcnt(6)
    buffer_load_dwordx4 a[64:67], v221, s[4:7], s46 offen sc1
    v_mfma_f32_16x16x32_bf16 v[96:99], a[168:171], a[16:19], v[96:99]
    ds_read_b64_tr_b16 a[164:165], v201 offset:40960
    v_mfma_f32_16x16x32_bf16 v[104:107], a[168:171], a[48:51], v[104:107]
    ds_read_b64_tr_b16 a[166:167], v201 offset:45056
    v_mfma_f32_16x16x32_bf16 v[112:115], a[168:171], a[80:83], v[112:115]
    s_add_u32 s46, s46, 131072
    v_mfma_f32_16x16x32_bf16 v[120:123], a[168:171], a[112:115], v[120:123]
    s_waitcnt lgkmcnt(6)
    buffer_load_dwordx4 a[96:99], v221, s[4:7], s46 offen sc1
    v_mfma_f32_16x16x32_bf16 v[100:103], a[172:175], a[16:19], v[100:103]
    ds_read_b64_tr_b16 a[168:169], v202 offset:40960
    v_mfma_f32_16x16x32_bf16 v[108:111], a[172:175], a[48:51], v[108:111]
    ds_read_b64_tr_b16 a[170:171], v202 offset:45056
    v_mfma_f32_16x16x32_bf16 v[116:119], a[172:175], a[80:83], v[116:119]
    v_mfma_f32_16x16x32_bf16 v[124:127], a[172:175], a[112:115], v[124:127]
    s_waitcnt lgkmcnt(6)
    ds_read_b64_tr_b16 a[172:173], v203 offset:40960
    ds_read_b64_tr_b16 a[174:175], v203 offset:45056
    s_waitcnt vmcnt(17)
    s_barrier
    buffer_store_dword v219, v218, s[12:15], s28 offen offset:48 sc1
    v_mfma_f32_16x16x32_bf16 v[0:3], a[144:147], a[20:23], v[0:3]
    s_xor_b32 s52, s30, 14
    v_mfma_f32_16x16x32_bf16 v[8:11], a[144:147], a[52:55], v[8:11]
    s_lshl_b32 s52, s52, 15
    v_mfma_f32_16x16x32_bf16 v[16:19], a[144:147], a[84:87], v[16:19]
    s_add_u32 m0, s53, 16384
    v_mfma_f32_16x16x32_bf16 v[24:27], a[144:147], a[116:119], v[24:27]
    s_waitcnt lgkmcnt(6)
    buffer_load_dwordx4 v205, s[16:19], s52 offen lds
    v_mfma_f32_16x16x32_bf16 v[4:7], a[148:151], a[20:23], v[4:7]
    ds_read_b64_tr_b16 a[144:145], v196 offset:49152
    v_mfma_f32_16x16x32_bf16 v[12:15], a[148:151], a[52:55], v[12:15]
    ds_read_b64_tr_b16 a[146:147], v196 offset:53248
    v_mfma_f32_16x16x32_bf16 v[20:23], a[148:151], a[84:87], v[20:23]
    v_mfma_f32_16x16x32_bf16 v[28:31], a[148:151], a[116:119], v[28:31]
    s_waitcnt lgkmcnt(6)
    buffer_load_dwordx4 v206, s[16:19], s52 offen offset:1024 lds
    v_mfma_f32_16x16x32_bf16 v[32:35], a[152:155], a[20:23], v[32:35]
    ds_read_b64_tr_b16 a[148:149], v197 offset:49152
    v_mfma_f32_16x16x32_bf16 v[40:43], a[152:155], a[52:55], v[40:43]
    ds_read_b64_tr_b16 a[150:151], v197 offset:53248
    v_mfma_f32_16x16x32_bf16 v[48:51], a[152:155], a[84:87], v[48:51]
    v_mfma_f32_16x16x32_bf16 v[56:59], a[152:155], a[116:119], v[56:59]
    s_waitcnt lgkmcnt(6)
    v_mfma_f32_16x16x32_bf16 v[36:39], a[156:159], a[20:23], v[36:39]
    s_xor_b32 s46, s30, 29
    ds_read_b64_tr_b16 a[152:153], v198 offset:49152
    v_mfma_f32_16x16x32_bf16 v[44:47], a[156:159], a[52:55], v[44:47]
    s_lshl_b32 s46, s46, 10
    ds_read_b64_tr_b16 a[154:155], v198 offset:53248
    v_mfma_f32_16x16x32_bf16 v[52:55], a[156:159], a[84:87], v[52:55]
    buffer_load_dwordx4 a[4:7], v221, s[4:7], s46 offen sc1
    v_mfma_f32_16x16x32_bf16 v[60:63], a[156:159], a[116:119], v[60:63]
    s_waitcnt lgkmcnt(6)
    v_mfma_f32_16x16x32_bf16 v[64:67], a[160:163], a[20:23], v[64:67]
    ds_read_b64_tr_b16 a[156:157], v199 offset:49152
    v_mfma_f32_16x16x32_bf16 v[72:75], a[160:163], a[52:55], v[72:75]
    s_add_u32 s46, s46, 131072
    ds_read_b64_tr_b16 a[158:159], v199 offset:53248
    v_mfma_f32_16x16x32_bf16 v[80:83], a[160:163], a[84:87], v[80:83]
    buffer_load_dwordx4 a[36:39], v221, s[4:7], s46 offen sc1
    v_mfma_f32_16x16x32_bf16 v[88:91], a[160:163], a[116:119], v[88:91]
    s_waitcnt lgkmcnt(6)
    v_mfma_f32_16x16x32_bf16 v[68:71], a[164:167], a[20:23], v[68:71]
    ds_read_b64_tr_b16 a[160:161], v200 offset:49152
    v_mfma_f32_16x16x32_bf16 v[76:79], a[164:167], a[52:55], v[76:79]
    ds_read_b64_tr_b16 a[162:163], v200 offset:53248
    v_mfma_f32_16x16x32_bf16 v[84:87], a[164:167], a[84:87], v[84:87]
    s_add_u32 s46, s46, 131072
    v_mfma_f32_16x16x32_bf16 v[92:95], a[164:167], a[116:119], v[92:95]
    s_waitcnt lgkmcnt(6)
    buffer_load_dwordx4 a[68:71], v221, s[4:7], s46 offen sc1
    v_mfma_f32_16x16x32_bf16 v[96:99], a[168:171], a[20:23], v[96:99]
    ds_read_b64_tr_b16 a[164:165], v201 offset:49152
    v_mfma_f32_16x16x32_bf16 v[104:107], a[168:171], a[52:55], v[104:107]
    ds_read_b64_tr_b16 a[166:167], v201 offset:53248
    v_mfma_f32_16x16x32_bf16 v[112:115], a[168:171], a[84:87], v[112:115]
    s_add_u32 s46, s46, 131072
    v_mfma_f32_16x16x32_bf16 v[120:123], a[168:171], a[116:119], v[120:123]
    s_waitcnt lgkmcnt(6)
    buffer_load_dwordx4 a[100:103], v221, s[4:7], s46 offen sc1
    v_mfma_f32_16x16x32_bf16 v[100:103], a[172:175], a[20:23], v[100:103]
    ds_read_b64_tr_b16 a[168:169], v202 offset:49152
    v_mfma_f32_16x16x32_bf16 v[108:111], a[172:175], a[52:55], v[108:111]
    ds_read_b64_tr_b16 a[170:171], v202 offset:53248
    v_mfma_f32_16x16x32_bf16 v[116:119], a[172:175], a[84:87], v[116:119]
    v_mfma_f32_16x16x32_bf16 v[124:127], a[172:175], a[116:119], v[124:127]
    s_waitcnt lgkmcnt(6)
    ds_read_b64_tr_b16 a[172:173], v203 offset:49152
    ds_read_b64_tr_b16 a[174:175], v203 offset:53248
    s_waitcnt vmcnt(13)
    v_cmp_ne_u32 vcc, s54, v208
    s_cmp_eq_u32 vcc_lo, 0
    s_cbranch_scc0 K1_SPIN3
K1_CHK3_OK:
    v_mfma_f32_16x16x32_bf16 v[0:3], a[144:147], a[24:27], v[0:3]
    s_xor_b32 s52, s30, 22
    v_mfma_f32_16x16x32_bf16 v[8:11], a[144:147], a[56:59], v[8:11]
    s_lshl_b32 s52, s52, 15
    v_mfma_f32_16x16x32_bf16 v[16:19], a[144:147], a[88:91], v[16:19]
    s_add_u32 m0, s53, 24576
    v_mfma_f32_16x16x32_bf16 v[24:27], a[144:147], a[120:123], v[24:27]
    s_waitcnt lgkmcnt(6)
    buffer_load_dwordx4 v205, s[16:19], s52 offen lds
    v_mfma_f32_16x16x32_bf16 v[4:7], a[148:151], a[24:27], v[4:7]
    ds_read_b64_tr_b16 a[144:145], v196 offset:57344
    v_mfma_f32_16x16x32_bf16 v[12:15], a[148:151], a[56:59], v[12:15]
    ds_read_b64_tr_b16 a[146:147], v196 offset:61440
    v_mfma_f32_16x16x32_bf16 v[20:23], a[148:151], a[88:91], v[20:23]
    v_mfma_f32_16x16x32_bf16 v[28:31], a[148:151], a[120:123], v[28:31]
    s_waitcnt lgkmcnt(6)
    buffer_load_dwordx4 v206, s[16:19], s52 offen offset:1024 lds
    v_mfma_f32_16x16x32_bf16 v[32:35], a[152:155], a[24:27], v[32:35]
    ds_read_b64_tr_b16 a[148:149], v197 offset:57344
    v_mfma_f32_16x16x32_bf16 v[40:43], a[152:155], a[56:59], v[40:43]
    ds_read_b64_tr_b16 a[150:151], v197 offset:61440
    v_mfma_f32_16x16x32_bf16 v[48:51], a[152:155], a[88:91], v[48:51]
    v_mfma_f32_16x16x32_bf16 v[56:59], a[152:155], a[120:123], v[56:59]
    s_waitcnt lgkmcnt(6)
    v_mfma_f32_16x16x32_bf16 v[36:39], a[156:159], a[24:27], v[36:39]
    s_xor_b32 s46, s30, 14
    ds_read_b64_tr_b16 a[152:153], v198 offset:57344
    v_mfma_f32_16x16x32_bf16 v[44:47], a[156:159], a[56:59], v[44:47]
    s_lshl_b32 s46, s46, 10
    ds_read_b64_tr_b16 a[154:155], v198 offset:61440
    v_mfma_f32_16x16x32_bf16 v[52:55], a[156:159], a[88:91], v[52:55]
    buffer_load_dwordx4 a[8:11], v221, s[4:7], s46 offen sc1
    v_mfma_f32_16x16x32_bf16 v[60:63], a[156:159], a[120:123], v[60:63]
    s_waitcnt lgkmcnt(6)
    v_mfma_f32_16x16x32_bf16 v[64:67], a[160:163], a[24:27], v[64:67]
    ds_read_b64_tr_b16 a[156:157], v199 offset:57344
    v_mfma_f32_16x16x32_bf16 v[72:75], a[160:163], a[56:59], v[72:75]
    s_add_u32 s46, s46, 131072
    ds_read_b64_tr_b16 a[158:159], v199 offset:61440
    v_mfma_f32_16x16x32_bf16 v[80:83], a[160:163], a[88:91], v[80:83]
    buffer_load_dwordx4 a[40:43], v221, s[4:7], s46 offen sc1
    v_mfma_f32_16x16x32_bf16 v[88:91], a[160:163], a[120:123], v[88:91]
    s_waitcnt lgkmcnt(6)
    v_mfma_f32_16x16x32_bf16 v[68:71], a[164:167], a[24:27], v[68:71]
    ds_read_b64_tr_b16 a[160:161], v200 offset:57344
    v_mfma_f32_16x16x32_bf16 v[76:79], a[164:167], a[56:59], v[76:79]
    ds_read_b64_tr_b16 a[162:163], v200 offset:61440
    v_mfma_f32_16x16x32_bf16 v[84:87], a[164:167], a[88:91], v[84:87]
    s_add_u32 s46, s46, 131072
    v_mfma_f32_16x16x32_bf16 v[92:95], a[164:167], a[120:123], v[92:95]
    s_waitcnt lgkmcnt(6)
    buffer_load_dwordx4 a[72:75], v221, s[4:7], s46 offen sc1
    v_mfma_f32_16x16x32_bf16 v[96:99], a[168:171], a[24:27], v[96:99]
    ds_read_b64_tr_b16 a[164:165], v201 offset:57344
    v_mfma_f32_16x16x32_bf16 v[104:107], a[168:171], a[56:59], v[104:107]
    ds_read_b64_tr_b16 a[166:167], v201 offset:61440
    v_mfma_f32_16x16x32_bf16 v[112:115], a[168:171], a[88:91], v[112:115]
    s_add_u32 s46, s46, 131072
    v_mfma_f32_16x16x32_bf16 v[120:123], a[168:171], a[120:123], v[120:123]
    s_waitcnt lgkmcnt(6)
    buffer_load_dwordx4 a[104:107], v221, s[4:7], s46 offen sc1
    v_mfma_f32_16x16x32_bf16 v[100:103], a[172:175], a[24:27], v[100:103]
    ds_read_b64_tr_b16 a[168:169], v202 offset:57344
    v_mfma_f32_16x16x32_bf16 v[108:111], a[172:175], a[56:59], v[108:111]
    ds_read_b64_tr_b16 a[170:171], v202 offset:61440
    v_mfma_f32_16x16x32_bf16 v[116:119], a[172:175], a[88:91], v[116:119]
    v_mfma_f32_16x16x32_bf16 v[124:127], a[172:175], a[120:123], v[124:127]
    s_waitcnt lgkmcnt(6)
    ds_read_b64_tr_b16 a[172:173], v203 offset:57344
    ds_read_b64_tr_b16 a[174:175], v203 offset:61440
    s_waitcnt vmcnt(17)
    s_barrier
    v_mfma_f32_16x16x32_bf16 v[0:3], a[144:147], a[28:31], v[0:3]
    s_xor_b32 s52, s30, 30
    v_mfma_f32_16x16x32_bf16 v[8:11], a[144:147], a[60:63], v[8:11]
    s_lshl_b32 s52, s52, 15
    v_mfma_f32_16x16x32_bf16 v[16:19], a[144:147], a[92:95], v[16:19]
    s_add_u32 m0, s53, 32768
    v_mfma_f32_16x16x32_bf16 v[24:27], a[144:147], a[124:127], v[24:27]
    s_waitcnt lgkmcnt(6)
    buffer_load_dwordx4 v205, s[16:19], s52 offen lds
    v_mfma_f32_16x16x32_bf16 v[4:7], a[148:151], a[28:31], v[4:7]
    ds_read_b64_tr_b16 a[176:177], v196 offset:0
    v_mfma_f32_16x16x32_bf16 v[12:15], a[148:151], a[60:63], v[12:15]
    ds_read_b64_tr_b16 a[178:179], v196 offset:4096
    v_mfma_f32_16x16x32_bf16 v[20:23], a[148:151], a[92:95], v[20:23]
    v_mfma_f32_16x16x32_bf16 v[28:31], a[148:151], a[124:127], v[28:31]
    s_waitcnt lgkmcnt(6)
    buffer_load_dwordx4 v206, s[16:19], s52 offen offset:1024 lds
    v_mfma_f32_16x16x32_bf16 v[32:35], a[152:155], a[28:31], v[32:35]
    ds_read_b64_tr_b16 a[180:181], v197 offset:0
    v_mfma_f32_16x16x32_bf16 v[40:43], a[152:155], a[60:63], v[40:43]
    ds_read_b64_tr_b16 a[182:183], v197 offset:4096
    v_mfma_f32_16x16x32_bf16 v[48:51], a[152:155], a[92:95], v[48:51]
    v_mfma_f32_16x16x32_bf16 v[56:59], a[152:155], a[124:127], v[56:59]
    s_waitcnt lgkmcnt(6)
    v_mfma_f32_16x16x32_bf16 v[36:39], a[156:159], a[28:31], v[36:39]
    s_xor_b32 s46, s30, 22
    ds_read_b64_tr_b16 a[152:153], v198 offset:0
    v_mfma_f32_16x16x32_bf16 v[44:47], a[156:159], a[60:63], v[44:47]
    s_lshl_b32 s46, s46, 10
    ds_read_b64_tr_b16 a[154:155], v198 offset:4096
    v_mfma_f32_16x16x32_bf16 v[52:55], a[156:159], a[92:95], v[52:55]
    buffer_load_dwordx4 a[12:15], v221, s[4:7], s46 offen sc1
    v_mfma_f32_16x16x32_bf16 v[60:63], a[156:159], a[124:127], v[60:63]
    s_waitcnt lgkmcnt(6)
    v_mfma_f32_16x16x32_bf16 v[64:67], a[160:163], a[28:31], v[64:67]
    ds_read_b64_tr_b16 a[156:157], v199 offset:0
    v_mfma_f32_16x16x32_bf16 v[72:75], a[160:163], a[60:63], v[72:75]
    s_add_u32 s46, s46, 131072
    ds_read_b64_tr_b16 a[158:159], v199 offset:4096
    v_mfma_f32_16x16x32_bf16 v[80:83], a[160:163], a[92:95], v[80:83]
    buffer_load_dwordx4 a[44:47], v221, s[4:7], s46 offen sc1
    v_mfma_f32_16x16x32_bf16 v[88:91], a[160:163], a[124:127], v[88:91]
    s_waitcnt lgkmcnt(6)
    v_mfma_f32_16x16x32_bf16 v[68:71], a[164:167], a[28:31], v[68:71]
    ds_read_b64_tr_b16 a[160:161], v200 offset:0
    v_mfma_f32_16x16x32_bf16 v[76:79], a[164:167], a[60:63], v[76:79]
    ds_read_b64_tr_b16 a[162:163], v200 offset:4096
    v_mfma_f32_16x16x32_bf16 v[84:87], a[164:167], a[92:95], v[84:87]
    s_add_u32 s46, s46, 131072
    v_mfma_f32_16x16x32_bf16 v[92:95], a[164:167], a[124:127], v[92:95]
    s_waitcnt lgkmcnt(6)
    buffer_load_dwordx4 a[76:79], v221, s[4:7], s46 offen sc1
    v_mfma_f32_16x16x32_bf16 v[96:99], a[168:171], a[28:31], v[96:99]
    ds_read_b64_tr_b16 a[164:165], v201 offset:0
    v_mfma_f32_16x16x32_bf16 v[104:107], a[168:171], a[60:63], v[104:107]
    ds_read_b64_tr_b16 a[166:167], v201 offset:4096
    v_mfma_f32_16x16x32_bf16 v[112:115], a[168:171], a[92:95], v[112:115]
    s_add_u32 s46, s46, 131072
    v_mfma_f32_16x16x32_bf16 v[120:123], a[168:171], a[124:127], v[120:123]
    s_waitcnt lgkmcnt(6)
    buffer_load_dwordx4 a[108:111], v221, s[4:7], s46 offen sc1
    v_mfma_f32_16x16x32_bf16 v[100:103], a[172:175], a[28:31], v[100:103]
    ds_read_b64_tr_b16 a[168:169], v202 offset:0
    v_mfma_f32_16x16x32_bf16 v[108:111], a[172:175], a[60:63], v[108:111]
    ds_read_b64_tr_b16 a[170:171], v202 offset:4096
    v_mfma_f32_16x16x32_bf16 v[116:119], a[172:175], a[92:95], v[116:119]
    v_mfma_f32_16x16x32_bf16 v[124:127], a[172:175], a[124:127], v[124:127]
    s_waitcnt lgkmcnt(6)
    ds_read_b64_tr_b16 a[172:173], v203 offset:0
    ds_read_b64_tr_b16 a[174:175], v203 offset:4096
    s_waitcnt vmcnt(19)
    v_mfma_f32_16x16x32_bf16 v[32:35], a[152:155], a[0:3], v[32:35]
    s_xor_b32 s52, s30, 15
    ds_read_b64_tr_b16 a[184:185], v196 offset:8192
    v_mfma_f32_16x16x32_bf16 v[40:43], a[152:155], a[32:35], v[40:43]
    s_lshl_b32 s52, s52, 15
    ds_read_b64_tr_b16 a[186:187], v196 offset:12288
    v_mfma_f32_16x16x32_bf16 v[48:51], a[152:155], a[64:67], v[48:51]
    s_add_u32 m0, s53, 40960
    ds_read_b64_tr_b16 a[188:189], v197 offset:8192
    v_mfma_f32_16x16x32_bf16 v[56:59], a[152:155], a[96:99], v[56:59]
    s_waitcnt lgkmcnt(6)
    ds_read_b64_tr_b16 a[190:191], v197 offset:12288
    buffer_load_dwordx4 v205, s[16:19], s52 offen lds
    v_mfma_f32_16x16x32_bf16 v[36:39], a[156:159], a[0:3], v[36:39]
    ds_read_b64_tr_b16 a[152:153], v198 offset:8192
    v_mfma_f32_16x16x32_bf16 v[44:47], a[156:159], a[32:35], v[44:47]
    ds_read_b64_tr_b16 a[154:155], v198 offset:12288
    v_mfma_f32_16x16x32_bf16 v[52:55], a[156:159], a[64:67], v[52:55]
    buffer_load_dwordx4 v206, s[16:19], s52 offen offset:1024 lds
    v_mfma_f32_16x16x32_bf16 v[60:63], a[156:159], a[96:99], v[60:63]
    s_waitcnt lgkmcnt(6)
    v_mfma_f32_16x16x32_bf16 v[64:67], a[160:163], a[0:3], v[64:67]
    s_xor_b32 s46, s30, 30
    ds_read_b64_tr_b16 a[156:157], v199 offset:8192
    v_mfma_f32_16x16x32_bf16 v[72:75], a[160:163], a[32:35], v[72:75]
    s_lshl_b32 s46, s46, 10
    ds_read_b64_tr_b16 a[158:159], v199 offset:12288
    v_mfma_f32_16x16x32_bf16 v[80:83], a[160:163], a[64:67], v[80:83]
    buffer_load_dwordx4 a[16:19], v221, s[4:7], s46 offen sc1
    v_mfma_f32_16x16x32_bf16 v[88:91], a[160:163], a[96:99], v[88:91]
    s_waitcnt lgkmcnt(6)
    v_mfma_f32_16x16x32_bf16 v[68:71], a[164:167], a[0:3], v[68:71]
    ds_read_b64_tr_b16 a[160:161], v200 offset:8192
    v_mfma_f32_16x16x32_bf16 v[76:79], a[164:167], a[32:35], v[76:79]
    s_add_u32 s46, s46, 131072
    ds_read_b64_tr_b16 a[162:163], v200 offset:12288
    v_mfma_f32_16x16x32_bf16 v[84:87], a[164:167], a[64:67], v[84:87]
    buffer_load_dwordx4 a[48:51], v221, s[4:7], s46 offen sc1
    v_mfma_f32_16x16x32_bf16 v[92:95], a[164:167], a[96:99], v[92:95]
    s_waitcnt lgkmcnt(6)
    v_mfma_f32_16x16x32_bf16 v[96:99], a[168:171], a[0:3], v[96:99]
    ds_read_b64_tr_b16 a[164:165], v201 offset:8192
    v_mfma_f32_16x16x32_bf16 v[104:107], a[168:171], a[32:35], v[104:107]
    s_add_u32 s46, s46, 131072
    ds_read_b64_tr_b16 a[166:167], v201 offset:12288
    v_mfma_f32_16x16x32_bf16 v[112:115], a[168:171], a[64:67], v[112:115]
    buffer_load_dwordx4 a[80:83], v221, s[4:7], s46 offen sc1
    v_mfma_f32_16x16x32_bf16 v[120:123], a[168:171], a[96:99], v[120:123]
    s_waitcnt lgkmcnt(6)
    v_mfma_f32_16x16x32_bf16 v[100:103], a[172:175], a[0:3], v[100:103]
    ds_read_b64_tr_b16 a[168:169], v202 offset:8192
    v_mfma_f32_16x16x32_bf16 v[108:111], a[172:175], a[32:35], v[108:111]
    s_add_u32 s46, s46, 131072
    ds_read_b64_tr_b16 a[170:171], v202 offset:12288
    v_mfma_f32_16x16x32_bf16 v[116:119], a[172:175], a[64:67], v[116:119]
    buffer_load_dwordx4 a[112:115], v221, s[4:7], s46 offen sc1
    v_mfma_f32_16x16x32_bf16 v[124:127], a[172:175], a[96:99], v[124:127]
    s_waitcnt lgkmcnt(6)
    ds_read_b64_tr_b16 a[172:173], v203 offset:8192
    ds_read_b64_tr_b16 a[174:175], v203 offset:12288
    s_waitcnt vmcnt(16)
    s_barrier
    v_mfma_f32_16x16x32_bf16 v[32:35], a[152:155], a[4:7], v[32:35]
    s_xor_b32 s52, s30, 23
    ds_read_b64_tr_b16 a[192:193], v196 offset:16384
    v_mfma_f32_16x16x32_bf16 v[40:43], a[152:155], a[36:39], v[40:43]
    s_lshl_b32 s52, s52, 15
    ds_read_b64_tr_b16 a[194:195], v196 offset:20480
    v_mfma_f32_16x16x32_bf16 v[48:51], a[152:155], a[68:71], v[48:51]
    s_add_u32 m0, s53, 49152
    ds_read_b64_tr_b16 a[196:197], v197 offset:16384
    v_mfma_f32_16x16x32_bf16 v[56:59], a[152:155], a[100:103], v[56:59]
    s_waitcnt lgkmcnt(6)
    ds_read_b64_tr_b16 a[198:199], v197 offset:20480
    buffer_load_dwordx4 v205, s[16:19], s52 offen lds
    v_mfma_f32_16x16x32_bf16 v[36:39], a[156:159], a[4:7], v[36:39]
    ds_read_b64_tr_b16 a[152:153], v198 offset:16384
    v_mfma_f32_16x16x32_bf16 v[44:47], a[156:159], a[36:39], v[44:47]
    ds_read_b64_tr_b16 a[154:155], v198 offset:20480
    v_mfma_f32_16x16x32_bf16 v[52:55], a[156:159], a[68:71], v[52:55]
    buffer_load_dwordx4 v206, s[16:19], s52 offen offset:1024 lds
    v_mfma_f32_16x16x32_bf16 v[60:63], a[156:159], a[100:103], v[60:63]
    s_waitcnt lgkmcnt(6)
    v_mfma_f32_16x16x32_bf16 v[64:67], a[160:163], a[4:7], v[64:67]
    s_xor_b32 s46, s30, 15
    ds_read_b64_tr_b16 a[156:157], v199 offset:16384
    v_mfma_f32_16x16x32_bf16 v[72:75], a[160:163], a[36:39], v[72:75]
    s_lshl_b32 s46, s46, 10
    ds_read_b64_tr_b16 a[158:159], v199 offset:20480
    v_mfma_f32_16x16x32_bf16 v[80:83], a[160:163], a[68:71], v[80:83]
    buffer_load_dwordx4 a[20:23], v221, s[4:7], s46 offen sc1
    v_mfma_f32_16x16x32_bf16 v[88:91], a[160:163], a[100:103], v[88:91]
    s_waitcnt lgkmcnt(6)
    v_mfma_f32_16x16x32_bf16 v[68:71], a[164:167], a[4:7], v[68:71]
    ds_read_b64_tr_b16 a[160:161], v200 offset:16384
    v_mfma_f32_16x16x32_bf16 v[76:79], a[164:167], a[36:39], v[76:79]
    s_add_u32 s46, s46, 131072
    ds_read_b64_tr_b16 a[162:163], v200 offset:20480
    v_mfma_f32_16x16x32_bf16 v[84:87], a[164:167], a[68:71], v[84:87]
    buffer_load_dwordx4 a[52:55], v221, s[4:7], s46 offen sc1
    v_mfma_f32_16x16x32_bf16 v[92:95], a[164:167], a[100:103], v[92:95]
    s_waitcnt lgkmcnt(6)
    v_mfma_f32_16x16x32_bf16 v[96:99], a[168:171], a[4:7], v[96:99]
    ds_read_b64_tr_b16 a[164:165], v201 offset:16384
    v_mfma_f32_16x16x32_bf16 v[104:107], a[168:171], a[36:39], v[104:107]
    s_add_u32 s46, s46, 131072
    ds_read_b64_tr_b16 a[166:167], v201 offset:20480
    v_mfma_f32_16x16x32_bf16 v[112:115], a[168:171], a[68:71], v[112:115]
    buffer_load_dwordx4 a[84:87], v221, s[4:7], s46 offen sc1
    v_mfma_f32_16x16x32_bf16 v[120:123], a[168:171], a[100:103], v[120:123]
    s_waitcnt lgkmcnt(6)
    v_mfma_f32_16x16x32_bf16 v[100:103], a[172:175], a[4:7], v[100:103]
    ds_read_b64_tr_b16 a[168:169], v202 offset:16384
    v_mfma_f32_16x16x32_bf16 v[108:111], a[172:175], a[36:39], v[108:111]
    s_add_u32 s46, s46, 131072
    ds_read_b64_tr_b16 a[170:171], v202 offset:20480
    v_mfma_f32_16x16x32_bf16 v[116:119], a[172:175], a[68:71], v[116:119]
    buffer_load_dwordx4 a[116:119], v221, s[4:7], s46 offen sc1
    v_mfma_f32_16x16x32_bf16 v[124:127], a[172:175], a[100:103], v[124:127]
    s_waitcnt lgkmcnt(6)
    ds_read_b64_tr_b16 a[172:173], v203 offset:16384
    ds_read_b64_tr_b16 a[174:175], v203 offset:20480
    s_waitcnt vmcnt(18)
    v_mfma_f32_16x16x32_bf16 v[32:35], a[152:155], a[8:11], v[32:35]
    s_xor_b32 s52, s30, 31
    ds_read_b64_tr_b16 a[200:201], v196 offset:24576
    v_mfma_f32_16x16x32_bf16 v[40:43], a[152:155], a[40:43], v[40:43]
    s_lshl_b32 s52, s52, 15
    ds_read_b64_tr_b16 a[202:203], v196 offset:28672
    v_mfma_f32_16x16x32_bf16 v[48:51], a[152:155], a[72:75], v[48:51]
    s_add_u32 m0, s53, 57344
    ds_read_b64_tr_b16 a[204:205], v197 offset:24576
    v_mfma_f32_16x16x32_bf16 v[56:59], a[152:155], a[104:107], v[56:59]
    s_waitcnt lgkmcnt(6)
    ds_read_b64_tr_b16 a[206:207], v197 offset:28672
    buffer_load_dwordx4 v205, s[16:19], s52 offen lds
    v_mfma_f32_16x16x32_bf16 v[36:39], a[156:159], a[8:11], v[36:39]
    ds_read_b64_tr_b16 a[152:153], v198 offset:24576
    v_mfma_f32_16x16x32_bf16 v[44:47], a[156:159], a[40:43], v[44:47]
    ds_read_b64_tr_b16 a[154:155], v198 offset:28672
    v_mfma_f32_16x16x32_bf16 v[52:55], a[156:159], a[72:75], v[52:55]
    buffer_load_dwordx4 v206, s[16:19], s52 offen offset:1024 lds
    v_mfma_f32_16x16x32_bf16 v[60:63], a[156:159], a[104:107], v[60:63]
    s_waitcnt lgkmcnt(6)
    v_mfma_f32_16x16x32_bf16 v[64:67], a[160:163], a[8:11], v[64:67]
    s_xor_b32 s46, s30, 23
    ds_read_b64_tr_b16 a[156:157], v199 offset:24576
    v_mfma_f32_16x16x32_bf16 v[72:75], a[160:163], a[40:43], v[72:75]
    s_lshl_b32 s46, s46, 10
    ds_read_b64_tr_b16 a[158:159], v199 offset:28672
    v_mfma_f32_16x16x32_bf16 v[80:83], a[160:163], a[72:75], v[80:83]
    buffer_load_dwordx4 a[24:27], v221, s[4:7], s46 offen sc1
    v_mfma_f32_16x16x32_bf16 v[88:91], a[160:163], a[104:107], v[88:91]
    s_waitcnt lgkmcnt(6)
    v_mfma_f32_16x16x32_bf16 v[68:71], a[164:167], a[8:11], v[68:71]
    ds_read_b64_tr_b16 a[160:161], v200 offset:24576
    v_mfma_f32_16x16x32_bf16 v[76:79], a[164:167], a[40:43], v[76:79]
    s_add_u32 s46, s46, 131072
    ds_read_b64_tr_b16 a[162:163], v200 offset:28672
    v_mfma_f32_16x16x32_bf16 v[84:87], a[164:167], a[72:75], v[84:87]
    buffer_load_dwordx4 a[56:59], v221, s[4:7], s46 offen sc1
    v_mfma_f32_16x16x32_bf16 v[92:95], a[164:167], a[104:107], v[92:95]
    s_waitcnt lgkmcnt(6)
    v_mfma_f32_16x16x32_bf16 v[96:99], a[168:171], a[8:11], v[96:99]
    ds_read_b64_tr_b16 a[164:165], v201 offset:24576
    v_mfma_f32_16x16x32_bf16 v[104:107], a[168:171], a[40:43], v[104:107]
    s_add_u32 s46, s46, 131072
    ds_read_b64_tr_b16 a[166:167], v201 offset:28672
    v_mfma_f32_16x16x32_bf16 v[112:115], a[168:171], a[72:75], v[112:115]
    buffer_load_dwordx4 a[88:91], v221, s[4:7], s46 offen sc1
    v_mfma_f32_16x16x32_bf16 v[120:123], a[168:171], a[104:107], v[120:123]
    s_waitcnt lgkmcnt(6)
    v_mfma_f32_16x16x32_bf16 v[100:103], a[172:175], a[8:11], v[100:103]
    ds_read_b64_tr_b16 a[168:169], v202 offset:24576
    v_mfma_f32_16x16x32_bf16 v[108:111], a[172:175], a[40:43], v[108:111]
    s_add_u32 s46, s46, 131072
    ds_read_b64_tr_b16 a[170:171], v202 offset:28672
    v_mfma_f32_16x16x32_bf16 v[116:119], a[172:175], a[72:75], v[116:119]
    buffer_load_dwordx4 a[120:123], v221, s[4:7], s46 offen sc1
    v_mfma_f32_16x16x32_bf16 v[124:127], a[172:175], a[104:107], v[124:127]
    s_waitcnt lgkmcnt(6)
    ds_read_b64_tr_b16 a[172:173], v203 offset:24576
    ds_read_b64_tr_b16 a[174:175], v203 offset:28672
    s_waitcnt vmcnt(16)
    s_barrier
    v_mfma_f32_16x16x32_bf16 v[32:35], a[152:155], a[12:15], v[32:35]
    ds_read_b64_tr_b16 a[208:209], v196 offset:32768
    v_mfma_f32_16x16x32_bf16 v[40:43], a[152:155], a[44:47], v[40:43]
    s_xor_b32 s46, s30, 31
    ds_read_b64_tr_b16 a[210:211], v196 offset:36864
    v_mfma_f32_16x16x32_bf16 v[48:51], a[152:155], a[76:79], v[48:51]
    s_lshl_b32 s46, s46, 10
    ds_read_b64_tr_b16 a[212:213], v197 offset:32768
    v_mfma_f32_16x16x32_bf16 v[56:59], a[152:155], a[108:111], v[56:59]
    s_waitcnt lgkmcnt(6)
    ds_read_b64_tr_b16 a[214:215], v197 offset:36864
    buffer_load_dwordx4 a[28:31], v221, s[4:7], s46 offen sc1
    v_mfma_f32_16x16x32_bf16 v[36:39], a[156:159], a[12:15], v[36:39]
    ds_read_b64_tr_b16 a[152:153], v198 offset:32768
    v_mfma_f32_16x16x32_bf16 v[44:47], a[156:159], a[44:47], v[44:47]
    ds_read_b64_tr_b16 a[154:155], v198 offset:36864
    v_mfma_f32_16x16x32_bf16 v[52:55], a[156:159], a[76:79], v[52:55]
    s_add_u32 s46, s46, 131072
    v_mfma_f32_16x16x32_bf16 v[60:63], a[156:159], a[108:111], v[60:63]
    s_waitcnt lgkmcnt(6)
    buffer_load_dwordx4 a[60:63], v221, s[4:7], s46 offen sc1
    v_mfma_f32_16x16x32_bf16 v[64:67], a[160:163], a[12:15], v[64:67]
    ds_read_b64_tr_b16 a[156:157], v199 offset:32768
    v_mfma_f32_16x16x32_bf16 v[72:75], a[160:163], a[44:47], v[72:75]
    ds_read_b64_tr_b16 a[158:159], v199 offset:36864
    v_mfma_f32_16x16x32_bf16 v[80:83], a[160:163], a[76:79], v[80:83]
    v_mfma_f32_16x16x32_bf16 v[88:91], a[160:163], a[108:111], v[88:91]
    s_waitcnt lgkmcnt(6)
    v_mfma_f32_16x16x32_bf16 v[68:71], a[164:167], a[12:15], v[68:71]
    ds_read_b64_tr_b16 a[160:161], v200 offset:32768
    v_mfma_f32_16x16x32_bf16 v[76:79], a[164:167], a[44:47], v[76:79]
    s_add_u32 s46, s46, 131072
    ds_read_b64_tr_b16 a[162:163], v200 offset:36864
    v_mfma_f32_16x16x32_bf16 v[84:87], a[164:167], a[76:79], v[84:87]
    buffer_load_dwordx4 a[92:95], v221, s[4:7], s46 offen sc1
    v_mfma_f32_16x16x32_bf16 v[92:95], a[164:167], a[108:111], v[92:95]
    s_waitcnt lgkmcnt(6)
    v_mfma_f32_16x16x32_bf16 v[96:99], a[168:171], a[12:15], v[96:99]
    ds_read_b64_tr_b16 a[164:165], v201 offset:32768
    v_mfma_f32_16x16x32_bf16 v[104:107], a[168:171], a[44:47], v[104:107]
    ds_read_b64_tr_b16 a[166:167], v201 offset:36864
    v_mfma_f32_16x16x32_bf16 v[112:115], a[168:171], a[76:79], v[112:115]
    s_add_u32 s46, s46, 131072
    v_mfma_f32_16x16x32_bf16 v[120:123], a[168:171], a[108:111], v[120:123]
    s_waitcnt lgkmcnt(6)
    buffer_load_dwordx4 a[124:127], v221, s[4:7], s46 offen sc1
    v_mfma_f32_16x16x32_bf16 v[100:103], a[172:175], a[12:15], v[100:103]
    ds_read_b64_tr_b16 a[168:169], v202 offset:32768
    v_mfma_f32_16x16x32_bf16 v[108:111], a[172:175], a[44:47], v[108:111]
    ds_read_b64_tr_b16 a[170:171], v202 offset:36864
    v_mfma_f32_16x16x32_bf16 v[116:119], a[172:175], a[76:79], v[116:119]
    v_mfma_f32_16x16x32_bf16 v[124:127], a[172:175], a[108:111], v[124:127]
    s_waitcnt lgkmcnt(6)
    ds_read_b64_tr_b16 a[172:173], v203 offset:32768
    ds_read_b64_tr_b16 a[174:175], v203 offset:36864
    s_waitcnt vmcnt(16)
    v_mfma_f32_16x16x32_bf16 v[32:35], a[152:155], a[16:19], v[32:35]
    ds_read_b64_tr_b16 a[216:217], v196 offset:40960
    v_mfma_f32_16x16x32_bf16 v[40:43], a[152:155], a[48:51], v[40:43]
    ds_read_b64_tr_b16 a[218:219], v196 offset:45056
    v_mfma_f32_16x16x32_bf16 v[48:51], a[152:155], a[80:83], v[48:51]
    ds_read_b64_tr_b16 a[220:221], v197 offset:40960
    v_mfma_f32_16x16x32_bf16 v[56:59], a[152:155], a[112:115], v[56:59]
    s_waitcnt lgkmcnt(6)
    ds_read_b64_tr_b16 a[222:223], v197 offset:45056
    buffer_load_dword v208, v204, s[12:15], s60 offen offset:48 sc1
    v_mfma_f32_16x16x32_bf16 v[36:39], a[156:159], a[16:19], v[36:39]
    ds_read_b64_tr_b16 a[152:153], v198 offset:40960
    v_mfma_f32_16x16x32_bf16 v[44:47], a[156:159], a[48:51], v[44:47]
    ds_read_b64_tr_b16 a[154:155], v198 offset:45056
    v_mfma_f32_16x16x32_bf16 v[52:55], a[156:159], a[80:83], v[52:55]
    v_mfma_f32_16x16x32_bf16 v[60:63], a[156:159], a[112:115], v[60:63]
    s_waitcnt lgkmcnt(6)
    v_mfma_f32_16x16x32_bf16 v[64:67], a[160:163], a[16:19], v[64:67]
    ds_read_b64_tr_b16 a[156:157], v199 offset:40960
    v_mfma_f32_16x16x32_bf16 v[72:75], a[160:163], a[48:51], v[72:75]
    ds_read_b64_tr_b16 a[158:159], v199 offset:45056
    v_mfma_f32_16x16x32_bf16 v[80:83], a[160:163], a[80:83], v[80:83]
    v_mfma_f32_16x16x32_bf16 v[88:91], a[160:163], a[112:115], v[88:91]
    s_waitcnt lgkmcnt(6)
    v_mfma_f32_16x16x32_bf16 v[68:71], a[164:167], a[16:19], v[68:71]
    ds_read_b64_tr_b16 a[160:161], v200 offset:40960
    v_mfma_f32_16x16x32_bf16 v[76:79], a[164:167], a[48:51], v[76:79]
    ds_read_b64_tr_b16 a[162:163], v200 offset:45056
    v_mfma_f32_16x16x32_bf16 v[84:87], a[164:167], a[80:83], v[84:87]
    v_mfma_f32_16x16x32_bf16 v[92:95], a[164:167], a[112:115], v[92:95]
    s_waitcnt lgkmcnt(6)
    v_mfma_f32_16x16x32_bf16 v[96:99], a[168:171], a[16:19], v[96:99]
    ds_read_b64_tr_b16 a[164:165], v201 offset:40960
    v_mfma_f32_16x16x32_bf16 v[104:107], a[168:171], a[48:51], v[104:107]
    ds_read_b64_tr_b16 a[166:167], v201 offset:45056
    v_mfma_f32_16x16x32_bf16 v[112:115], a[168:171], a[80:83], v[112:115]
    v_mfma_f32_16x16x32_bf16 v[120:123], a[168:171], a[112:115], v[120:123]
    s_waitcnt lgkmcnt(6)
    v_mfma_f32_16x16x32_bf16 v[100:103], a[172:175], a[16:19], v[100:103]
    ds_read_b64_tr_b16 a[168:169], v202 offset:40960
    v_mfma_f32_16x16x32_bf16 v[108:111], a[172:175], a[48:51], v[108:111]
    ds_read_b64_tr_b16 a[170:171], v202 offset:45056
    v_mfma_f32_16x16x32_bf16 v[116:119], a[172:175], a[80:83], v[116:119]
    v_mfma_f32_16x16x32_bf16 v[124:127], a[172:175], a[112:115], v[124:127]
    s_waitcnt lgkmcnt(6)
    ds_read_b64_tr_b16 a[172:173], v203 offset:40960
    ds_read_b64_tr_b16 a[174:175], v203 offset:45056
    s_waitcnt vmcnt(9)
    s_barrier
    v_mfma_f32_16x16x32_bf16 v[32:35], a[152:155], a[20:23], v[32:35]
    ds_read_b64_tr_b16 a[224:225], v196 offset:49152
    v_mfma_f32_16x16x32_bf16 v[40:43], a[152:155], a[52:55], v[40:43]
    ds_read_b64_tr_b16 a[226:227], v196 offset:53248
    v_mfma_f32_16x16x32_bf16 v[48:51], a[152:155], a[84:87], v[48:51]
    ds_read_b64_tr_b16 a[228:229], v197 offset:49152
    v_mfma_f32_16x16x32_bf16 v[56:59], a[152:155], a[116:119], v[56:59]
    s_waitcnt lgkmcnt(6)
    ds_read_b64_tr_b16 a[230:231], v197 offset:53248
    v_mfma_f32_16x16x32_bf16 v[36:39], a[156:159], a[20:23], v[36:39]
    ds_read_b64_tr_b16 a[152:153], v198 offset:49152
    v_mfma_f32_16x16x32_bf16 v[44:47], a[156:159], a[52:55], v[44:47]
    ds_read_b64_tr_b16 a[154:155], v198 offset:53248
    v_mfma_f32_16x16x32_bf16 v[52:55], a[156:159], a[84:87], v[52:55]
    v_mfma_f32_16x16x32_bf16 v[60:63], a[156:159], a[116:119], v[60:63]
    s_waitcnt lgkmcnt(6)
    v_mfma_f32_16x16x32_bf16 v[64:67], a[160:163], a[20:23], v[64:67]
    ds_read_b64_tr_b16 a[156:157], v199 offset:49152
    v_mfma_f32_16x16x32_bf16 v[72:75], a[160:163], a[52:55], v[72:75]
    ds_read_b64_tr_b16 a[158:159], v199 offset:53248
    v_mfma_f32_16x16x32_bf16 v[80:83], a[160:163], a[84:87], v[80:83]
    v_mfma_f32_16x16x32_bf16 v[88:91], a[160:163], a[116:119], v[88:91]
    s_waitcnt lgkmcnt(6)
    v_mfma_f32_16x16x32_bf16 v[68:71], a[164:167], a[20:23], v[68:71]
    ds_read_b64_tr_b16 a[160:161], v200 offset:49152
    v_mfma_f32_16x16x32_bf16 v[76:79], a[164:167], a[52:55], v[76:79]
    ds_read_b64_tr_b16 a[162:163], v200 offset:53248
    v_mfma_f32_16x16x32_bf16 v[84:87], a[164:167], a[84:87], v[84:87]
    v_mfma_f32_16x16x32_bf16 v[92:95], a[164:167], a[116:119], v[92:95]
    s_waitcnt lgkmcnt(6)
    v_mfma_f32_16x16x32_bf16 v[96:99], a[168:171], a[20:23], v[96:99]
    ds_read_b64_tr_b16 a[164:165], v201 offset:49152
    v_mfma_f32_16x16x32_bf16 v[104:107], a[168:171], a[52:55], v[104:107]
    ds_read_b64_tr_b16 a[166:167], v201 offset:53248
    v_mfma_f32_16x16x32_bf16 v[112:115], a[168:171], a[84:87], v[112:115]
    v_mfma_f32_16x16x32_bf16 v[120:123], a[168:171], a[116:119], v[120:123]
    s_waitcnt lgkmcnt(6)
    v_mfma_f32_16x16x32_bf16 v[100:103], a[172:175], a[20:23], v[100:103]
    ds_read_b64_tr_b16 a[168:169], v202 offset:49152
    v_mfma_f32_16x16x32_bf16 v[108:111], a[172:175], a[52:55], v[108:111]
    ds_read_b64_tr_b16 a[170:171], v202 offset:53248
    v_mfma_f32_16x16x32_bf16 v[116:119], a[172:175], a[84:87], v[116:119]
    v_mfma_f32_16x16x32_bf16 v[124:127], a[172:175], a[116:119], v[124:127]
    s_waitcnt lgkmcnt(6)
    ds_read_b64_tr_b16 a[172:173], v203 offset:49152
    ds_read_b64_tr_b16 a[174:175], v203 offset:53248
    s_waitcnt vmcnt(0)
    v_cmp_ne_u32 vcc, s54, v208
    s_cmp_eq_u32 vcc_lo, 0
    s_cbranch_scc0 K1_SPIN4
K1_CHK4_OK:
    v_mfma_f32_16x16x32_bf16 v[32:35], a[152:155], a[24:27], v[32:35]
    ds_read_b64_tr_b16 a[232:233], v196 offset:57344
    v_mfma_f32_16x16x32_bf16 v[40:43], a[152:155], a[56:59], v[40:43]
    ds_read_b64_tr_b16 a[234:235], v196 offset:61440
    v_mfma_f32_16x16x32_bf16 v[48:51], a[152:155], a[88:91], v[48:51]
    ds_read_b64_tr_b16 a[236:237], v197 offset:57344
    v_mfma_f32_16x16x32_bf16 v[56:59], a[152:155], a[120:123], v[56:59]
    s_waitcnt lgkmcnt(6)
    ds_read_b64_tr_b16 a[238:239], v197 offset:61440
    v_mfma_f32_16x16x32_bf16 v[36:39], a[156:159], a[24:27], v[36:39]
    ds_read_b64_tr_b16 a[152:153], v198 offset:57344
    v_mfma_f32_16x16x32_bf16 v[44:47], a[156:159], a[56:59], v[44:47]
    ds_read_b64_tr_b16 a[154:155], v198 offset:61440
    v_mfma_f32_16x16x32_bf16 v[52:55], a[156:159], a[88:91], v[52:55]
    v_mfma_f32_16x16x32_bf16 v[60:63], a[156:159], a[120:123], v[60:63]
    s_waitcnt lgkmcnt(6)
    v_mfma_f32_16x16x32_bf16 v[64:67], a[160:163], a[24:27], v[64:67]
    ds_read_b64_tr_b16 a[156:157], v199 offset:57344
    v_mfma_f32_16x16x32_bf16 v[72:75], a[160:163], a[56:59], v[72:75]
    ds_read_b64_tr_b16 a[158:159], v199 offset:61440
    v_mfma_f32_16x16x32_bf16 v[80:83], a[160:163], a[88:91], v[80:83]
    v_mfma_f32_16x16x32_bf16 v[88:91], a[160:163], a[120:123], v[88:91]
    s_waitcnt lgkmcnt(6)
    v_mfma_f32_16x16x32_bf16 v[68:71], a[164:167], a[24:27], v[68:71]
    ds_read_b64_tr_b16 a[160:161], v200 offset:57344
    v_mfma_f32_16x16x32_bf16 v[76:79], a[164:167], a[56:59], v[76:79]
    ds_read_b64_tr_b16 a[162:163], v200 offset:61440
    v_mfma_f32_16x16x32_bf16 v[84:87], a[164:167], a[88:91], v[84:87]
    v_mfma_f32_16x16x32_bf16 v[92:95], a[164:167], a[120:123], v[92:95]
    s_waitcnt lgkmcnt(6)
    v_mfma_f32_16x16x32_bf16 v[96:99], a[168:171], a[24:27], v[96:99]
    ds_read_b64_tr_b16 a[164:165], v201 offset:57344
    v_mfma_f32_16x16x32_bf16 v[104:107], a[168:171], a[56:59], v[104:107]
    ds_read_b64_tr_b16 a[166:167], v201 offset:61440
    v_mfma_f32_16x16x32_bf16 v[112:115], a[168:171], a[88:91], v[112:115]
    v_mfma_f32_16x16x32_bf16 v[120:123], a[168:171], a[120:123], v[120:123]
    s_waitcnt lgkmcnt(6)
    v_mfma_f32_16x16x32_bf16 v[100:103], a[172:175], a[24:27], v[100:103]
    ds_read_b64_tr_b16 a[168:169], v202 offset:57344
    v_mfma_f32_16x16x32_bf16 v[108:111], a[172:175], a[56:59], v[108:111]
    ds_read_b64_tr_b16 a[170:171], v202 offset:61440
    v_mfma_f32_16x16x32_bf16 v[116:119], a[172:175], a[88:91], v[116:119]
    v_mfma_f32_16x16x32_bf16 v[124:127], a[172:175], a[120:123], v[124:127]
    s_waitcnt lgkmcnt(6)
    ds_read_b64_tr_b16 a[172:173], v203 offset:57344
    ds_read_b64_tr_b16 a[174:175], v203 offset:61440
    v_mfma_f32_16x16x32_bf16 v[32:35], a[152:155], a[28:31], v[32:35]
    v_mfma_f32_16x16x32_bf16 v[40:43], a[152:155], a[60:63], v[40:43]
    v_mfma_f32_16x16x32_bf16 v[48:51], a[152:155], a[92:95], v[48:51]
    v_mfma_f32_16x16x32_bf16 v[56:59], a[152:155], a[124:127], v[56:59]
    s_waitcnt lgkmcnt(8)
    v_mfma_f32_16x16x32_bf16 v[36:39], a[156:159], a[28:31], v[36:39]
    v_mfma_f32_16x16x32_bf16 v[44:47], a[156:159], a[60:63], v[44:47]
    v_mfma_f32_16x16x32_bf16 v[52:55], a[156:159], a[92:95], v[52:55]
    v_mfma_f32_16x16x32_bf16 v[60:63], a[156:159], a[124:127], v[60:63]
    s_waitcnt lgkmcnt(6)
    v_mfma_f32_16x16x32_bf16 v[64:67], a[160:163], a[28:31], v[64:67]
    v_mfma_f32_16x16x32_bf16 v[72:75], a[160:163], a[60:63], v[72:75]
    v_mfma_f32_16x16x32_bf16 v[80:83], a[160:163], a[92:95], v[80:83]
    v_mfma_f32_16x16x32_bf16 v[88:91], a[160:163], a[124:127], v[88:91]
    s_waitcnt lgkmcnt(4)
    v_mfma_f32_16x16x32_bf16 v[68:71], a[164:167], a[28:31], v[68:71]
    v_mfma_f32_16x16x32_bf16 v[76:79], a[164:167], a[60:63], v[76:79]
    v_mfma_f32_16x16x32_bf16 v[84:87], a[164:167], a[92:95], v[84:87]
    v_mfma_f32_16x16x32_bf16 v[92:95], a[164:167], a[124:127], v[92:95]
    s_waitcnt lgkmcnt(2)
    v_mfma_f32_16x16x32_bf16 v[96:99], a[168:171], a[28:31], v[96:99]
    v_mfma_f32_16x16x32_bf16 v[104:107], a[168:171], a[60:63], v[104:107]
    v_mfma_f32_16x16x32_bf16 v[112:115], a[168:171], a[92:95], v[112:115]
    v_mfma_f32_16x16x32_bf16 v[120:123], a[168:171], a[124:127], v[120:123]
    s_waitcnt lgkmcnt(0)
    v_mfma_f32_16x16x32_bf16 v[100:103], a[172:175], a[28:31], v[100:103]
    v_mfma_f32_16x16x32_bf16 v[108:111], a[172:175], a[60:63], v[108:111]
    v_mfma_f32_16x16x32_bf16 v[116:119], a[172:175], a[92:95], v[116:119]
    v_mfma_f32_16x16x32_bf16 v[124:127], a[172:175], a[124:127], v[124:127]
    s_waitcnt lgkmcnt(0)
    v_mfma_f32_16x16x32_bf16 v[0:3], a[176:179], a[0:3], v[0:3]
    v_cvt_pk_bf16_f32 v32, v32, v33
    v_cvt_pk_bf16_f32 v33, v34, v35
    v_mfma_f32_16x16x32_bf16 v[8:11], a[176:179], a[32:35], v[8:11]
    v_cvt_pk_bf16_f32 v34, v36, v37
    v_cvt_pk_bf16_f32 v35, v38, v39
    v_mfma_f32_16x16x32_bf16 v[16:19], a[176:179], a[64:67], v[16:19]
    buffer_store_dwordx4 v[32:35], v221, s[20:23], s55 offen offset:1024 sc1
    v_cvt_pk_bf16_f32 v40, v40, v41
    v_mfma_f32_16x16x32_bf16 v[24:27], a[176:179], a[96:99], v[24:27]
    v_cvt_pk_bf16_f32 v41, v42, v43
    v_cvt_pk_bf16_f32 v42, v44, v45
    v_mfma_f32_16x16x32_bf16 v[4:7], a[180:183], a[0:3], v[4:7]
    v_cvt_pk_bf16_f32 v43, v46, v47
    v_mfma_f32_16x16x32_bf16 v[12:15], a[180:183], a[32:35], v[12:15]
    buffer_store_dwordx4 v[40:43], v221, s[20:23], s56 offen offset:1024 sc1
    v_cvt_pk_bf16_f32 v48, v48, v49
    v_mfma_f32_16x16x32_bf16 v[20:23], a[180:183], a[64:67], v[20:23]
    v_cvt_pk_bf16_f32 v49, v50, v51
    v_cvt_pk_bf16_f32 v50, v52, v53
    v_mfma_f32_16x16x32_bf16 v[28:31], a[180:183], a[96:99], v[28:31]
    v_cvt_pk_bf16_f32 v51, v54, v55
    v_mfma_f32_16x16x32_bf16 v[0:3], a[184:187], a[4:7], v[0:3]
    buffer_store_dwordx4 v[48:51], v221, s[20:23], s57 offen offset:1024 sc1
    v_cvt_pk_bf16_f32 v56, v56, v57
    v_mfma_f32_16x16x32_bf16 v[8:11], a[184:187], a[36:39], v[8:11]
    v_cvt_pk_bf16_f32 v57, v58, v59
    v_cvt_pk_bf16_f32 v58, v60, v61
    v_mfma_f32_16x16x32_bf16 v[16:19], a[184:187], a[68:71], v[16:19]
    v_cvt_pk_bf16_f32 v59, v62, v63
    v_mfma_f32_16x16x32_bf16 v[24:27], a[184:187], a[100:103], v[24:27]
    buffer_store_dwordx4 v[56:59], v221, s[20:23], s58 offen offset:1024 sc1
    v_cvt_pk_bf16_f32 v64, v64, v65
    v_mfma_f32_16x16x32_bf16 v[4:7], a[188:191], a[4:7], v[4:7]
    v_cvt_pk_bf16_f32 v65, v66, v67
    v_cvt_pk_bf16_f32 v66, v68, v69
    v_mfma_f32_16x16x32_bf16 v[12:15], a[188:191], a[36:39], v[12:15]
    v_cvt_pk_bf16_f32 v67, v70, v71
    v_mfma_f32_16x16x32_bf16 v[20:23], a[188:191], a[68:71], v[20:23]
    buffer_store_dwordx4 v[64:67], v221, s[20:23], s55 offen offset:2048 sc1
    v_cvt_pk_bf16_f32 v72, v72, v73
    v_mfma_f32_16x16x32_bf16 v[28:31], a[188:191], a[100:103], v[28:31]
    v_cvt_pk_bf16_f32 v73, v74, v75
    v_cvt_pk_bf16_f32 v74, v76, v77
    v_mfma_f32_16x16x32_bf16 v[0:3], a[192:195], a[8:11], v[0:3]
    v_cvt_pk_bf16_f32 v75, v78, v79
    v_mfma_f32_16x16x32_bf16 v[8:11], a[192:195], a[40:43], v[8:11]
    buffer_store_dwordx4 v[72:75], v221, s[20:23], s56 offen offset:2048 sc1
    v_cvt_pk_bf16_f32 v80, v80, v81
    v_mfma_f32_16x16x32_bf16 v[16:19], a[192:195], a[72:75], v[16:19]
    v_cvt_pk_bf16_f32 v81, v82, v83
    v_cvt_pk_bf16_f32 v82, v84, v85
    v_mfma_f32_16x16x32_bf16 v[24:27], a[192:195], a[104:107], v[24:27]
    v_cvt_pk_bf16_f32 v83, v86, v87
    v_mfma_f32_16x16x32_bf16 v[4:7], a[196:199], a[8:11], v[4:7]
    buffer_store_dwordx4 v[80:83], v221, s[20:23], s57 offen offset:2048 sc1
    v_cvt_pk_bf16_f32 v88, v88, v89
    v_mfma_f32_16x16x32_bf16 v[12:15], a[196:199], a[40:43], v[12:15]
    v_cvt_pk_bf16_f32 v89, v90, v91
    v_cvt_pk_bf16_f32 v90, v92, v93
    v_mfma_f32_16x16x32_bf16 v[20:23], a[196:199], a[72:75], v[20:23]
    v_cvt_pk_bf16_f32 v91, v94, v95
    v_mfma_f32_16x16x32_bf16 v[28:31], a[196:199], a[104:107], v[28:31]
    buffer_store_dwordx4 v[88:91], v221, s[20:23], s58 offen offset:2048 sc1
    v_cvt_pk_bf16_f32 v96, v96, v97
    v_mfma_f32_16x16x32_bf16 v[0:3], a[200:203], a[12:15], v[0:3]
    v_cvt_pk_bf16_f32 v97, v98, v99
    v_cvt_pk_bf16_f32 v98, v100, v101
    v_mfma_f32_16x16x32_bf16 v[8:11], a[200:203], a[44:47], v[8:11]
    v_cvt_pk_bf16_f32 v99, v102, v103
    v_mfma_f32_16x16x32_bf16 v[16:19], a[200:203], a[76:79], v[16:19]
    buffer_store_dwordx4 v[96:99], v221, s[20:23], s55 offen offset:3072 sc1
    v_cvt_pk_bf16_f32 v104, v104, v105
    v_mfma_f32_16x16x32_bf16 v[24:27], a[200:203], a[108:111], v[24:27]
    v_cvt_pk_bf16_f32 v105, v106, v107
    v_cvt_pk_bf16_f32 v106, v108, v109
    v_mfma_f32_16x16x32_bf16 v[4:7], a[204:207], a[12:15], v[4:7]
    v_cvt_pk_bf16_f32 v107, v110, v111
    v_mfma_f32_16x16x32_bf16 v[12:15], a[204:207], a[44:47], v[12:15]
    buffer_store_dwordx4 v[104:107], v221, s[20:23], s56 offen offset:3072 sc1
    v_cvt_pk_bf16_f32 v112, v112, v113
    v_mfma_f32_16x16x32_bf16 v[20:23], a[204:207], a[76:79], v[20:23]
    v_cvt_pk_bf16_f32 v113, v114, v115
    v_cvt_pk_bf16_f32 v114, v116, v117
    v_mfma_f32_16x16x32_bf16 v[28:31], a[204:207], a[108:111], v[28:31]
    v_cvt_pk_bf16_f32 v115, v118, v119
    v_mfma_f32_16x16x32_bf16 v[0:3], a[208:211], a[16:19], v[0:3]
    buffer_store_dwordx4 v[112:115], v221, s[20:23], s57 offen offset:3072 sc1
    v_cvt_pk_bf16_f32 v120, v120, v121
    v_mfma_f32_16x16x32_bf16 v[8:11], a[208:211], a[48:51], v[8:11]
    v_cvt_pk_bf16_f32 v121, v122, v123
    v_cvt_pk_bf16_f32 v122, v124, v125
    v_mfma_f32_16x16x32_bf16 v[16:19], a[208:211], a[80:83], v[16:19]
    v_cvt_pk_bf16_f32 v123, v126, v127
    v_mfma_f32_16x16x32_bf16 v[24:27], a[208:211], a[112:115], v[24:27]
    buffer_store_dwordx4 v[120:123], v221, s[20:23], s58 offen offset:3072 sc1
    v_mfma_f32_16x16x32_bf16 v[4:7], a[212:215], a[16:19], v[4:7]
    s_xor_b32 s3, s35, 0
    v_mfma_f32_16x16x32_bf16 v[12:15], a[212:215], a[48:51], v[12:15]
    s_nop 0
    v_mfma_f32_16x16x32_bf16 v[20:23], a[212:215], a[80:83], v[20:23]
    s_lshl_b32 s3, s3, 9
    v_mfma_f32_16x16x32_bf16 v[28:31], a[212:215], a[112:115], v[28:31]
    s_add_u32 s46, s3, s29
    v_mfma_f32_16x16x32_bf16 v[0:3], a[216:219], a[20:23], v[0:3]
    s_xor_b32 s3, s35, 1
    v_mfma_f32_16x16x32_bf16 v[8:11], a[216:219], a[52:55], v[8:11]
    s_lshl_b32 s33, s3, 15
    v_mfma_f32_16x16x32_bf16 v[16:19], a[216:219], a[84:87], v[16:19]
    s_lshl_b32 s3, s3, 9
    v_mfma_f32_16x16x32_bf16 v[24:27], a[216:219], a[116:119], v[24:27]
    s_add_u32 s47, s3, s29
    v_mfma_f32_16x16x32_bf16 v[4:7], a[220:223], a[20:23], v[4:7]
    s_xor_b32 s3, s35, 2
    v_mfma_f32_16x16x32_bf16 v[12:15], a[220:223], a[52:55], v[12:15]
    s_lshl_b32 s34, s3, 15
    v_mfma_f32_16x16x32_bf16 v[20:23], a[220:223], a[84:87], v[20:23]
    s_lshl_b32 s3, s3, 9
    v_mfma_f32_16x16x32_bf16 v[28:31], a[220:223], a[116:119], v[28:31]
    s_add_u32 s50, s3, s29
    v_mfma_f32_16x16x32_bf16 v[0:3], a[224:227], a[24:27], v[0:3]
    s_xor_b32 s3, s35, 3
    v_mfma_f32_16x16x32_bf16 v[8:11], a[224:227], a[56:59], v[8:11]
    s_lshl_b32 s36, s3, 15
    v_mfma_f32_16x16x32_bf16 v[16:19], a[224:227], a[88:91], v[16:19]
    s_lshl_b32 s3, s3, 9
    v_mfma_f32_16x16x32_bf16 v[24:27], a[224:227], a[120:123], v[24:27]
    s_add_u32 s51, s3, s29
    v_mfma_f32_16x16x32_bf16 v[4:7], a[228:231], a[24:27], v[4:7]
    s_mov_b32 s31, 0
    v_mfma_f32_16x16x32_bf16 v[12:15], a[228:231], a[56:59], v[12:15]
    v_mfma_f32_16x16x32_bf16 v[20:23], a[228:231], a[88:91], v[20:23]
    v_mfma_f32_16x16x32_bf16 v[28:31], a[228:231], a[120:123], v[28:31]
    v_mfma_f32_16x16x32_bf16 v[0:3], a[232:235], a[28:31], v[0:3]
    v_mfma_f32_16x16x32_bf16 v[8:11], a[232:235], a[60:63], v[8:11]
    v_mfma_f32_16x16x32_bf16 v[16:19], a[232:235], a[92:95], v[16:19]
    v_mfma_f32_16x16x32_bf16 v[24:27], a[232:235], a[124:127], v[24:27]
    v_mfma_f32_16x16x32_bf16 v[4:7], a[236:239], a[28:31], v[4:7]
    v_mfma_f32_16x16x32_bf16 v[12:15], a[236:239], a[60:63], v[12:15]
    v_mfma_f32_16x16x32_bf16 v[20:23], a[236:239], a[92:95], v[20:23]
    v_mfma_f32_16x16x32_bf16 v[28:31], a[236:239], a[124:127], v[28:31]
    s_waitcnt vmcnt(8)
    buffer_store_dword v219, v218, s[12:15], s47 offen offset:4 sc1
    s_waitcnt vmcnt(5)
    buffer_store_dword v219, v218, s[12:15], s50 offen offset:8 sc1
    s_waitcnt vmcnt(2)
    buffer_store_dword v219, v218, s[12:15], s51 offen offset:12 sc1
    v_add_u32 v192, 131072, v221
    v_add_u32 v193, 262144, v221
    v_add_u32 v194, 393216, v221
    s_mov_b32 s55, 0
    s_mov_b32 s56, 32768
    s_mov_b32 s57, 65536
    s_mov_b32 s58, 98304
K1_POLLX:
    buffer_load_dword v208, v204, s[12:15], s46 offen sc1
    s_add_u32 s31, s31, 1
    s_waitcnt vmcnt(0)
    v_cmp_ne_u32 vcc, s54, v208
    s_cmp_gt_u32 s31, 0x20000
    s_cbranch_scc1 K1_GOX
    s_and_b32 s3, vcc_lo, 14
    s_cbranch_scc1 K1_POLLX
K1_GOX:
    buffer_load_dwordx4 v[32:35], v221, s[8:11], s33 offen offset:1024 sc1
    buffer_load_dwordx4 v[64:67], v221, s[8:11], s34 offen offset:2048 sc1
    buffer_load_dwordx4 v[96:99], v221, s[8:11], s36 offen offset:3072 sc1
    buffer_load_dwordx4 v[40:43], v192, s[8:11], s33 offen offset:1024 sc1
    buffer_load_dwordx4 v[72:75], v192, s[8:11], s34 offen offset:2048 sc1
    buffer_load_dwordx4 v[104:107], v192, s[8:11], s36 offen offset:3072 sc1
    buffer_load_dwordx4 v[48:51], v193, s[8:11], s33 offen offset:1024 sc1
    buffer_load_dwordx4 v[80:83], v193, s[8:11], s34 offen offset:2048 sc1
    buffer_load_dwordx4 v[112:115], v193, s[8:11], s36 offen offset:3072 sc1
    buffer_load_dwordx4 v[56:59], v194, s[8:11], s33 offen offset:1024 sc1
    buffer_load_dwordx4 v[88:91], v194, s[8:11], s34 offen offset:2048 sc1
    buffer_load_dwordx4 v[120:123], v194, s[8:11], s36 offen offset:3072 sc1
    s_mov_b32 s3, 0xffff0000
    s_waitcnt vmcnt(9)
    v_and_b32 v39, s3, v35
    v_lshlrev_b32 v38, 16, v35
    v_and_b32 v37, s3, v34
    v_lshlrev_b32 v36, 16, v34
    v_and_b32 v35, s3, v33
    v_lshlrev_b32 v34, 16, v33
    v_and_b32 v33, s3, v32
    v_lshlrev_b32 v32, 16, v32
    v_pk_add_f32 v[0:1], v[0:1], v[32:33]
    v_pk_add_f32 v[2:3], v[2:3], v[34:35]
    v_pk_add_f32 v[4:5], v[4:5], v[36:37]
    v_pk_add_f32 v[6:7], v[6:7], v[38:39]
    v_and_b32 v71, s3, v67
    v_lshlrev_b32 v70, 16, v67
    v_and_b32 v69, s3, v66
    v_lshlrev_b32 v68, 16, v66
    v_and_b32 v67, s3, v65
    v_lshlrev_b32 v66, 16, v65
    v_and_b32 v65, s3, v64
    v_lshlrev_b32 v64, 16, v64
    v_pk_add_f32 v[0:1], v[0:1], v[64:65]
    v_pk_add_f32 v[2:3], v[2:3], v[66:67]
    v_pk_add_f32 v[4:5], v[4:5], v[68:69]
    v_pk_add_f32 v[6:7], v[6:7], v[70:71]
    v_and_b32 v103, s3, v99
    v_lshlrev_b32 v102, 16, v99
    v_and_b32 v101, s3, v98
    v_lshlrev_b32 v100, 16, v98
    v_and_b32 v99, s3, v97
    v_lshlrev_b32 v98, 16, v97
    v_and_b32 v97, s3, v96
    v_lshlrev_b32 v96, 16, v96
    v_pk_add_f32 v[0:1], v[0:1], v[96:97]
    v_pk_add_f32 v[2:3], v[2:3], v[98:99]
    v_pk_add_f32 v[4:5], v[4:5], v[100:101]
    v_pk_add_f32 v[6:7], v[6:7], v[102:103]
    v_cvt_pk_bf16_f32 v0, v0, v1
    v_cvt_pk_bf16_f32 v1, v2, v3
    v_cvt_pk_bf16_f32 v2, v4, v5
    v_cvt_pk_bf16_f32 v3, v6, v7
    s_nop 0
    v_permlane16_swap_b32 v0, v2
    v_permlane16_swap_b32 v1, v3
    buffer_store_dwordx4 v[0:3], v207, s[24:27], s55 offen sc1
    s_waitcnt vmcnt(7)
    v_and_b32 v47, s3, v43
    v_lshlrev_b32 v46, 16, v43
    v_and_b32 v45, s3, v42
    v_lshlrev_b32 v44, 16, v42
    v_and_b32 v43, s3, v41
    v_lshlrev_b32 v42, 16, v41
    v_and_b32 v41, s3, v40
    v_lshlrev_b32 v40, 16, v40
    v_pk_add_f32 v[8:9], v[8:9], v[40:41]
    v_pk_add_f32 v[10:11], v[10:11], v[42:43]
    v_pk_add_f32 v[12:13], v[12:13], v[44:45]
    v_pk_add_f32 v[14:15], v[14:15], v[46:47]
    v_and_b32 v79, s3, v75
    v_lshlrev_b32 v78, 16, v75
    v_and_b32 v77, s3, v74
    v_lshlrev_b32 v76, 16, v74
    v_and_b32 v75, s3, v73
    v_lshlrev_b32 v74, 16, v73
    v_and_b32 v73, s3, v72
    v_lshlrev_b32 v72, 16, v72
    v_pk_add_f32 v[8:9], v[8:9], v[72:73]
    v_pk_add_f32 v[10:11], v[10:11], v[74:75]
    v_pk_add_f32 v[12:13], v[12:13], v[76:77]
    v_pk_add_f32 v[14:15], v[14:15], v[78:79]
    v_and_b32 v111, s3, v107
    v_lshlrev_b32 v110, 16, v107
    v_and_b32 v109, s3, v106
    v_lshlrev_b32 v108, 16, v106
    v_and_b32 v107, s3, v105
    v_lshlrev_b32 v106, 16, v105
    v_and_b32 v105, s3, v104
    v_lshlrev_b32 v104, 16, v104
    v_pk_add_f32 v[8:9], v[8:9], v[104:105]
    v_pk_add_f32 v[10:11], v[10:11], v[106:107]
    v_pk_add_f32 v[12:13], v[12:13], v[108:109]
    v_pk_add_f32 v[14:15], v[14:15], v[110:111]
    v_cvt_pk_bf16_f32 v8, v8, v9
    v_cvt_pk_bf16_f32 v9, v10, v11
    v_cvt_pk_bf16_f32 v10, v12, v13
    v_cvt_pk_bf16_f32 v11, v14, v15
    s_nop 0
    v_permlane16_swap_b32 v8, v10
    v_permlane16_swap_b32 v9, v11
    buffer_store_dwordx4 v[8:11], v207, s[24:27], s56 offen sc1
    s_waitcnt vmcnt(5)
    v_and_b32 v55, s3, v51
    v_lshlrev_b32 v54, 16, v51
    v_and_b32 v53, s3, v50
    v_lshlrev_b32 v52, 16, v50
    v_and_b32 v51, s3, v49
    v_lshlrev_b32 v50, 16, v49
    v_and_b32 v49, s3, v48
    v_lshlrev_b32 v48, 16, v48
    v_pk_add_f32 v[16:17], v[16:17], v[48:49]
    v_pk_add_f32 v[18:19], v[18:19], v[50:51]
    v_pk_add_f32 v[20:21], v[20:21], v[52:53]
    v_pk_add_f32 v[22:23], v[22:23], v[54:55]
    v_and_b32 v87, s3, v83
    v_lshlrev_b32 v86, 16, v83
    v_and_b32 v85, s3, v82
    v_lshlrev_b32 v84, 16, v82
    v_and_b32 v83, s3, v81
    v_lshlrev_b32 v82, 16, v81
    v_and_b32 v81, s3, v80
    v_lshlrev_b32 v80, 16, v80
    v_pk_add_f32 v[16:17], v[16:17], v[80:81]
    v_pk_add_f32 v[18:19], v[18:19], v[82:83]
    v_pk_add_f32 v[20:21], v[20:21], v[84:85]
    v_pk_add_f32 v[22:23], v[22:23], v[86:87]
    v_and_b32 v119, s3, v115
    v_lshlrev_b32 v118, 16, v115
    v_and_b32 v117, s3, v114
    v_lshlrev_b32 v116, 16, v114
    v_and_b32 v115, s3, v113
    v_lshlrev_b32 v114, 16, v113
    v_and_b32 v113, s3, v112
    v_lshlrev_b32 v112, 16, v112
    v_pk_add_f32 v[16:17], v[16:17], v[112:113]
    v_pk_add_f32 v[18:19], v[18:19], v[114:115]
    v_pk_add_f32 v[20:21], v[20:21], v[116:117]
    v_pk_add_f32 v[22:23], v[22:23], v[118:119]
    v_cvt_pk_bf16_f32 v16, v16, v17
    v_cvt_pk_bf16_f32 v17, v18, v19
    v_cvt_pk_bf16_f32 v18, v20, v21
    v_cvt_pk_bf16_f32 v19, v22, v23
    s_nop 0
    v_permlane16_swap_b32 v16, v18
    v_permlane16_swap_b32 v17, v19
    buffer_store_dwordx4 v[16:19], v207, s[24:27], s57 offen sc1
    s_waitcnt vmcnt(3)
    v_and_b32 v63, s3, v59
    v_lshlrev_b32 v62, 16, v59
    v_and_b32 v61, s3, v58
    v_lshlrev_b32 v60, 16, v58
    v_and_b32 v59, s3, v57
    v_lshlrev_b32 v58, 16, v57
    v_and_b32 v57, s3, v56
    v_lshlrev_b32 v56, 16, v56
    v_pk_add_f32 v[24:25], v[24:25], v[56:57]
    v_pk_add_f32 v[26:27], v[26:27], v[58:59]
    v_pk_add_f32 v[28:29], v[28:29], v[60:61]
    v_pk_add_f32 v[30:31], v[30:31], v[62:63]
    v_and_b32 v95, s3, v91
    v_lshlrev_b32 v94, 16, v91
    v_and_b32 v93, s3, v90
    v_lshlrev_b32 v92, 16, v90
    v_and_b32 v91, s3, v89
    v_lshlrev_b32 v90, 16, v89
    v_and_b32 v89, s3, v88
    v_lshlrev_b32 v88, 16, v88
    v_pk_add_f32 v[24:25], v[24:25], v[88:89]
    v_pk_add_f32 v[26:27], v[26:27], v[90:91]
    v_pk_add_f32 v[28:29], v[28:29], v[92:93]
    v_pk_add_f32 v[30:31], v[30:31], v[94:95]
    v_and_b32 v127, s3, v123
    v_lshlrev_b32 v126, 16, v123
    v_and_b32 v125, s3, v122
    v_lshlrev_b32 v124, 16, v122
    v_and_b32 v123, s3, v121
    v_lshlrev_b32 v122, 16, v121
    v_and_b32 v121, s3, v120
    v_lshlrev_b32 v120, 16, v120
    v_pk_add_f32 v[24:25], v[24:25], v[120:121]
    v_pk_add_f32 v[26:27], v[26:27], v[122:123]
    v_pk_add_f32 v[28:29], v[28:29], v[124:125]
    v_pk_add_f32 v[30:31], v[30:31], v[126:127]
    v_cvt_pk_bf16_f32 v24, v24, v25
    v_cvt_pk_bf16_f32 v25, v26, v27
    v_cvt_pk_bf16_f32 v26, v28, v29
    v_cvt_pk_bf16_f32 v27, v30, v31
    s_nop 0
    v_permlane16_swap_b32 v24, v26
    v_permlane16_swap_b32 v25, v27
    buffer_store_dwordx4 v[24:27], v207, s[24:27], s58 offen sc1
    s_endpgm
K1_SPIN1:
    s_add_u32 s31, s31, 1
    s_cmp_gt_u32 s31, 0x20000
    s_cbranch_scc1 K1_CHK1_OK
    buffer_load_dword v208, v204, s[12:15], s60 offen offset:0 sc1
    s_waitcnt vmcnt(0)
    v_cmp_ne_u32 vcc, s54, v208
    s_cmp_eq_u32 vcc_lo, 0
    s_cbranch_scc0 K1_SPIN1
    s_branch K1_CHK1_OK
K1_SPIN2:
    s_add_u32 s31, s31, 1
    s_cmp_gt_u32 s31, 0x20000
    s_cbranch_scc1 K1_CHK2_OK
    buffer_load_dword v208, v204, s[12:15], s60 offen offset:16 sc1
    s_waitcnt vmcnt(0)
    v_cmp_ne_u32 vcc, s54, v208
    s_cmp_eq_u32 vcc_lo, 0
    s_cbranch_scc0 K1_SPIN2
    s_branch K1_CHK2_OK
K1_SPIN3:
    s_add_u32 s31, s31, 1
    s_cmp_gt_u32 s31, 0x20000
    s_cbranch_scc1 K1_CHK3_OK
    buffer_load_dword v208, v204, s[12:15], s60 offen offset:32 sc1
    s_waitcnt vmcnt(0)
    v_cmp_ne_u32 vcc, s54, v208
    s_cmp_eq_u32 vcc_lo, 0
    s_cbranch_scc0 K1_SPIN3
    s_branch K1_CHK3_OK
K1_SPIN4:
    s_add_u32 s31, s31, 1
    s_cmp_gt_u32 s31, 0x20000
    s_cbranch_scc1 K1_CHK4_OK
    buffer_load_dword v208, v204, s[12:15], s60 offen offset:48 sc1
    s_waitcnt vmcnt(0)
    v_cmp_ne_u32 vcc, s54, v208
    s_cmp_eq_u32 vcc_lo, 0
    s_cbranch_scc0 K1_SPIN4
    s_branch K1_CHK4_OK
K1_SLOW:
    s_waitcnt vmcnt(0)
    s_nop 7
    s_nop 7
    v_mbcnt_lo_u32_b32 v212, -1, 0
    v_mbcnt_hi_u32_b32 v212, -1, v212
    v_and_b32 v211, 15, v212
    v_lshrrev_b32 v212, 4, v212
    v_lshlrev_b32 v210, 8, v211
    v_lshl_add_u32 v210, v212, 4, v210
    v_lshlrev_b32 v211, 1, v211
    v_lshl_add_u32 v211, v212, 10, v211
    s_lshl_b32 s32, s41, 18
    s_add_u32 s34, s32, 262144
    v_mov_b32 v28, 0xff800000
    v_mov_b32 v60, 0xff800000
    v_mov_b32 v92, 0xff800000
    v_mov_b32 v124, 0xff800000
K1_SL1:
    s_add_u32 s33, s32, 4096
    buffer_load_dwordx4 a[176:179], v210, s[4:7], s32 offen offset:0
    buffer_load_dwordx4 a[180:183], v210, s[4:7], s32 offen offset:64
    buffer_load_dwordx4 a[184:187], v210, s[4:7], s32 offen offset:128
    buffer_load_dwordx4 a[188:191], v210, s[4:7], s32 offen offset:192
    buffer_load_dwordx4 a[192:195], v210, s[4:7], s33 offen offset:0
    buffer_load_dwordx4 a[196:199], v210, s[4:7], s33 offen offset:64
    buffer_load_dwordx4 a[200:203], v210, s[4:7], s33 offen offset:128
    buffer_load_dwordx4 a[204:207], v210, s[4:7], s33 offen offset:192
    s_waitcnt vmcnt(0)
    v_mfma_f32_16x16x32_bf16 v[0:3], a[176:179], v[128:131], 0
    v_mfma_f32_16x16x32_bf16 v[32:35], a[176:179], v[144:147], 0
    v_mfma_f32_16x16x32_bf16 v[64:67], a[176:179], v[160:163], 0
    v_mfma_f32_16x16x32_bf16 v[96:99], a[176:179], v[176:179], 0
    v_mfma_f32_16x16x32_bf16 v[4:7], a[192:195], v[128:131], 0
    v_mfma_f32_16x16x32_bf16 v[36:39], a[192:195], v[144:147], 0
    v_mfma_f32_16x16x32_bf16 v[68:71], a[192:195], v[160:163], 0
    v_mfma_f32_16x16x32_bf16 v[100:103], a[192:195], v[176:179], 0
    v_mfma_f32_16x16x32_bf16 v[0:3], a[180:183], v[132:135], v[0:3]
    v_mfma_f32_16x16x32_bf16 v[32:35], a[180:183], v[148:151], v[32:35]
    v_mfma_f32_16x16x32_bf16 v[64:67], a[180:183], v[164:167], v[64:67]
    v_mfma_f32_16x16x32_bf16 v[96:99], a[180:183], v[180:183], v[96:99]
    v_mfma_f32_16x16x32_bf16 v[4:7], a[196:199], v[132:135], v[4:7]
    v_mfma_f32_16x16x32_bf16 v[36:39], a[196:199], v[148:151], v[36:39]
    v_mfma_f32_16x16x32_bf16 v[68:71], a[196:199], v[164:167], v[68:71]
    v_mfma_f32_16x16x32_bf16 v[100:103], a[196:199], v[180:183], v[100:103]
    v_mfma_f32_16x16x32_bf16 v[0:3], a[184:187], v[136:139], v[0:3]
    v_mfma_f32_16x16x32_bf16 v[32:35], a[184:187], v[152:155], v[32:35]
    v_mfma_f32_16x16x32_bf16 v[64:67], a[184:187], v[168:171], v[64:67]
    v_mfma_f32_16x16x32_bf16 v[96:99], a[184:187], v[184:187], v[96:99]
    v_mfma_f32_16x16x32_bf16 v[4:7], a[200:203], v[136:139], v[4:7]
    v_mfma_f32_16x16x32_bf16 v[36:39], a[200:203], v[152:155], v[36:39]
    v_mfma_f32_16x16x32_bf16 v[68:71], a[200:203], v[168:171], v[68:71]
    v_mfma_f32_16x16x32_bf16 v[100:103], a[200:203], v[184:187], v[100:103]
    v_mfma_f32_16x16x32_bf16 v[0:3], a[188:191], v[140:143], v[0:3]
    v_mfma_f32_16x16x32_bf16 v[32:35], a[188:191], v[156:159], v[32:35]
    v_mfma_f32_16x16x32_bf16 v[64:67], a[188:191], v[172:175], v[64:67]
    v_mfma_f32_16x16x32_bf16 v[96:99], a[188:191], v[188:191], v[96:99]
    v_mfma_f32_16x16x32_bf16 v[4:7], a[204:207], v[140:143], v[4:7]
    v_mfma_f32_16x16x32_bf16 v[36:39], a[204:207], v[156:159], v[36:39]
    v_mfma_f32_16x16x32_bf16 v[68:71], a[204:207], v[172:175], v[68:71]
    v_mfma_f32_16x16x32_bf16 v[100:103], a[204:207], v[188:191], v[100:103]
    s_nop 7
    v_max3_f32 v28, v28, v0, v1
    v_max3_f32 v28, v28, v2, v3
    v_max3_f32 v28, v28, v4, v5
    v_max3_f32 v28, v28, v6, v7
    v_max3_f32 v60, v60, v32, v33
    v_max3_f32 v60, v60, v34, v35
    v_max3_f32 v60, v60, v36, v37
    v_max3_f32 v60, v60, v38, v39
    v_max3_f32 v92, v92, v64, v65
    v_max3_f32 v92, v92, v66, v67
    v_max3_f32 v92, v92, v68, v69
    v_max3_f32 v92, v92, v70, v71
    v_max3_f32 v124, v124, v96, v97
    v_max3_f32 v124, v124, v98, v99
    v_max3_f32 v124, v124, v100, v101
    v_max3_f32 v124, v124, v102, v103
    s_add_u32 s32, s32, 8192
    s_cmp_lt_u32 s32, s34
    s_cbranch_scc1 K1_SL1
    v_mov_b32 v29, v28
    s_nop 1
    v_permlane16_swap_b32 v28, v29
    v_max_f32 v28, v28, v29
    v_mov_b32 v29, v28
    s_nop 1
    v_permlane32_swap_b32 v28, v29
    v_max_f32 v28, v28, v29
    v_sub_f32 v24, 0, v28
    v_mov_b32 v25, v24
    v_mov_b32 v26, v24
    v_mov_b32 v27, v24
    v_mov_b32 v61, v60
    s_nop 1
    v_permlane16_swap_b32 v60, v61
    v_max_f32 v60, v60, v61
    v_mov_b32 v61, v60
    s_nop 1
    v_permlane32_swap_b32 v60, v61
    v_max_f32 v60, v60, v61
    v_sub_f32 v56, 0, v60
    v_mov_b32 v57, v56
    v_mov_b32 v58, v56
    v_mov_b32 v59, v56
    v_mov_b32 v93, v92
    s_nop 1
    v_permlane16_swap_b32 v92, v93
    v_max_f32 v92, v92, v93
    v_mov_b32 v93, v92
    s_nop 1
    v_permlane32_swap_b32 v92, v93
    v_max_f32 v92, v92, v93
    v_sub_f32 v88, 0, v92
    v_mov_b32 v89, v88
    v_mov_b32 v90, v88
    v_mov_b32 v91, v88
    v_mov_b32 v125, v124
    s_nop 1
    v_permlane16_swap_b32 v124, v125
    v_max_f32 v124, v124, v125
    v_mov_b32 v125, v124
    s_nop 1
    v_permlane32_swap_b32 v124, v125
    v_max_f32 v124, v124, v125
    v_sub_f32 v120, s61, v124
    v_mov_b32 v121, v120
    v_mov_b32 v122, v120
    v_mov_b32 v123, v120
    v_mfma_f32_32x32x16_bf16 a[0:15], a[244:247], a[244:247], 0
    v_mfma_f32_32x32x16_bf16 a[16:31], a[244:247], a[244:247], 0
    v_mfma_f32_32x32x16_bf16 a[32:47], a[244:247], a[244:247], 0
    v_mfma_f32_32x32x16_bf16 a[48:63], a[244:247], a[244:247], 0
    v_mfma_f32_32x32x16_bf16 a[64:79], a[244:247], a[244:247], 0
    v_mfma_f32_32x32x16_bf16 a[80:95], a[244:247], a[244:247], 0
    v_mfma_f32_32x32x16_bf16 a[96:111], a[244:247], a[244:247], 0
    v_mfma_f32_32x32x16_bf16 a[112:127], a[244:247], a[244:247], 0
    v_mfma_f32_32x32x16_bf16 a[128:143], a[244:247], a[244:247], 0
    s_lshl_b32 s32, s41, 18
K1_SL2:
    s_add_u32 s33, s32, 4096
    buffer_load_dwordx4 a[176:179], v210, s[4:7], s32 offen offset:0
    buffer_load_dwordx4 a[180:183], v210, s[4:7], s32 offen offset:64
    buffer_load_dwordx4 a[184:187], v210, s[4:7], s32 offen offset:128
    buffer_load_dwordx4 a[188:191], v210, s[4:7], s32 offen offset:192
    buffer_load_dwordx4 a[192:195], v210, s[4:7], s33 offen offset:0
    buffer_load_dwordx4 a[196:199], v210, s[4:7], s33 offen offset:64
    buffer_load_dwordx4 a[200:203], v210, s[4:7], s33 offen offset:128
    buffer_load_dwordx4 a[204:207], v210, s[4:7], s33 offen offset:192
    buffer_load_ushort v8, v211, s[8:11], s32 offen offset:0
    buffer_load_ushort v20, v211, s[8:11], s32 offen offset:256
    buffer_load_ushort v9, v211, s[8:11], s32 offen offset:512
    buffer_load_ushort v21, v211, s[8:11], s32 offen offset:768
    buffer_load_ushort v12, v211, s[8:11], s32 offen offset:32
    buffer_load_ushort v22, v211, s[8:11], s32 offen offset:288
    buffer_load_ushort v13, v211, s[8:11], s32 offen offset:544
    buffer_load_ushort v23, v211, s[8:11], s32 offen offset:800
    buffer_load_ushort v40, v211, s[8:11], s32 offen offset:64
    buffer_load_ushort v52, v211, s[8:11], s32 offen offset:320
    buffer_load_ushort v41, v211, s[8:11], s32 offen offset:576
    buffer_load_ushort v53, v211, s[8:11], s32 offen offset:832
    buffer_load_ushort v44, v211, s[8:11], s32 offen offset:96
    buffer_load_ushort v54, v211, s[8:11], s32 offen offset:352
    buffer_load_ushort v45, v211, s[8:11], s32 offen offset:608
    buffer_load_ushort v55, v211, s[8:11], s32 offen offset:864
    buffer_load_ushort v72, v211, s[8:11], s32 offen offset:128
    buffer_load_ushort v84, v211, s[8:11], s32 offen offset:384
    buffer_load_ushort v73, v211, s[8:11], s32 offen offset:640
    buffer_load_ushort v85, v211, s[8:11], s32 offen offset:896
    buffer_load_ushort v76, v211, s[8:11], s32 offen offset:160
    buffer_load_ushort v86, v211, s[8:11], s32 offen offset:416
    buffer_load_ushort v77, v211, s[8:11], s32 offen offset:672
    buffer_load_ushort v87, v211, s[8:11], s32 offen offset:928
    buffer_load_ushort v104, v211, s[8:11], s32 offen offset:192
    buffer_load_ushort v116, v211, s[8:11], s32 offen offset:448
    buffer_load_ushort v105, v211, s[8:11], s32 offen offset:704
    buffer_load_ushort v117, v211, s[8:11], s32 offen offset:960
    buffer_load_ushort v108, v211, s[8:11], s32 offen offset:224
    buffer_load_ushort v118, v211, s[8:11], s32 offen offset:480
    buffer_load_ushort v109, v211, s[8:11], s32 offen offset:736
    buffer_load_ushort v119, v211, s[8:11], s32 offen offset:992
    s_waitcnt vmcnt(0)
    v_lshl_or_b32 v8, v20, 16, v8
    v_lshl_or_b32 v9, v21, 16, v9
    v_lshl_or_b32 v12, v22, 16, v12
    v_lshl_or_b32 v13, v23, 16, v13
    v_lshl_or_b32 v40, v52, 16, v40
    v_lshl_or_b32 v41, v53, 16, v41
    v_lshl_or_b32 v44, v54, 16, v44
    v_lshl_or_b32 v45, v55, 16, v45
    v_lshl_or_b32 v72, v84, 16, v72
    v_lshl_or_b32 v73, v85, 16, v73
    v_lshl_or_b32 v76, v86, 16, v76
    v_lshl_or_b32 v77, v87, 16, v77
    v_lshl_or_b32 v104, v116, 16, v104
    v_lshl_or_b32 v105, v117, 16, v105
    v_lshl_or_b32 v108, v118, 16, v108
    v_lshl_or_b32 v109, v119, 16, v109
    buffer_load_ushort v10, v211, s[8:11], s33 offen offset:0
    buffer_load_ushort v20, v211, s[8:11], s33 offen offset:256
    buffer_load_ushort v11, v211, s[8:11], s33 offen offset:512
    buffer_load_ushort v21, v211, s[8:11], s33 offen offset:768
    buffer_load_ushort v14, v211, s[8:11], s33 offen offset:32
    buffer_load_ushort v22, v211, s[8:11], s33 offen offset:288
    buffer_load_ushort v15, v211, s[8:11], s33 offen offset:544
    buffer_load_ushort v23, v211, s[8:11], s33 offen offset:800
    buffer_load_ushort v42, v211, s[8:11], s33 offen offset:64
    buffer_load_ushort v52, v211, s[8:11], s33 offen offset:320
    buffer_load_ushort v43, v211, s[8:11], s33 offen offset:576
    buffer_load_ushort v53, v211, s[8:11], s33 offen offset:832
    buffer_load_ushort v46, v211, s[8:11], s33 offen offset:96
    buffer_load_ushort v54, v211, s[8:11], s33 offen offset:352
    buffer_load_ushort v47, v211, s[8:11], s33 offen offset:608
    buffer_load_ushort v55, v211, s[8:11], s33 offen offset:864
    buffer_load_ushort v74, v211, s[8:11], s33 offen offset:128
    buffer_load_ushort v84, v211, s[8:11], s33 offen offset:384
    buffer_load_ushort v75, v211, s[8:11], s33 offen offset:640
    buffer_load_ushort v85, v211, s[8:11], s33 offen offset:896
    buffer_load_ushort v78, v211, s[8:11], s33 offen offset:160
    buffer_load_ushort v86, v211, s[8:11], s33 offen offset:416
    buffer_load_ushort v79, v211, s[8:11], s33 offen offset:672
    buffer_load_ushort v87, v211, s[8:11], s33 offen offset:928
    buffer_load_ushort v106, v211, s[8:11], s33 offen offset:192
    buffer_load_ushort v116, v211, s[8:11], s33 offen offset:448
    buffer_load_ushort v107, v211, s[8:11], s33 offen offset:704
    buffer_load_ushort v117, v211, s[8:11], s33 offen offset:960
    buffer_load_ushort v110, v211, s[8:11], s33 offen offset:224
    buffer_load_ushort v118, v211, s[8:11], s33 offen offset:480
    buffer_load_ushort v111, v211, s[8:11], s33 offen offset:736
    buffer_load_ushort v119, v211, s[8:11], s33 offen offset:992
    s_waitcnt vmcnt(0)
    v_lshl_or_b32 v10, v20, 16, v10
    v_lshl_or_b32 v11, v21, 16, v11
    v_lshl_or_b32 v14, v22, 16, v14
    v_lshl_or_b32 v15, v23, 16, v15
    v_lshl_or_b32 v42, v52, 16, v42
    v_lshl_or_b32 v43, v53, 16, v43
    v_lshl_or_b32 v46, v54, 16, v46
    v_lshl_or_b32 v47, v55, 16, v47
    v_lshl_or_b32 v74, v84, 16, v74
    v_lshl_or_b32 v75, v85, 16, v75
    v_lshl_or_b32 v78, v86, 16, v78
    v_lshl_or_b32 v79, v87, 16, v79
    v_lshl_or_b32 v106, v116, 16, v106
    v_lshl_or_b32 v107, v117, 16, v107
    v_lshl_or_b32 v110, v118, 16, v110
    v_lshl_or_b32 v111, v119, 16, v111
    v_mfma_f32_16x16x32_bf16 v[0:3], a[176:179], v[128:131], v[24:27]
    v_mfma_f32_16x16x32_bf16 v[32:35], a[176:179], v[144:147], v[56:59]
    v_mfma_f32_16x16x32_bf16 v[64:67], a[176:179], v[160:163], v[88:91]
    v_mfma_f32_16x16x32_bf16 v[96:99], a[176:179], v[176:179], v[120:123]
    v_mfma_f32_16x16x32_bf16 v[4:7], a[192:195], v[128:131], v[24:27]
    v_mfma_f32_16x16x32_bf16 v[36:39], a[192:195], v[144:147], v[56:59]
    v_mfma_f32_16x16x32_bf16 v[68:71], a[192:195], v[160:163], v[88:91]
    v_mfma_f32_16x16x32_bf16 v[100:103], a[192:195], v[176:179], v[120:123]
    v_mfma_f32_16x16x32_bf16 v[0:3], a[180:183], v[132:135], v[0:3]
    v_mfma_f32_16x16x32_bf16 v[32:35], a[180:183], v[148:151], v[32:35]
    v_mfma_f32_16x16x32_bf16 v[64:67], a[180:183], v[164:167], v[64:67]
    v_mfma_f32_16x16x32_bf16 v[96:99], a[180:183], v[180:183], v[96:99]
    v_mfma_f32_16x16x32_bf16 v[4:7], a[196:199], v[132:135], v[4:7]
    v_mfma_f32_16x16x32_bf16 v[36:39], a[196:199], v[148:151], v[36:39]
    v_mfma_f32_16x16x32_bf16 v[68:71], a[196:199], v[164:167], v[68:71]
    v_mfma_f32_16x16x32_bf16 v[100:103], a[196:199], v[180:183], v[100:103]
    v_mfma_f32_16x16x32_bf16 v[0:3], a[184:187], v[136:139], v[0:3]
    v_mfma_f32_16x16x32_bf16 v[32:35], a[184:187], v[152:155], v[32:35]
    v_mfma_f32_16x16x32_bf16 v[64:67], a[184:187], v[168:171], v[64:67]
    v_mfma_f32_16x16x32_bf16 v[96:99], a[184:187], v[184:187], v[96:99]
    v_mfma_f32_16x16x32_bf16 v[4:7], a[200:203], v[136:139], v[4:7]
    v_mfma_f32_16x16x32_bf16 v[36:39], a[200:203], v[152:155], v[36:39]
    v_mfma_f32_16x16x32_bf16 v[68:71], a[200:203], v[168:171], v[68:71]
    v_mfma_f32_16x16x32_bf16 v[100:103], a[200:203], v[184:187], v[100:103]
    v_mfma_f32_16x16x32_bf16 v[0:3], a[188:191], v[140:143], v[0:3]
    v_mfma_f32_16x16x32_bf16 v[32:35], a[188:191], v[156:159], v[32:35]
    v_mfma_f32_16x16x32_bf16 v[64:67], a[188:191], v[172:175], v[64:67]
    v_mfma_f32_16x16x32_bf16 v[96:99], a[188:191], v[188:191], v[96:99]
    v_mfma_f32_16x16x32_bf16 v[4:7], a[204:207], v[140:143], v[4:7]
    v_mfma_f32_16x16x32_bf16 v[36:39], a[204:207], v[156:159], v[36:39]
    v_mfma_f32_16x16x32_bf16 v[68:71], a[204:207], v[172:175], v[68:71]
    v_mfma_f32_16x16x32_bf16 v[100:103], a[204:207], v[188:191], v[100:103]
    s_nop 7
    v_exp_f32 v0, v0
    v_exp_f32 v1, v1
    v_exp_f32 v2, v2
    v_exp_f32 v3, v3
    v_cvt_pk_bf16_f32 v16, v0, v1
    v_exp_f32 v4, v4
    v_exp_f32 v5, v5
    v_cvt_pk_bf16_f32 v17, v2, v3
    v_exp_f32 v6, v6
    v_exp_f32 v7, v7
    v_cvt_pk_bf16_f32 v18, v4, v5
    v_exp_f32 v32, v32
    v_exp_f32 v33, v33
    v_cvt_pk_bf16_f32 v19, v6, v7
    v_exp_f32 v34, v34
    v_exp_f32 v35, v35
    v_cvt_pk_bf16_f32 v48, v32, v33
    v_exp_f32 v36, v36
    v_exp_f32 v37, v37
    v_cvt_pk_bf16_f32 v49, v34, v35
    v_exp_f32 v38, v38
    v_exp_f32 v39, v39
    v_cvt_pk_bf16_f32 v50, v36, v37
    v_exp_f32 v64, v64
    v_exp_f32 v65, v65
    v_cvt_pk_bf16_f32 v51, v38, v39
    v_exp_f32 v66, v66
    v_exp_f32 v67, v67
    v_cvt_pk_bf16_f32 v80, v64, v65
    v_exp_f32 v68, v68
    v_exp_f32 v69, v69
    v_cvt_pk_bf16_f32 v81, v66, v67
    v_exp_f32 v70, v70
    v_exp_f32 v71, v71
    v_cvt_pk_bf16_f32 v82, v68, v69
    v_exp_f32 v96, v96
    v_exp_f32 v97, v97
    v_cvt_pk_bf16_f32 v83, v70, v71
    v_exp_f32 v98, v98
    v_exp_f32 v99, v99
    v_cvt_pk_bf16_f32 v112, v96, v97
    v_exp_f32 v100, v100
    v_exp_f32 v101, v101
    v_cvt_pk_bf16_f32 v113, v98, v99
    v_exp_f32 v102, v102
    v_exp_f32 v103, v103
    v_cvt_pk_bf16_f32 v114, v100, v101
    v_cvt_pk_bf16_f32 v115, v102, v103
    s_nop 1
    v_mfma_f32_16x16x32_bf16 a[0:3], v[8:11], v[16:19], a[0:3]
    v_mfma_f32_16x16x32_bf16 a[32:35], v[8:11], v[48:51], a[32:35]
    v_mfma_f32_16x16x32_bf16 a[64:67], v[8:11], v[80:83], a[64:67]
    v_mfma_f32_16x16x32_bf16 a[96:99], v[8:11], v[112:115], a[96:99]
    v_mfma_f32_16x16x32_bf16 a[4:7], v[12:15], v[16:19], a[4:7]
    v_mfma_f32_16x16x32_bf16 a[36:39], v[12:15], v[48:51], a[36:39]
    v_mfma_f32_16x16x32_bf16 a[68:71], v[12:15], v[80:83], a[68:71]
    v_mfma_f32_16x16x32_bf16 a[100:103], v[12:15], v[112:115], a[100:103]
    v_mfma_f32_16x16x32_bf16 a[8:11], v[40:43], v[16:19], a[8:11]
    v_mfma_f32_16x16x32_bf16 a[40:43], v[40:43], v[48:51], a[40:43]
    v_mfma_f32_16x16x32_bf16 a[72:75], v[40:43], v[80:83], a[72:75]
    v_mfma_f32_16x16x32_bf16 a[104:107], v[40:43], v[112:115], a[104:107]
    v_mfma_f32_16x16x32_bf16 a[12:15], v[44:47], v[16:19], a[12:15]
    v_mfma_f32_16x16x32_bf16 a[44:47], v[44:47], v[48:51], a[44:47]
    v_mfma_f32_16x16x32_bf16 a[76:79], v[44:47], v[80:83], a[76:79]
    v_mfma_f32_16x16x32_bf16 a[108:111], v[44:47], v[112:115], a[108:111]
    v_mfma_f32_16x16x32_bf16 a[16:19], v[72:75], v[16:19], a[16:19]
    v_mfma_f32_16x16x32_bf16 a[48:51], v[72:75], v[48:51], a[48:51]
    v_mfma_f32_16x16x32_bf16 a[80:83], v[72:75], v[80:83], a[80:83]
    v_mfma_f32_16x16x32_bf16 a[112:115], v[72:75], v[112:115], a[112:115]
    v_mfma_f32_16x16x32_bf16 a[20:23], v[76:79], v[16:19], a[20:23]
    v_mfma_f32_16x16x32_bf16 a[52:55], v[76:79], v[48:51], a[52:55]
    v_mfma_f32_16x16x32_bf16 a[84:87], v[76:79], v[80:83], a[84:87]
    v_mfma_f32_16x16x32_bf16 a[116:119], v[76:79], v[112:115], a[116:119]
    v_mfma_f32_16x16x32_bf16 a[24:27], v[104:107], v[16:19], a[24:27]
    v_mfma_f32_16x16x32_bf16 a[56:59], v[104:107], v[48:51], a[56:59]
    v_mfma_f32_16x16x32_bf16 a[88:91], v[104:107], v[80:83], a[88:91]
    v_mfma_f32_16x16x32_bf16 a[120:123], v[104:107], v[112:115], a[120:123]
    v_mfma_f32_16x16x32_bf16 a[28:31], v[108:111], v[16:19], a[28:31]
    v_mfma_f32_16x16x32_bf16 a[60:63], v[108:111], v[48:51], a[60:63]
    v_mfma_f32_16x16x32_bf16 a[92:95], v[108:111], v[80:83], a[92:95]
    v_mfma_f32_16x16x32_bf16 a[124:127], v[108:111], v[112:115], a[124:127]
    v_mfma_f32_16x16x32_bf16 a[128:131], a[240:243], v[16:19], a[128:131]
    v_mfma_f32_16x16x32_bf16 a[132:135], a[240:243], v[48:51], a[132:135]
    v_mfma_f32_16x16x32_bf16 a[136:139], a[240:243], v[80:83], a[136:139]
    v_mfma_f32_16x16x32_bf16 a[140:143], a[240:243], v[112:115], a[140:143]
    s_add_u32 s32, s32, 8192
    s_cmp_lt_u32 s32, s34
    s_cbranch_scc1 K1_SL2
    s_nop 7
    v_accvgpr_read_b32 v210, a128
    v_accvgpr_read_b32 v212, a132
    v_accvgpr_read_b32 v214, a136
    v_accvgpr_read_b32 v216, a140
    v_rcp_f32 v210, v210
    v_rcp_f32 v212, v212
    v_rcp_f32 v214, v214
    v_rcp_f32 v216, v216
    v_mov_b32 v211, v210
    v_mov_b32 v213, v212
    v_mov_b32 v215, v214
    v_mov_b32 v217, v216
    s_cmp_eq_u32 s41, 1
    s_cbranch_scc1 K1_SLOW_RET2
    ds_read_b128 v[128:131], v222 offset:0
    ds_read_b128 v[132:135], v222 offset:1024
    ds_read_b128 v[136:139], v222 offset:2048
    ds_read_b128 v[140:143], v222 offset:3072
    ds_read_b128 v[144:147], v222 offset:4096
    ds_read_b128 v[148:151], v222 offset:5120
    ds_read_b128 v[152:155], v222 offset:6144
    ds_read_b128 v[156:159], v222 offset:7168
    v_mov_b32 v160, v224
    v_mov_b32 v161, v225
    v_mov_b32 v162, v226
    v_mov_b32 v163, v227
    v_mov_b32 v164, v228
    v_mov_b32 v165, v229
    v_mov_b32 v166, v230
    v_mov_b32 v167, v231
    v_mov_b32 v168, v232
    v_mov_b32 v169, v233
    v_mov_b32 v170, v234
    v_mov_b32 v171, v235
    v_mov_b32 v172, v236
    v_mov_b32 v173, v237
    v_mov_b32 v174, v238
    v_mov_b32 v175, v239
    v_mov_b32 v176, v240
    v_mov_b32 v177, v241
    v_mov_b32 v178, v242
    v_mov_b32 v179, v243
    v_mov_b32 v180, v244
    v_mov_b32 v181, v245
    v_mov_b32 v182, v246
    v_mov_b32 v183, v247
    v_mov_b32 v184, v248
    v_mov_b32 v185, v249
    v_mov_b32 v186, v250
    v_mov_b32 v187, v251
    v_mov_b32 v188, v252
    v_mov_b32 v189, v253
    v_mov_b32 v190, v254
    v_mov_b32 v191, v255
    s_branch K1_SLOW_RET
K1_END:
    s_endpgm
.section .rodata,"a"
.p2align 6
.amdhsa_kernel concat_heads__mha_block_cached__gqa_block_cached__near_ridge_kernel
  .amdhsa_next_free_vgpr 512
  .amdhsa_next_free_sgpr 102
  .amdhsa_accum_offset 256
  .amdhsa_group_segment_fixed_size 0
  .amdhsa_kernarg_size 104
  .amdhsa_user_sgpr_count 2
  .amdhsa_user_sgpr_kernarg_segment_ptr 1
  .amdhsa_system_sgpr_workgroup_id_x 1
.end_amdhsa_kernel
```
